```python
import torch

def _softmax(x, axis=-1):
    return torch.softmax(x, dim=axis)

def _gelu(x):
    return torch.nn.functional.gelu(x, approximate='tanh')

def _silu(x):
    return torch.nn.functional.silu(x)

def _sigmoid(x):
    return torch.sigmoid(x)

def _layernorm(x, axis=-1, eps=1e-05):
    m = x.mean(dim=axis, keepdim=True)
    v = x.var(dim=axis, keepdim=True, unbiased=False)
    return (x - m) / torch.sqrt(v + eps)

def _scatter_add(tgt, idx, src, axis=0):
    return tgt.clone().index_add_(axis, idx, src)

def _segment_sum(src, seg, n):
    out = torch.zeros((n,) + src.shape[1:], dtype=src.dtype)
    return out.index_add_(0, seg, src)

def _pad(x, pw):
    flat = tuple((v for pair in reversed(pw) for v in pair))
    return torch.nn.functional.pad(x, flat)
kernel_name = 'gated_mix__grouped_kv_mqa__memory_aug_recurrent_mem_tr__prompt'

def setup_inputs():

    _w = lambda a: (lambda t: t.to(torch.bfloat16) if t.is_floating_point() else t)(torch.as_tensor(a))

    def _A_setup():
        B, S, D, H = (1, 2048, 1024, 32)
        Dh = D // H
        return {'x': _w((lambda *s: torch.randn(*s, dtype=torch.bfloat16) * 0.1)(B, S, D)), 'wq': _w((lambda *s: torch.randn(*s, dtype=torch.bfloat16) * 0.8)(D, H * Dh)), 'wk': _w((lambda *s: torch.randn(*s, dtype=torch.bfloat16) * 0.2)(D, Dh)), 'wv': _w((lambda *s: torch.randn(*s, dtype=torch.bfloat16) * 0.2)(D, Dh)), 'wo': _w((lambda *s: torch.randn(*s, dtype=torch.bfloat16) * 0.2)(H * Dh, D))}
    _A_in = _A_setup()

    def _B_setup():
        B, S, Dm = (1, 2048, 1024)
        H, Dh = (32, 128)
        M, seg = (8, 32)
        seg = min(seg, S)
        S = S // seg * seg
        return {'x': _w((lambda *s: torch.randn(*s, dtype=torch.bfloat16) * 0.1)(B, S, Dm)), 'mem0': _w((lambda *s: torch.randn(*s, dtype=torch.bfloat16) * 1.6)(B, M, Dm)), 'Wq': _w((lambda *s: torch.randn(*s, dtype=torch.bfloat16) * 0.8)(Dm, H, Dh) * Dm ** (-0.5)), 'Wk': _w((lambda *s: torch.randn(*s, dtype=torch.bfloat16) * 0.8)(Dm, H, Dh) * Dm ** (-0.5)), 'Wv': _w((lambda *s: torch.randn(*s, dtype=torch.bfloat16) * 1.6)(Dm, H, Dh) * Dm ** (-0.5)), 'Wo': _w((lambda *s: torch.randn(*s, dtype=torch.bfloat16) * 1.6)(H, Dh, Dm) * (H * Dh) ** (-0.5)), 'seg_len': seg}
    _B_in = _B_setup()
    return {'A_x': _A_in['x'], 'A_wq': _A_in['wq'], 'A_wk': _A_in['wk'], 'A_wv': _A_in['wv'], 'A_wo': _A_in['wo'], 'B_x': _B_in['x'], 'B_mem0': _B_in['mem0'], 'B_Wq': _B_in['Wq'], 'B_Wk': _B_in['Wk'], 'B_Wv': _B_in['Wv'], 'B_Wo': _B_in['Wo'], 'B_seg_len': _B_in['seg_len'], 'gate_w': _w((lambda *s: torch.randn(*s, dtype=torch.bfloat16) * 1.6)(1024) * 16.0)}

def reference(A_x, A_wq, A_wk, A_wv, A_wo, B_x, B_mem0, B_Wq, B_Wk, B_Wv, B_Wo, B_seg_len, gate_w):

    def _A_ref(x, wq, wk, wv, wo):
        B, S, D = x.shape
        H = 32
        Dh = D // H
        q = (lambda x, *d: x.permute(*d))((x @ wq).reshape(B, S, H, Dh), 0, 2, 1, 3)
        k = x @ wk
        v = x @ wv
        scores = torch.einsum('bhqd,bkd->bhqk', q, k) * Dh ** (-0.5)
        p = _softmax(scores, axis=-1)
        o = torch.einsum('bhqk,bkd->bhqd', p, v)
        return (lambda x, *d: x.permute(*d))(o, 0, 2, 1, 3).reshape(B, S, H * Dh) @ wo

    def _B_ref(x, mem0, Wq, Wk, Wv, Wo, seg_len):
        B, S, Dm = x.shape
        H, Dh = (Wq.shape[1], Wq.shape[2])
        M = mem0.shape[1]
        scale = Dh ** (-0.5)
        n_seg = S // seg_len
        L = M + seg_len
        idx = torch.arange(L)
        mask = (idx[:, None] < M) | (idx[:, None] >= idx[None, :])
        mem = mem0
        outs = []
        for s in range(n_seg):
            xs = x[:, s * seg_len:(s + 1) * seg_len, :].clone()
            h = torch.concatenate([mem, xs], axis=1)
            q = torch.einsum('btd,dhe->bhte', h, Wq)
            k = torch.einsum('btd,dhe->bhte', h, Wk)
            v = torch.einsum('btd,dhe->bhte', h, Wv)
            scores = torch.einsum('bhqe,bhke->bhqk', q, k) * scale
            scores = torch.where(mask[None, None], scores, -1000000000.0)
            p = _softmax(scores, axis=-1)
            o = torch.einsum('bhqk,bhke->bhqe', p, v)
            o = torch.einsum('bhte,hed->btd', o, Wo)
            mem = o[:, :M, :].clone()
            outs.append(o[:, M:, :])
        return torch.concatenate(outs, axis=1)
    x = A_x
    g = _sigmoid((x * gate_w).sum(-1, keepdims=True))
    a = _A_ref(x, A_wq, A_wk, A_wv, A_wo)
    b = _B_ref(x, B_mem0, B_Wq, B_Wk, B_Wv, B_Wo, B_seg_len)
    return g * a + (1 - g) * b
```

```asm
; @launch kernel=fused_kernel grid=(256,1,1) block=(512,1,1) lds=163840
.amdgcn_target "amdgcn-amd-amdhsa--gfx950"
.text
.globl fused_kernel
.p2align 8
.type fused_kernel,@function
fused_kernel:
  s_cmp_ge_u32 s2, 256
  s_cbranch_scc1 fused_kernel_end
  s_load_dwordx2 s[4:5], s[0:1], 120
  s_load_dwordx2 s[8:9], s[0:1], 112
  s_load_dwordx2 s[28:29], s[0:1], 56
  s_load_dwordx2 s[32:33], s[0:1], 64
  s_load_dwordx2 s[36:37], s[0:1], 72
  s_load_dwordx2 s[80:81], s[0:1], 48
  s_load_dwordx2 s[84:85], s[0:1], 80
  v_lshrrev_b32 v1, 6, v0
  s_nop 0
  v_readfirstlane_b32 s20, v1
  s_and_b32 s6, s2, 3
  s_lshr_b32 s7, s2, 3
  s_waitcnt lgkmcnt(0)
  s_mov_b32 s24, s4
  s_and_b32 s25, s5, 0xffff
  s_mov_b32 s26, 268435456
  s_mov_b32 s27, 0x20000
  s_and_b32 s9, s9, 0xffff
  s_mov_b32 s10, 256
  s_mov_b32 s11, 0x20000
  s_bitcmp1_b32 s2, 2
  s_cbranch_scc1 fused_kernel_worker
  s_lshl_b32 s47, s6, 5
  s_add_u32 s47, s47, s7
  s_lshr_b32 s21, s47, 4
  s_and_b32 s22, s47, 15
  s_sub_u32 s60, 0, s4
  s_and_b32 s60, s60, 0x1fffff
  s_add_u32 s60, s60, 119537664
  s_cmp_lt_u32 s20, 4
  s_cbranch_scc1 fused_kernel_b
  s_cmp_lg_u32 s20, 6
  s_cbranch_scc1 fused_kernel_c
  s_setprio 3
  s_lshl_b32 s44, s6, 14
  s_lshl_b32 s45, s7, 8
  s_add_u32 s44, s44, s45
  s_add_u32 s44, s44, 1048576
  s_add_u32 s44, s44, s60
  s_and_b32 s46, s7, 1
  s_lshl_b32 s45, s46, 13
  s_add_u32 s44, s44, s45
  s_lshl_b32 s46, s46, 14
  s_sub_u32 s45, s44, s46
  s_add_u32 s45, s45, 8192
  v_and_b32 v1, 63, v0
  v_lshlrev_b32 v2, 2, v1
  v_mov_b32 v12, -1
  v_mov_b32 v13, -1
  v_mov_b32 v14, -1
  v_mov_b32 v15, -1
  buffer_store_dword v12, v2, s[24:27], s44 offen sc1
  buffer_store_dword v12, v2, s[24:27], s45 offen sc1
  v_lshlrev_b32 v9, 4, v1
  v_lshlrev_b32 v10, 3, v1
  v_mov_b32 v16, 0
  v_mov_b32 v17, 0
  s_lshl_b32 s46, s47, 9
  s_add_u32 s46, s46, 124780544
  buffer_store_dwordx2 v[16:17], v10, s[24:27], s46 offen sc1
  s_lshl_b32 s46, s47, 11
  s_add_u32 s46, s46, 118489088
  buffer_store_dwordx4 v[12:15], v9, s[24:27], s46 offen offset:0 sc1
  buffer_store_dwordx4 v[12:15], v9, s[24:27], s46 offen offset:1024 sc1
  s_add_u32 s46, s46, s60
  s_sub_u32 s46, s46, 118489088
  buffer_store_dwordx4 v[12:15], v9, s[24:27], s46 offen offset:0 sc1
  buffer_store_dwordx4 v[12:15], v9, s[24:27], s46 offen offset:1024 sc1
  s_lshl_b32 s46, s6, 18
  s_lshl_b32 s42, s7, 11
  s_add_u32 s46, s46, s42
  s_add_u32 s46, s46, 134283264
  buffer_store_dwordx4 v[12:15], v9, s[24:27], s46 offen offset:0 sc1
  buffer_store_dwordx4 v[12:15], v9, s[24:27], s46 offen offset:1024 sc1
  v_lshlrev_b32 v3, 21, v1
  s_lshl_b32 s46, s47, 6
  s_and_b32 s29, s29, 0xffff
  s_mov_b32 s30, 8388608
  s_mov_b32 s31, 0x20000
  buffer_load_dword v4, v3, s[28:31], s46 offen
  s_and_b32 s33, s33, 0xffff
  s_mov_b32 s34, 8388608
  s_mov_b32 s35, 0x20000
  buffer_load_dword v5, v3, s[32:35], s46 offen
  s_and_b32 s37, s37, 0xffff
  s_mov_b32 s38, 8388608
  s_mov_b32 s39, 0x20000
  buffer_load_dword v6, v3, s[36:39], s46 offen
  s_and_b32 s85, s85, 0xffff
  s_mov_b32 s86, 8388608
  s_mov_b32 s87, 0x20000
  buffer_load_dword v7, v3, s[84:87], s46 offen
  buffer_load_dword v8, off, s[8:11], 0 sc1
  s_getreg_b32 s23, hwreg(HW_REG_XCC_ID)
  s_and_b32 s23, s23, 7
  s_mul_i32 s46, s23, s23
  s_lshl_b32 s23, s23, 12
  s_lshl_b32 s46, s46, 20
  s_add_u32 s23, s23, s46
  s_add_u32 s23, s23, 1
  s_lshl_b32 s42, s6, 3
  s_add_u32 s42, s42, 32
  v_mov_b32 v254, s23
  s_mov_b32 s46, 10
  s_waitcnt vmcnt(0)
  s_mov_b32 s41, 0
  s_mov_b32 s40, s7
  s_and_b32 s47, s22, 14
  s_cmp_lg_u32 s47, 6
  s_cbranch_scc1 cal_1z
  s_mov_b32 s43, 6
cal_1r:
  s_mov_b32 s46, 10
  buffer_store_dword v12, v2, s[24:27], s44 offen sc1
  buffer_store_dword v12, v2, s[24:27], s45 offen sc1
  s_waitcnt vmcnt(1)
cal_1:
  s_getreg_b32 s47, hwreg(HW_REG_IB_STS, 0, 4)
  s_cmp_eq_u32 s47, 0
  s_cbranch_scc1 cal_1x
  s_sub_u32 s46, s46, 1
  s_cbranch_scc0 cal_1
cal_1x:
  s_sub_u32 s47, 0, s46
  s_bitcmp1_b32 s40, 0
  s_cselect_b32 s46, s47, s46
  s_add_u32 s41, s41, s46
  s_xor_b32 s40, s40, 1
  s_mov_b32 s47, s44
  s_mov_b32 s44, s45
  s_mov_b32 s45, s47
  s_waitcnt vmcnt(0)
  s_sub_u32 s43, s43, 1
  s_cmp_lg_u32 s43, 0
  s_cbranch_scc1 cal_1r
  s_barrier
cal_1z:
  s_mov_b32 s46, s41
  v_mov_b32 v255, s46
  s_mov_b64 exec, 1
  buffer_atomic_add_x2 v[254:255], off, s[8:11], s42 sc1
  s_mov_b64 exec, -1
  s_setprio 0
  s_branch fused_kernel_c1
fused_kernel_b:
  v_and_b32 v36, 63, v0
  s_lshl_b32 s44, s21, 4
  s_add_u32 s44, s44, s22
  s_lshl_b32 s46, s20, 21
  s_lshl_b32 s45, s44, 6
  s_add_u32 s46, s46, s45
  v_and_b32 v1, 60, v36
  v_lshlrev_b32 v38, 11, v1
  v_and_b32 v1, 3, v36
  v_lshl_add_u32 v38, v1, 4, v38
  v_add_u32 v38, s46, v38
  s_mul_i32 s42, s20, 24576
  s_mov_b32 s41, s44
  s_and_b32 s29, s29, 0xffff
  s_mov_b32 s30, 8388608
  s_mov_b32 s31, 0x20000
  s_and_b32 s33, s33, 0xffff
  s_mov_b32 s34, 8388608
  s_mov_b32 s35, 0x20000
  s_and_b32 s37, s37, 0xffff
  s_mov_b32 s38, 8388608
  s_mov_b32 s39, 0x20000
  v_and_b32 v1, 62, v36
  v_lshlrev_b32 v40, 15, v1
  v_and_b32 v1, 1, v36
  v_lshl_add_u32 v40, v1, 10, v40
  s_lshl_b32 s45, s20, 21
  s_lshl_b32 s46, s44, 6
  s_add_u32 s45, s45, s46
  s_and_b32 s45, s45, 6297600
  s_and_b32 s46, s44, 7
  s_lshl_b32 s46, s46, 13
  s_add_u32 s45, s45, s46
  s_bfe_u32 s47, s44, 131075
  s_mov_b32 s56, 384
  s_mov_b32 s68, 1023
  s_cmp_lg_u32 s47, 3
  s_cbranch_scc1 b_fx_2n
  v_lshlrev_b32 v40, 18, v36
  s_lshr_b32 s45, s44, 5
  s_lshl_b32 s45, s45, 16
  s_add_u32 s45, s45, s46
  s_mov_b32 s47, s20
  s_mov_b32 s56, 8064
  s_mov_b32 s68, 8191
b_fx_2n:
  s_and_b32 s48, s22, 14
  s_cmp_lg_u32 s48, 6
  s_cbranch_scc1 b_fx_2b
  s_barrier
b_fx_2b:
  s_cmp_lg_u32 s47, 0
  s_cbranch_scc1 b_fx_20
  s_sub_u32 s46, s56, s28
  s_and_b32 s46, s46, s68
  s_add_u32 s45, s45, s46
  buffer_load_dword v39, v40, s[28:31], s45 offen
b_fx_20:
  s_cmp_lg_u32 s47, 1
  s_cbranch_scc1 b_fx_21
  s_sub_u32 s46, s56, s32
  s_and_b32 s46, s46, s68
  s_add_u32 s45, s45, s46
  buffer_load_dword v39, v40, s[32:35], s45 offen
b_fx_21:
  s_cmp_lg_u32 s47, 2
  s_cbranch_scc1 b_fx_22
  s_sub_u32 s46, s56, s36
  s_and_b32 s46, s46, s68
  s_add_u32 s45, s45, s46
  buffer_load_dword v39, v40, s[36:39], s45 offen
b_fx_22:
  s_add_u32 m0, s42, 0
  s_mov_b32 s46, 0
  buffer_load_dwordx4 v38, s[28:31], s46 offen lds
  s_add_u32 m0, s42, 1024
  s_mov_b32 s46, 131072
  buffer_load_dwordx4 v38, s[28:31], s46 offen lds
  s_add_u32 m0, s42, 2048
  s_mov_b32 s46, 262144
  buffer_load_dwordx4 v38, s[28:31], s46 offen lds
  s_add_u32 m0, s42, 3072
  s_mov_b32 s46, 393216
  buffer_load_dwordx4 v38, s[28:31], s46 offen lds
  s_add_u32 m0, s42, 4096
  s_mov_b32 s46, 0
  buffer_load_dwordx4 v38, s[32:35], s46 offen lds
  s_add_u32 m0, s42, 5120
  s_mov_b32 s46, 131072
  buffer_load_dwordx4 v38, s[32:35], s46 offen lds
  s_add_u32 m0, s42, 6144
  s_mov_b32 s46, 262144
  buffer_load_dwordx4 v38, s[32:35], s46 offen lds
  s_add_u32 m0, s42, 7168
  s_mov_b32 s46, 393216
  buffer_load_dwordx4 v38, s[32:35], s46 offen lds
  s_add_u32 m0, s42, 8192
  s_mov_b32 s46, 0
  buffer_load_dwordx4 v38, s[36:39], s46 offen lds
  s_add_u32 m0, s42, 9216
  s_mov_b32 s46, 131072
  buffer_load_dwordx4 v38, s[36:39], s46 offen lds
  s_add_u32 m0, s42, 10240
  s_mov_b32 s46, 262144
  buffer_load_dwordx4 v38, s[36:39], s46 offen lds
  s_add_u32 m0, s42, 11264
  s_mov_b32 s46, 393216
  buffer_load_dwordx4 v38, s[36:39], s46 offen lds
  s_and_b32 s81, s81, 0xffff
  s_mov_b32 s82, 16384
  s_mov_b32 s83, 0x20000
  v_lshlrev_b32 v2, 4, v36
  v_lshlrev_b32 v0, 3, v36
  v_and_b32 v1, 12, v36
  v_lshlrev_b32 v37, 4, v1
  v_and_b32 v1, 48, v36
  v_lshl_add_u32 v37, v1, 5, v37
  v_and_b32 v1, 3, v36
  v_lshl_add_u32 v37, v1, 3, v37
  v_add_u32 v37, s42, v37
  s_lshl_b32 s54, s22, 14
  s_lshl_b32 s45, s20, 11
  s_add_u32 s54, s54, s45
  s_lshl_b32 s49, s21, 7
  s_add_u32 s49, s49, s54
  s_and_b32 s46, s21, 1
  s_lshr_b32 s47, s21, 1
  s_lshl_b32 s45, s46, 10
  s_add_u32 s54, s54, s45
  s_lshl_b32 s55, s47, 14
  s_lshl_b32 s45, s20, 12
  s_add_u32 s55, s55, s45
  s_add_u32 s55, s55, 117440512
  s_lshl_b32 s67, s47, 14
  s_lshl_b32 s45, s22, 10
  s_add_u32 s67, s67, s45
  s_lshl_b32 s45, s20, 8
  s_add_u32 s67, s67, s45
  s_lshl_b32 s45, s46, 7
  s_add_u32 s67, s67, s45
  s_add_u32 s67, s67, 117440512
  v_and_b32 v1, 48, v36
  v_lshlrev_b32 v9, 1, v1
  v_and_b32 v1, 7, v36
  v_lshl_add_u32 v9, v1, 2, v9
  v_and_b32 v1, 32, v36
  v_lshlrev_b32 v14, 5, v1
  v_and_b32 v1, 31, v36
  v_lshl_add_u32 v14, v1, 2, v14
  s_lshr_b32 s46, s44, 2
  s_and_b32 s47, s44, 3
  s_lshl_b32 s69, s46, 13
  s_lshl_b32 s45, s47, 9
  s_add_u32 s69, s69, s45
  s_lshl_b32 s45, s20, 7
  s_add_u32 s69, s69, s45
  s_add_u32 s69, s69, 118489088
  s_lshl_b32 s71, s44, 11
  s_lshl_b32 s45, s20, 9
  s_add_u32 s71, s71, s45
  s_add_u32 s71, s71, 118489088
  s_lshl_b32 s72, s21, 22
  s_lshl_b32 s45, s22, 12
  s_add_u32 s72, s72, s45
  s_lshl_b32 s45, s20, 10
  s_add_u32 s72, s72, s45
  s_add_u32 s72, s72, 83820544
  s_lshl_b32 s73, s20, 10
  s_add_u32 s73, s73, 49152
  v_lshlrev_b32 v3, 1, v36
  s_lshr_b32 s45, s20, 1
  s_mul_i32 s45, s45, 1280
  s_and_b32 s46, s20, 1
  s_lshl_b32 s46, s46, 2
  s_add_u32 s45, s45, s46
  v_and_b32 v1, 15, v36
  v_lshlrev_b32 v4, 5, v1
  v_and_b32 v1, 15, v36
  v_lshl_add_u32 v4, v1, 3, v4
  v_and_b32 v1, 48, v36
  v_lshrrev_b32 v1, 1, v1
  v_lshl_add_u32 v4, v1, 0, v4
  v_add_u32 v4, s45, v4
  s_lshl_b32 s45, s20, 10
  s_add_u32 s45, s45, 8192
  v_and_b32 v1, 1, v36
  v_lshlrev_b32 v5, 2, v1
  v_and_b32 v1, 2, v36
  v_lshl_add_u32 v5, v1, 4, v5
  v_and_b32 v1, 12, v36
  v_lshl_add_u32 v5, v1, 1, v5
  v_and_b32 v1, 16, v36
  v_lshl_add_u32 v5, v1, 4, v5
  v_and_b32 v1, 32, v36
  v_lshl_add_u32 v5, v1, 2, v5
  v_add_u32 v5, s45, v5
  s_lshl_b32 s45, s20, 8
  s_add_u32 s45, s45, 8192
  v_and_b32 v1, 63, v36
  v_lshlrev_b32 v6, 2, v1
  v_add_u32 v6, s45, v6
  v_and_b32 v1, 3, v36
  v_lshlrev_b32 v8, 2, v1
  v_add_u32 v8, 24576, v8
  s_mov_b32 s45, 24608
  v_writelane_b32 v8, s45, 63
  v_and_b32 v1, 2, v36
  v_cmp_eq_u32 vcc, 0, v1
  v_mov_b32 v1, 0xeeeeeeee
  v_mov_b32 v12, 0x44444444
  v_cndmask_b32 v7, v1, v12, vcc
  v_mov_b32 v10, -1
  v_mov_b32 v11, -1
  v_mov_b32 v255, 0x3e0293ee
  v_and_b32 v1, 1, v36
  v_lshlrev_b32 v12, 4, v1
  v_mov_b32 v1, 0x3f80
  v_lshlrev_b32 v12, v12, v1
  v_and_b32 v1, 14, v36
  v_cmp_eq_u32 vcc, 0, v1
  s_nop 1
  v_cndmask_b32 v16, 0, v12, vcc
  v_cmp_eq_u32 vcc, 4, v1
  s_nop 1
  v_cndmask_b32 v17, 0, v12, vcc
  v_cmp_eq_u32 vcc, 8, v1
  s_nop 1
  v_cndmask_b32 v18, 0, v12, vcc
  v_cmp_eq_u32 vcc, 12, v1
  s_nop 1
  v_cndmask_b32 v19, 0, v12, vcc
  s_lshl_b32 s58, s21, 15
  s_lshl_b32 s45, s20, 13
  s_add_u32 s58, s58, s45
  s_add_u32 s58, s58, 33554432
  s_lshl_b32 s59, s20, 13
  s_add_u32 s59, s59, 65536
  s_mov_b32 s40, 0
  s_mov_b32 s43, 400000
  s_mov_b32 s57, s55
  s_mov_b32 s70, s69
  s_lshl_b32 s61, s21, 11
  s_add_u32 s61, s61, 124813312
  s_lshl_b32 s63, s22, 10
  s_lshl_b32 s45, s21, 7
  s_add_u32 s63, s63, s45
  s_add_u32 s63, s63, 124796928
  s_mov_b32 s62, 0
  s_lshl_b32 s45, s21, 15
  s_lshl_b32 s46, s22, 11
  s_add_u32 s45, s45, s46
  s_lshl_b32 s46, s20, 9
  s_add_u32 s45, s45, s46
  v_and_b32 v1, 3, v36
  v_lshlrev_b32 v252, 7, v1
  v_and_b32 v1, 12, v36
  v_lshl_add_u32 v252, v1, 22, v252
  v_add_u32 v252, s45, v252
  s_lshl_b32 s45, s21, 13
  s_lshl_b32 s46, s22, 9
  s_add_u32 s45, s45, s46
  s_lshl_b32 s46, s20, 7
  s_add_u32 s45, s45, s46
  s_add_u32 s45, s45, 134217728
  v_mov_b32 v1, s45
  v_cmp_eq_u32 vcc, 12, v36
  s_nop 1
  v_cndmask_b32 v252, v252, v1, vcc
  v_mov_b32 v1, 0x80000000
  v_cmp_lt_u32 vcc, 12, v36
  s_nop 1
  v_cndmask_b32 v252, v252, v1, vcc
  s_mov_b32 s64, 262144
  s_mov_b32 s50, 1048576
  v_and_b32 v1, 1, v36
  v_lshlrev_b32 v41, 11, v1
  v_and_b32 v1, 12, v36
  v_lshl_add_u32 v41, v1, 10, v41
  v_and_b32 v1, 2, v36
  v_lshl_add_u32 v41, v1, 1, v41
  v_and_b32 v1, 48, v36
  v_lshl_add_u32 v41, v1, 1, v41
  s_add_u32 s46, s49, s60
  s_add_u32 s44, s67, 262144
  buffer_store_dword v10, v9, s[24:27], s44 offen sc1
  s_add_u32 s45, s71, 262144
  buffer_store_dwordx2 v[10:11], v0, s[24:27], s45 offen sc1
  s_add_u32 s46, s46, 262144
  s_add_u32 s47, s46, 8192
  buffer_store_dword v10, v14, s[24:27], s46 offen sc1
  buffer_store_dword v10, v14, s[24:27], s47 offen sc1
  s_add_u32 s44, s67, 524288
  buffer_store_dword v10, v9, s[24:27], s44 offen sc1
  s_add_u32 s45, s71, 524288
  buffer_store_dwordx2 v[10:11], v0, s[24:27], s45 offen sc1
  s_add_u32 s46, s46, 262144
  s_add_u32 s47, s46, 8192
  buffer_store_dword v10, v14, s[24:27], s46 offen sc1
  buffer_store_dword v10, v14, s[24:27], s47 offen sc1
  s_add_u32 s44, s67, 786432
  buffer_store_dword v10, v9, s[24:27], s44 offen sc1
  s_add_u32 s45, s71, 786432
  buffer_store_dwordx2 v[10:11], v0, s[24:27], s45 offen sc1
  s_add_u32 s46, s46, 262144
  s_add_u32 s47, s46, 8192
  buffer_store_dword v10, v14, s[24:27], s46 offen sc1
  buffer_store_dword v10, v14, s[24:27], s47 offen sc1
  s_add_u32 s44, s67, 0
  buffer_store_dword v10, v9, s[24:27], s44 offen sc1
  s_add_u32 m0, s42, 12288
  s_mov_b32 s46, 524288
  buffer_load_dwordx4 v38, s[28:31], s46 offen lds
  s_add_u32 m0, s42, 13312
  s_mov_b32 s46, 655360
  buffer_load_dwordx4 v38, s[28:31], s46 offen lds
  s_add_u32 m0, s42, 14336
  s_mov_b32 s46, 786432
  buffer_load_dwordx4 v38, s[28:31], s46 offen lds
  s_add_u32 m0, s42, 15360
  s_mov_b32 s46, 917504
  buffer_load_dwordx4 v38, s[28:31], s46 offen lds
  s_add_u32 m0, s42, 16384
  s_mov_b32 s46, 524288
  buffer_load_dwordx4 v38, s[32:35], s46 offen lds
  s_add_u32 m0, s42, 17408
  s_mov_b32 s46, 655360
  buffer_load_dwordx4 v38, s[32:35], s46 offen lds
  s_add_u32 m0, s42, 18432
  s_mov_b32 s46, 786432
  buffer_load_dwordx4 v38, s[32:35], s46 offen lds
  s_add_u32 m0, s42, 19456
  s_mov_b32 s46, 917504
  buffer_load_dwordx4 v38, s[32:35], s46 offen lds
  s_add_u32 m0, s42, 20480
  s_mov_b32 s46, 524288
  buffer_load_dwordx4 v38, s[36:39], s46 offen lds
  s_add_u32 m0, s42, 21504
  s_mov_b32 s46, 655360
  buffer_load_dwordx4 v38, s[36:39], s46 offen lds
  s_add_u32 m0, s42, 22528
  s_mov_b32 s46, 786432
  buffer_load_dwordx4 v38, s[36:39], s46 offen lds
  s_add_u32 m0, s42, 23552
  s_mov_b32 s46, 917504
  buffer_load_dwordx4 v38, s[36:39], s46 offen lds
  s_lshl_b32 s45, s20, 9
  buffer_load_dword v20, v41, s[80:83], s45 offen offset:0
  buffer_load_dword v21, v41, s[80:83], s45 offen offset:8
  buffer_load_dword v22, v41, s[80:83], s45 offen offset:16
  buffer_load_dword v23, v41, s[80:83], s45 offen offset:24
  buffer_load_dword v24, v41, s[80:83], s45 offen offset:128
  buffer_load_dword v25, v41, s[80:83], s45 offen offset:136
  buffer_load_dword v26, v41, s[80:83], s45 offen offset:144
  buffer_load_dword v27, v41, s[80:83], s45 offen offset:152
  buffer_load_dword v28, v41, s[80:83], s45 offen offset:256
  buffer_load_dword v29, v41, s[80:83], s45 offen offset:264
  buffer_load_dword v30, v41, s[80:83], s45 offen offset:272
  buffer_load_dword v31, v41, s[80:83], s45 offen offset:280
  buffer_load_dword v32, v41, s[80:83], s45 offen offset:384
  buffer_load_dword v33, v41, s[80:83], s45 offen offset:392
  buffer_load_dword v34, v41, s[80:83], s45 offen offset:400
  buffer_load_dword v35, v41, s[80:83], s45 offen offset:408
  s_waitcnt vmcnt(41)
  ds_read_b64_tr_b16 v[60:61], v37 offset:0
  ds_read_b64_tr_b16 v[62:63], v37 offset:256
  ds_read_b64_tr_b16 v[64:65], v37 offset:2048
  ds_read_b64_tr_b16 v[66:67], v37 offset:2304
  ds_read_b64_tr_b16 v[92:93], v37 offset:32
  ds_read_b64_tr_b16 v[94:95], v37 offset:288
  ds_read_b64_tr_b16 v[96:97], v37 offset:2080
  ds_read_b64_tr_b16 v[98:99], v37 offset:2336
  ds_read_b64_tr_b16 v[124:125], v37 offset:4096
  ds_read_b64_tr_b16 v[126:127], v37 offset:4352
  ds_read_b64_tr_b16 v[128:129], v37 offset:6144
  ds_read_b64_tr_b16 v[130:131], v37 offset:6400
  s_waitcnt lgkmcnt(0)
  ds_read_b64_tr_b16 v[156:157], v37 offset:4128
  ds_read_b64_tr_b16 v[158:159], v37 offset:4384
  ds_read_b64_tr_b16 v[160:161], v37 offset:6176
  ds_read_b64_tr_b16 v[162:163], v37 offset:6432
  ds_read_b64_tr_b16 v[188:189], v37 offset:8192
  ds_read_b64_tr_b16 v[190:191], v37 offset:8448
  ds_read_b64_tr_b16 v[192:193], v37 offset:10240
  ds_read_b64_tr_b16 v[194:195], v37 offset:10496
  ds_read_b64_tr_b16 v[220:221], v37 offset:8224
  ds_read_b64_tr_b16 v[222:223], v37 offset:8480
  ds_read_b64_tr_b16 v[224:225], v37 offset:10272
  ds_read_b64_tr_b16 v[226:227], v37 offset:10528
  s_waitcnt lgkmcnt(0)
  s_add_u32 m0, s42, 0
  s_mov_b32 s46, 1048576
  buffer_load_dwordx4 v38, s[28:31], s46 offen lds
  s_add_u32 m0, s42, 1024
  s_mov_b32 s46, 1179648
  buffer_load_dwordx4 v38, s[28:31], s46 offen lds
  s_add_u32 m0, s42, 2048
  s_mov_b32 s46, 1310720
  buffer_load_dwordx4 v38, s[28:31], s46 offen lds
  s_add_u32 m0, s42, 3072
  s_mov_b32 s46, 1441792
  buffer_load_dwordx4 v38, s[28:31], s46 offen lds
  s_add_u32 m0, s42, 4096
  s_mov_b32 s46, 1048576
  buffer_load_dwordx4 v38, s[32:35], s46 offen lds
  s_add_u32 m0, s42, 5120
  s_mov_b32 s46, 1179648
  buffer_load_dwordx4 v38, s[32:35], s46 offen lds
  s_add_u32 m0, s42, 6144
  s_mov_b32 s46, 1310720
  buffer_load_dwordx4 v38, s[32:35], s46 offen lds
  s_add_u32 m0, s42, 7168
  s_mov_b32 s46, 1441792
  buffer_load_dwordx4 v38, s[32:35], s46 offen lds
  s_add_u32 m0, s42, 8192
  s_mov_b32 s46, 1048576
  buffer_load_dwordx4 v38, s[36:39], s46 offen lds
  s_add_u32 m0, s42, 9216
  s_mov_b32 s46, 1179648
  buffer_load_dwordx4 v38, s[36:39], s46 offen lds
  s_add_u32 m0, s42, 10240
  s_mov_b32 s46, 1310720
  buffer_load_dwordx4 v38, s[36:39], s46 offen lds
  s_add_u32 m0, s42, 11264
  s_mov_b32 s46, 1441792
  buffer_load_dwordx4 v38, s[36:39], s46 offen lds
  s_waitcnt vmcnt(12)
  ds_read_b64_tr_b16 v[68:69], v37 offset:12288
  ds_read_b64_tr_b16 v[70:71], v37 offset:12544
  ds_read_b64_tr_b16 v[72:73], v37 offset:14336
  ds_read_b64_tr_b16 v[74:75], v37 offset:14592
  ds_read_b64_tr_b16 v[100:101], v37 offset:12320
  ds_read_b64_tr_b16 v[102:103], v37 offset:12576
  ds_read_b64_tr_b16 v[104:105], v37 offset:14368
  ds_read_b64_tr_b16 v[106:107], v37 offset:14624
  ds_read_b64_tr_b16 v[132:133], v37 offset:16384
  ds_read_b64_tr_b16 v[134:135], v37 offset:16640
  ds_read_b64_tr_b16 v[136:137], v37 offset:18432
  ds_read_b64_tr_b16 v[138:139], v37 offset:18688
  s_waitcnt lgkmcnt(0)
  ds_read_b64_tr_b16 v[164:165], v37 offset:16416
  ds_read_b64_tr_b16 v[166:167], v37 offset:16672
  ds_read_b64_tr_b16 v[168:169], v37 offset:18464
  ds_read_b64_tr_b16 v[170:171], v37 offset:18720
  ds_read_b64_tr_b16 v[196:197], v37 offset:20480
  ds_read_b64_tr_b16 v[198:199], v37 offset:20736
  ds_read_b64_tr_b16 v[200:201], v37 offset:22528
  ds_read_b64_tr_b16 v[202:203], v37 offset:22784
  ds_read_b64_tr_b16 v[228:229], v37 offset:20512
  ds_read_b64_tr_b16 v[230:231], v37 offset:20768
  ds_read_b64_tr_b16 v[232:233], v37 offset:22560
  ds_read_b64_tr_b16 v[234:235], v37 offset:22816
  s_waitcnt lgkmcnt(0)
  s_add_u32 m0, s42, 12288
  s_mov_b32 s46, 1572864
  buffer_load_dwordx4 v38, s[28:31], s46 offen lds
  s_add_u32 m0, s42, 13312
  s_mov_b32 s46, 1703936
  buffer_load_dwordx4 v38, s[28:31], s46 offen lds
  s_add_u32 m0, s42, 14336
  s_mov_b32 s46, 1835008
  buffer_load_dwordx4 v38, s[28:31], s46 offen lds
  s_add_u32 m0, s42, 15360
  s_mov_b32 s46, 1966080
  buffer_load_dwordx4 v38, s[28:31], s46 offen lds
  s_add_u32 m0, s42, 16384
  s_mov_b32 s46, 1572864
  buffer_load_dwordx4 v38, s[32:35], s46 offen lds
  s_add_u32 m0, s42, 17408
  s_mov_b32 s46, 1703936
  buffer_load_dwordx4 v38, s[32:35], s46 offen lds
  s_add_u32 m0, s42, 18432
  s_mov_b32 s46, 1835008
  buffer_load_dwordx4 v38, s[32:35], s46 offen lds
  s_add_u32 m0, s42, 19456
  s_mov_b32 s46, 1966080
  buffer_load_dwordx4 v38, s[32:35], s46 offen lds
  s_add_u32 m0, s42, 20480
  s_mov_b32 s46, 1572864
  buffer_load_dwordx4 v38, s[36:39], s46 offen lds
  s_add_u32 m0, s42, 21504
  s_mov_b32 s46, 1703936
  buffer_load_dwordx4 v38, s[36:39], s46 offen lds
  s_add_u32 m0, s42, 22528
  s_mov_b32 s46, 1835008
  buffer_load_dwordx4 v38, s[36:39], s46 offen lds
  s_add_u32 m0, s42, 23552
  s_mov_b32 s46, 1966080
  buffer_load_dwordx4 v38, s[36:39], s46 offen lds
  s_barrier
  s_waitcnt vmcnt(12)
  ds_read_b64_tr_b16 v[76:77], v37 offset:0
  ds_read_b64_tr_b16 v[78:79], v37 offset:256
  ds_read_b64_tr_b16 v[80:81], v37 offset:2048
  ds_read_b64_tr_b16 v[82:83], v37 offset:2304
  ds_read_b64_tr_b16 v[108:109], v37 offset:32
  ds_read_b64_tr_b16 v[110:111], v37 offset:288
  ds_read_b64_tr_b16 v[112:113], v37 offset:2080
  ds_read_b64_tr_b16 v[114:115], v37 offset:2336
  ds_read_b64_tr_b16 v[140:141], v37 offset:4096
  ds_read_b64_tr_b16 v[142:143], v37 offset:4352
  ds_read_b64_tr_b16 v[144:145], v37 offset:6144
  ds_read_b64_tr_b16 v[146:147], v37 offset:6400
  s_waitcnt lgkmcnt(0)
  ds_read_b64_tr_b16 v[172:173], v37 offset:4128
  ds_read_b64_tr_b16 v[174:175], v37 offset:4384
  ds_read_b64_tr_b16 v[176:177], v37 offset:6176
  ds_read_b64_tr_b16 v[178:179], v37 offset:6432
  ds_read_b64_tr_b16 v[204:205], v37 offset:8192
  ds_read_b64_tr_b16 v[206:207], v37 offset:8448
  ds_read_b64_tr_b16 v[208:209], v37 offset:10240
  ds_read_b64_tr_b16 v[210:211], v37 offset:10496
  ds_read_b64_tr_b16 v[236:237], v37 offset:8224
  ds_read_b64_tr_b16 v[238:239], v37 offset:8480
  ds_read_b64_tr_b16 v[240:241], v37 offset:10272
  ds_read_b64_tr_b16 v[242:243], v37 offset:10528
  s_waitcnt lgkmcnt(0)
  s_waitcnt vmcnt(0)
  ds_read_b64_tr_b16 v[84:85], v37 offset:12288
  ds_read_b64_tr_b16 v[86:87], v37 offset:12544
  ds_read_b64_tr_b16 v[88:89], v37 offset:14336
  ds_read_b64_tr_b16 v[90:91], v37 offset:14592
  ds_read_b64_tr_b16 v[116:117], v37 offset:12320
  ds_read_b64_tr_b16 v[118:119], v37 offset:12576
  ds_read_b64_tr_b16 v[120:121], v37 offset:14368
  ds_read_b64_tr_b16 v[122:123], v37 offset:14624
  ds_read_b64_tr_b16 v[148:149], v37 offset:16384
  ds_read_b64_tr_b16 v[150:151], v37 offset:16640
  ds_read_b64_tr_b16 v[152:153], v37 offset:18432
  ds_read_b64_tr_b16 v[154:155], v37 offset:18688
  s_waitcnt lgkmcnt(0)
  ds_read_b64_tr_b16 v[180:181], v37 offset:16416
  ds_read_b64_tr_b16 v[182:183], v37 offset:16672
  ds_read_b64_tr_b16 v[184:185], v37 offset:18464
  ds_read_b64_tr_b16 v[186:187], v37 offset:18720
  ds_read_b64_tr_b16 v[212:213], v37 offset:20480
  ds_read_b64_tr_b16 v[214:215], v37 offset:20736
  ds_read_b64_tr_b16 v[216:217], v37 offset:22528
  ds_read_b64_tr_b16 v[218:219], v37 offset:22784
  ds_read_b64_tr_b16 v[244:245], v37 offset:20512
  ds_read_b64_tr_b16 v[246:247], v37 offset:20768
  ds_read_b64_tr_b16 v[248:249], v37 offset:22560
  ds_read_b64_tr_b16 v[250:251], v37 offset:22816
  s_waitcnt lgkmcnt(0)
b_wo_3x:
  s_cmp_lg_u32 s20, 1
  s_cbranch_scc1 b_wo_3y
  v_and_b32 v1, 15, v36
  v_lshlrev_b32 v42, 7, v1
  v_and_b32 v1, 48, v36
  v_lshl_add_u32 v42, v1, 14, v42
  s_sub_u32 s44, s71, 512
  buffer_load_dword v253, v42, s[24:27], s44 offen sc1
  v_and_b32 v1, 3, v36
  v_lshlrev_b32 v42, 8, v1
  v_and_b32 v1, 48, v36
  v_lshl_add_u32 v42, v1, 14, v42
  s_sub_u32 s44, s67, 256
  buffer_load_dword v253, v42, s[24:27], s44 offen sc1
  s_add_u32 s44, s72, 65536
  buffer_load_dword v253, off, s[24:27], s44
b_wo_3y:
  s_bitset1_b32 s72, 30
  s_load_dwordx2 s[32:33], s[0:1], 104
  s_mov_b32 s41, 0
  s_mov_b32 s42, 524288
  v_mov_b32 v36, 0
  v_mov_b32 v37, 0
  v_mov_b32 v38, 0
  v_mov_b32 v39, 0
  v_mov_b32 v40, 0
  v_mov_b32 v41, 0
  v_mov_b32 v42, 0
  v_mov_b32 v43, 0
  v_mov_b32 v44, 0
  v_mov_b32 v45, 0
  v_mov_b32 v46, 0
  v_mov_b32 v47, 0
  v_mov_b32 v48, 0
  v_mov_b32 v49, 0
  v_mov_b32 v50, 0
  v_mov_b32 v51, 0
  v_mov_b32 v52, 0
  v_mov_b32 v53, 0
  v_mov_b32 v54, 0
  v_mov_b32 v55, 0
  v_mov_b32 v56, 0
  v_mov_b32 v57, 0
  v_mov_b32 v58, 0
  v_mov_b32 v59, 0
  s_waitcnt lgkmcnt(0)
  s_and_b32 s33, s33, 0xffff
  s_mov_b32 s34, 4194304
  s_mov_b32 s35, 0x20000
  s_lshl_b32 s65, s22, 7
  s_add_u32 s65, s65, 124780544
  s_mov_b32 s66, 0
  v_mov_b32 v1, 0
  s_cmp_lg_u32 s20, 0
  s_cbranch_scc1 b_gp_4
  s_getreg_b32 s44, hwreg(HW_REG_XCC_ID)
  s_and_b32 s44, s44, 7
  s_mul_i32 s45, s44, s44
  s_lshl_b32 s44, s44, 17
  s_lshl_b32 s45, s45, 25
  s_add_u32 s44, s44, s45
  s_add_u32 s44, s44, 32
gp_5:
  s_buffer_load_dwordx8 s[80:87], s[8:11], 32 glc
  s_sub_u32 s43, s43, 1
  s_cbranch_scc1 fused_kernel_fin
  s_waitcnt lgkmcnt(0)
  s_and_b32 s45, s80, s82
  s_and_b32 s46, s84, s86
  s_and_b32 s45, s45, s46
  s_bitcmp1_b32 s45, 5
  s_cbranch_scc1 gp_5x
  s_sleep 8
  s_branch gp_5
gp_5x:
  s_add_u32 s45, s81, s83
  s_add_u32 s46, s85, s87
  s_add_u32 s45, s45, s46
  s_cmp_gt_i32 s45, 0
  s_cselect_b32 s46, 8192, 0
  s_cmp_eq_u32 s6, 1
  s_cselect_b32 s80, s82, s80
  s_cmp_eq_u32 s6, 2
  s_cselect_b32 s80, s84, s80
  s_cmp_eq_u32 s6, 3
  s_cselect_b32 s80, s86, s80
  s_cmp_lg_u32 s80, s44
  s_addc_u32 s46, s46, 0
  v_mov_b32 v12, s46
  ds_write_b32 v1, v12
b_gp_4r:
  s_sleep 10
  s_buffer_load_dword s44, s[24:27], s61 glc
  s_sub_u32 s43, s43, 1
  s_cbranch_scc1 fused_kernel_fin
  s_waitcnt lgkmcnt(0)
  s_cmp_lt_u32 s44, 12
  s_cbranch_scc1 b_gp_4r
  s_mov_b32 s43, 400000
b_gp_4:
  s_add_u32 s61, s61, 128
  s_barrier
  ds_read_b32 v1, v1
  s_mov_b32 m0, s59
  s_nop 0
  buffer_load_dwordx4 v2, s[24:27], s58 offen offset:0 lds
  buffer_load_dwordx4 v2, s[24:27], s58 offen offset:1024 lds
  buffer_load_dwordx4 v2, s[24:27], s58 offen offset:2048 lds
  buffer_load_dwordx4 v2, s[24:27], s58 offen offset:3072 lds
  s_add_u32 m0, s59, 4096
  s_add_u32 s58, s58, 4096
  buffer_load_dwordx4 v2, s[24:27], s58 offen offset:0 lds
  buffer_load_dwordx4 v2, s[24:27], s58 offen offset:1024 lds
  buffer_load_dwordx4 v2, s[24:27], s58 offen offset:2048 lds
  buffer_load_dwordx4 v2, s[24:27], s58 offen offset:3072 lds
  s_add_u32 s58, s58, 258048
  s_xor_b32 s59, s59, 32768
  buffer_load_dword v253, v252, s[24:27], s64 offen
  s_add_u32 s64, s64, 262144
  buffer_load_dword v253, v252, s[24:27], s64 offen
  s_add_u32 s64, s64, 262144
  s_waitcnt lgkmcnt(0)
  v_readfirstlane_b32 s23, v1
  s_nop 0
  s_and_b32 s44, s23, 8192
  s_and_b32 s23, s23, 1
  s_add_u32 s60, s60, s44
  s_add_u32 s54, s54, s60
  s_add_u32 s49, s49, s60
  s_waitcnt vmcnt(2)
  s_barrier
  s_mov_b32 m0, s59
  s_nop 0
  buffer_load_dwordx4 v2, s[24:27], s58 offen offset:0 lds
  buffer_load_dwordx4 v2, s[24:27], s58 offen offset:1024 lds
  buffer_load_dwordx4 v2, s[24:27], s58 offen offset:2048 lds
  buffer_load_dwordx4 v2, s[24:27], s58 offen offset:3072 lds
  s_add_u32 m0, s59, 4096
  s_add_u32 s58, s58, 4096
  s_cmp_lg_u32 s20, 0
  s_cbranch_scc1 b_r1_6
  s_buffer_load_dword s62, s[24:27], s61 glc
b_r1_6:
  s_cmp_eq_u32 s23, 0
  s_cbranch_scc1 b_ent0_7
  s_branch b_ent1_8
b_top_10:
  s_cmp_lg_u32 s40, 63
  s_cbranch_scc1 b_top_10n
  s_buffer_load_dword s66, s[24:27], s65 glc
b_top_10n:
  s_sleep 3
  s_cbranch_vccnz b_pg_20
b_pg2_21:
  s_sleep 7
  s_setprio 2
  buffer_load_dwordx4 v[24:27], v2, s[24:27], s56 offen sc1
  s_sleep 2
  s_mov_b32 m0, s59
  s_nop 0
  buffer_load_dwordx4 v2, s[24:27], s58 offen offset:0 lds
  buffer_load_dwordx4 v2, s[24:27], s58 offen offset:1024 lds
  buffer_load_dwordx4 v2, s[24:27], s58 offen offset:2048 lds
  buffer_load_dwordx4 v2, s[24:27], s58 offen offset:3072 lds
  s_add_u32 m0, s59, 4096
  s_add_u32 s58, s58, 4096
  buffer_store_dword v10, v9, s[24:27], s44 offen
  buffer_store_dwordx2 v[10:11], v0, s[24:27], s45 offen
  s_waitcnt vmcnt(6)
  v_mfma_f32_16x16x32_bf16 v[28:31], v[16:19], v[24:27], 0
  s_nop 7
  v_add_f32_dpp v28, v28, v28 row_ror:8 row_mask:0xf bank_mask:0xf
  v_add_f32_dpp v29, v29, v29 row_ror:8 row_mask:0xf bank_mask:0xf
  v_cmp_u_f32 vcc, v28, v28
  v_cvt_pk_bf16_f32 v12, v28, v29
  s_cbranch_vccnz b_pa_11
b_pa_11x:
  buffer_store_dword v12, v9, s[24:27], s68 offen
b_pa_11y:
  s_sleep 3
b_pa_11z:
  buffer_load_dwordx4 v[20:23], v2, s[24:27], s57 offen offset:0 sc1
  buffer_load_dwordx4 v[24:27], v2, s[24:27], s57 offen offset:1024 sc1
  buffer_load_dwordx4 v[28:31], v2, s[24:27], s57 offen offset:2048 sc1
  buffer_load_dwordx4 v[32:35], v2, s[24:27], s57 offen offset:3072 sc1
  s_waitcnt vmcnt(3)
  v_cmp_u_f32 vcc, v20, v23
  s_cbranch_vccnz m_22_p0_0
b_ent0_7:
m_22_s0_0:
  v_smfmac_f32_16x16x64_bf16 v[36:39], v[20:23], v[60:67], v7
  v_smfmac_f32_16x16x64_bf16 v[40:43], v[20:23], v[92:99], v7
  v_smfmac_f32_16x16x64_bf16 v[44:47], v[20:23], v[124:131], v7
  s_waitcnt vmcnt(2)
  v_cmp_u_f32 vcc, v24, v27
  v_smfmac_f32_16x16x64_bf16 v[48:51], v[20:23], v[156:163], v7
  s_cbranch_vccnz m_22_p0_1
m_22_s0_1:
  v_smfmac_f32_16x16x64_bf16 v[36:39], v[24:27], v[68:75], v7
  v_smfmac_f32_16x16x64_bf16 v[40:43], v[24:27], v[100:107], v7
  v_smfmac_f32_16x16x64_bf16 v[44:47], v[24:27], v[132:139], v7
  s_waitcnt vmcnt(1)
  v_cmp_u_f32 vcc, v28, v31
  v_smfmac_f32_16x16x64_bf16 v[48:51], v[24:27], v[164:171], v7
  s_cbranch_vccnz m_22_p0_2
m_22_s0_2:
  v_smfmac_f32_16x16x64_bf16 v[36:39], v[28:31], v[76:83], v7
  v_smfmac_f32_16x16x64_bf16 v[40:43], v[28:31], v[108:115], v7
  v_smfmac_f32_16x16x64_bf16 v[44:47], v[28:31], v[140:147], v7
  s_waitcnt vmcnt(0)
  v_cmp_u_f32 vcc, v32, v35
  v_smfmac_f32_16x16x64_bf16 v[48:51], v[28:31], v[172:179], v7
  s_cbranch_vccnz m_22_p0_3
m_22_s0_3:
  v_smfmac_f32_16x16x64_bf16 v[36:39], v[32:35], v[84:91], v7
  buffer_load_dwordx4 v2, s[24:27], s58 offen offset:0 lds
  v_smfmac_f32_16x16x64_bf16 v[40:43], v[32:35], v[116:123], v7
  buffer_load_dwordx4 v2, s[24:27], s58 offen offset:1024 lds
  v_smfmac_f32_16x16x64_bf16 v[44:47], v[32:35], v[148:155], v7
  v_smfmac_f32_16x16x64_bf16 v[48:51], v[32:35], v[180:187], v7
  v_smfmac_f32_16x16x64_bf16 v[52:55], v[20:23], v[188:195], v7
  s_nop 1
  v_add_f32 v36, v36, v38
  v_add_f32 v37, v37, v39
  v_cvt_pk_bf16_f32 v38, v36, v37
  v_smfmac_f32_16x16x64_bf16 v[56:59], v[20:23], v[220:227], v7
  ds_write_b32 v4, v38 offset:0
  v_add_f32 v40, v40, v42
  v_add_f32 v41, v41, v43
  v_smfmac_f32_16x16x64_bf16 v[52:55], v[24:27], v[196:203], v7
  v_cvt_pk_bf16_f32 v42, v40, v41
  ds_write_b32 v4, v42 offset:640
  v_add_f32 v44, v44, v46
  v_smfmac_f32_16x16x64_bf16 v[56:59], v[24:27], v[228:235], v7
  v_add_f32 v45, v45, v47
  v_cvt_pk_bf16_f32 v46, v44, v45
  ds_write_b32 v4, v46 offset:2560
  v_smfmac_f32_16x16x64_bf16 v[52:55], v[28:31], v[204:211], v7
  v_add_f32 v48, v48, v50
  v_add_f32 v49, v49, v51
  v_cvt_pk_bf16_f32 v50, v48, v49
  v_smfmac_f32_16x16x64_bf16 v[56:59], v[28:31], v[236:243], v7
  ds_write_b32 v4, v50 offset:3200
  v_smfmac_f32_16x16x64_bf16 v[52:55], v[32:35], v[212:219], v7
  v_smfmac_f32_16x16x64_bf16 v[56:59], v[32:35], v[244:251], v7
  buffer_load_dwordx4 v2, s[24:27], s58 offen offset:2048 lds
  buffer_load_dwordx4 v2, s[24:27], s58 offen offset:3072 lds
  s_nop 4
  v_add_f32 v52, v52, v54
  v_add_f32 v53, v53, v55
  ds_write2_b32 v5, v52, v53 offset0:0 offset1:16
  v_add_f32 v56, v56, v58
  v_add_f32 v57, v57, v59
  ds_write2_b32 v5, v56, v57 offset0:128 offset1:144
b_post_13:
  s_waitcnt lgkmcnt(0)
  s_barrier
  ds_read2st64_b32 v[20:21], v6 offset0:0 offset1:4
  ds_read2st64_b32 v[22:23], v6 offset0:8 offset1:12
  s_add_u32 s40, s40, 1
  s_waitcnt lgkmcnt(1)
  v_add_f32 v20, v20, v21
  s_waitcnt lgkmcnt(0)
  v_add_f32 v22, v22, v23
  v_add_f32 v20, v20, v22
  v_cvt_pk_bf16_f32 v12, v20, v20
  buffer_store_short v12, v3, s[24:27], s70 offen
  s_setprio 0
  ds_read_b32 v254, v8
  v_add_u32 v1, s73, v2
  s_lshr_b32 s44, s73, 3
  s_and_b32 s44, s44, 2048
  v_add_u32 v13, s44, v0
  s_xor_b32 s73, s73, 16384
  ds_read_b128 v[20:23], v1 offset:0
  ds_read_b64 v[44:45], v13 offset:28672
  ds_read_b128 v[24:27], v1 offset:4096
  ds_read_b64 v[46:47], v13 offset:29184
  ds_read_b128 v[28:31], v1 offset:8192
  ds_read_b64 v[48:49], v13 offset:29696
  ds_read_b128 v[32:35], v1 offset:12288
  ds_read_b64 v[50:51], v13 offset:30208
  s_waitcnt lgkmcnt(6)
  v_lshlrev_b32 v52, 16, v20
  v_and_b32 v20, 0xffff0000, v20
  v_lshlrev_b32 v53, 16, v21
  v_and_b32 v21, 0xffff0000, v21
  v_lshlrev_b32 v54, 16, v22
  v_and_b32 v22, 0xffff0000, v22
  v_lshlrev_b32 v55, 16, v23
  v_and_b32 v23, 0xffff0000, v23
  v_mul_f32 v36, v52, v44
  v_mul_f32 v37, v20, v44
  v_mul_f32 v38, v53, v44
  v_mul_f32 v39, v21, v44
  v_mul_f32 v40, v54, v45
  v_mul_f32 v41, v22, v45
  v_mul_f32 v42, v55, v45
  v_mul_f32 v43, v23, v45
  s_waitcnt lgkmcnt(4)
  v_lshlrev_b32 v52, 16, v24
  v_and_b32 v24, 0xffff0000, v24
  v_lshlrev_b32 v53, 16, v25
  v_and_b32 v25, 0xffff0000, v25
  v_lshlrev_b32 v54, 16, v26
  v_and_b32 v26, 0xffff0000, v26
  v_lshlrev_b32 v55, 16, v27
  v_and_b32 v27, 0xffff0000, v27
  v_fmac_f32 v36, v52, v46
  v_fmac_f32 v37, v24, v46
  v_fmac_f32 v38, v53, v46
  v_fmac_f32 v39, v25, v46
  v_fmac_f32 v40, v54, v47
  v_fmac_f32 v41, v26, v47
  v_fmac_f32 v42, v55, v47
  v_fmac_f32 v43, v27, v47
  s_waitcnt lgkmcnt(2)
  v_lshlrev_b32 v52, 16, v28
  v_and_b32 v28, 0xffff0000, v28
  v_lshlrev_b32 v53, 16, v29
  v_and_b32 v29, 0xffff0000, v29
  v_lshlrev_b32 v54, 16, v30
  v_and_b32 v30, 0xffff0000, v30
  v_lshlrev_b32 v55, 16, v31
  v_and_b32 v31, 0xffff0000, v31
  v_fmac_f32 v36, v52, v48
  v_fmac_f32 v37, v28, v48
  v_fmac_f32 v38, v53, v48
  v_fmac_f32 v39, v29, v48
  v_fmac_f32 v40, v54, v49
  v_fmac_f32 v41, v30, v49
  v_fmac_f32 v42, v55, v49
  v_fmac_f32 v43, v31, v49
  s_waitcnt lgkmcnt(0)
  v_lshlrev_b32 v52, 16, v32
  v_and_b32 v32, 0xffff0000, v32
  v_lshlrev_b32 v53, 16, v33
  v_and_b32 v33, 0xffff0000, v33
  v_lshlrev_b32 v54, 16, v34
  v_and_b32 v34, 0xffff0000, v34
  v_lshlrev_b32 v55, 16, v35
  v_and_b32 v35, 0xffff0000, v35
  v_fmac_f32 v36, v52, v50
  v_fmac_f32 v37, v32, v50
  v_fmac_f32 v38, v53, v50
  v_fmac_f32 v39, v33, v50
  v_fmac_f32 v40, v54, v51
  v_fmac_f32 v41, v34, v51
  v_fmac_f32 v42, v55, v51
  v_fmac_f32 v43, v35, v51
  v_cvt_pk_bf16_f32 v20, v36, v37
  v_cvt_pk_bf16_f32 v21, v38, v39
  v_cvt_pk_bf16_f32 v22, v40, v41
  v_cvt_pk_bf16_f32 v23, v42, v43
  v_mov_b32 v36, 0
  v_mov_b32 v37, 0
  v_mov_b32 v38, 0
  v_mov_b32 v39, 0
  v_mov_b32 v40, 0
  v_mov_b32 v41, 0
  v_mov_b32 v42, 0
  v_mov_b32 v43, 0
  v_mov_b32 v44, 0
  v_mov_b32 v45, 0
  v_mov_b32 v46, 0
  v_mov_b32 v47, 0
  v_mov_b32 v48, 0
  v_mov_b32 v49, 0
  v_mov_b32 v50, 0
  v_mov_b32 v51, 0
  v_mov_b32 v52, 0
  v_mov_b32 v53, 0
  v_mov_b32 v54, 0
  v_mov_b32 v55, 0
  v_mov_b32 v56, 0
  v_mov_b32 v57, 0
  v_mov_b32 v58, 0
  v_mov_b32 v59, 0
  s_add_u32 s44, s67, s42
  s_add_u32 s45, s71, s42
  s_add_u32 s46, s49, s42
  s_add_u32 s56, s54, s41
  s_add_u32 s41, s41, 262144
  s_and_b32 s41, s41, 786432
  s_xor_b32 s42, s41, 524288
  s_add_u32 s57, s55, s41
  s_add_u32 s68, s67, s41
  s_add_u32 s70, s69, s41
  s_add_u32 s58, s58, 258048
  s_xor_b32 s59, s59, 32768
  v_readlane_b32 s50, v254, 63
  s_lshl_b32 s47, s40, 18
  s_add_u32 s47, s47, 262144
  s_max_u32 s64, s64, s47
  s_cmp_lt_u32 s64, s50
  s_cselect_b32 s48, s64, 1073741824
  s_cselect_b32 s52, 262144, 0
  s_add_u32 s64, s64, s52
  s_add_u32 s47, s47, 524288
  s_min_u32 s52, s47, s50
  s_cmp_lt_u32 s64, s52
  s_cselect_b32 s52, 2, 0
  s_cmp_eq_u32 s20, 0
  s_cbranch_scc1 b_ck_23
b_ck_23x:
  s_waitcnt vmcnt(0)
b_f_12:
  ds_read_b32 v1, v8
  s_sub_u32 s43, s43, 1
  s_cbranch_scc1 fused_kernel_fin
  s_waitcnt lgkmcnt(0)
  v_cmp_gt_u32 vcc, s40, v1
  s_cbranch_vccnz b_f_12
  buffer_load_dword v253, v252, s[24:27], s48 offen
  buffer_store_dwordx4 v[20:23], v2, s[24:27], s72 offen sc1
  buffer_store_dword v10, v14, s[24:27], s46 offen sc1
  s_cmp_lg_u32 s52, 0
  s_cbranch_scc1 b_ac_27
b_b2_24:
  s_barrier
  s_add_u32 s72, s72, 65536
  s_bitset0_b32 s72, 30
  s_cmp_eq_u32 s40, 64
  s_cbranch_scc0 b_top_10
  s_branch b_fin_9
b_ac_27:
  s_and_b32 vcc_lo, s52, 1
  s_bitcmp0_b32 s52, 2
  s_cbranch_scc1 b_ac_271
  s_buffer_load_dword s62, s[24:27], s61 glc
b_ac_271:
  s_bitcmp0_b32 s52, 1
  s_cbranch_scc1 b_ac_272
  buffer_load_dword v253, v252, s[24:27], s64 offen
  s_add_u32 s64, s64, 262144
b_ac_272:
  s_bitcmp0_b32 s52, 3
  s_cbranch_scc1 b_b2_24
b_rw_28:
  buffer_load_dword v1, off, s[24:27], s61 sc1
  s_sub_u32 s43, s43, 1
  s_cbranch_scc1 fused_kernel_fin
  s_waitcnt vmcnt(0)
  v_cmp_gt_u32 vcc, 12, v1
  s_cbranch_vccnz b_rw_28
  s_mov_b32 s62, 0
  s_add_u32 s61, s61, 128
  s_add_u32 s47, s50, 1048576
  s_cmp_eq_u32 s47, 16777216
  s_cselect_b32 s47, 33554432, s47
  v_mov_b32 v1, 24608
  v_mov_b32 v12, s47
  ds_write_b32 v1, v12
  s_and_b32 vcc_lo, s52, 1
  s_waitcnt lgkmcnt(0)
  s_branch b_b2_24
b_ck_23:
  s_add_u32 s47, s47, 262144
  s_cmp_ge_u32 s47, s50
  s_cbranch_scc1 b_ck_231
b_ck_232:
  s_and_b32 s47, s40, 7
  s_cmp_gt_u32 s40, 57
  s_cselect_b32 s47, 2, s47
  s_cmp_eq_u32 s47, 2
  s_addc_u32 s52, s52, 0
  s_branch b_ck_23x
b_ck_231:
  s_cmp_ge_u32 s62, 12
  s_cbranch_scc1 b_c3_26
  s_sub_u32 s47, s47, 786432
  s_cmp_ge_u32 s47, s50
  s_cbranch_scc1 b_c2_25
  s_bitset1_b32 s52, 2
  s_branch b_ck_232
b_c2_25:
  s_bitset1_b32 s52, 3
  s_branch b_ck_232
b_c3_26:
  s_mov_b32 s62, 0
  s_add_u32 s61, s61, 128
  s_add_u32 s47, s50, 1048576
  s_cmp_eq_u32 s47, 16777216
  s_cselect_b32 s47, 33554432, s47
  v_mov_b32 v1, 24608
  v_mov_b32 v12, s47
  ds_write_b32 v1, v12
  s_branch b_ck_232
b_pg_20:
  s_sub_u32 s47, s40, 2
  v_mov_b32 v1, s47
  s_mov_b64 exec, 1
  buffer_store_dword v1, off, s[24:27], s63 sc1
  s_mov_b64 exec, -1
  s_branch b_pg2_21
b_pa_11:
  buffer_load_dwordx4 v[24:27], v2, s[24:27], s56 offen sc1
  s_sub_u32 s43, s43, 1
  s_cbranch_scc1 fused_kernel_fin
  s_waitcnt vmcnt(0)
  v_mfma_f32_16x16x32_bf16 v[28:31], v[16:19], v[24:27], 0
  s_nop 7
  v_add_f32_dpp v28, v28, v28 row_ror:8 row_mask:0xf bank_mask:0xf
  v_add_f32_dpp v29, v29, v29 row_ror:8 row_mask:0xf bank_mask:0xf
  v_cmp_u_f32 vcc, v28, v28
  v_cvt_pk_bf16_f32 v12, v28, v29
  s_cbranch_vccnz b_pa_11
  buffer_store_dword v12, v9, s[24:27], s68 offen
  s_sleep 2
  s_branch b_pa_11z
m_22_p0_0:
  buffer_load_dwordx4 v[20:23], v2, s[24:27], s57 offen offset:0 sc1
  s_waitcnt vmcnt(3)
  v_cmp_u_f32 vcc, v24, v27
  s_cbranch_vccnz m_22_p1_1
m_22_s1_1:
  v_smfmac_f32_16x16x64_bf16 v[36:39], v[24:27], v[68:75], v7
  v_smfmac_f32_16x16x64_bf16 v[40:43], v[24:27], v[100:107], v7
  v_smfmac_f32_16x16x64_bf16 v[44:47], v[24:27], v[132:139], v7
  s_waitcnt vmcnt(2)
  v_cmp_u_f32 vcc, v28, v31
  v_smfmac_f32_16x16x64_bf16 v[48:51], v[24:27], v[164:171], v7
  s_cbranch_vccnz m_22_p1_2
m_22_s1_2:
  v_smfmac_f32_16x16x64_bf16 v[36:39], v[28:31], v[76:83], v7
  v_smfmac_f32_16x16x64_bf16 v[40:43], v[28:31], v[108:115], v7
  v_smfmac_f32_16x16x64_bf16 v[44:47], v[28:31], v[140:147], v7
  s_waitcnt vmcnt(1)
  v_cmp_u_f32 vcc, v32, v35
  v_smfmac_f32_16x16x64_bf16 v[48:51], v[28:31], v[172:179], v7
  s_cbranch_vccnz m_22_p1_3
m_22_s1_3:
  v_smfmac_f32_16x16x64_bf16 v[36:39], v[32:35], v[84:91], v7
  v_smfmac_f32_16x16x64_bf16 v[40:43], v[32:35], v[116:123], v7
  v_smfmac_f32_16x16x64_bf16 v[44:47], v[32:35], v[148:155], v7
  v_smfmac_f32_16x16x64_bf16 v[48:51], v[32:35], v[180:187], v7
  v_smfmac_f32_16x16x64_bf16 v[52:55], v[24:27], v[196:203], v7
  v_smfmac_f32_16x16x64_bf16 v[56:59], v[24:27], v[228:235], v7
  v_smfmac_f32_16x16x64_bf16 v[52:55], v[28:31], v[204:211], v7
  v_smfmac_f32_16x16x64_bf16 v[56:59], v[28:31], v[236:243], v7
  v_smfmac_f32_16x16x64_bf16 v[52:55], v[32:35], v[212:219], v7
  v_smfmac_f32_16x16x64_bf16 v[56:59], v[32:35], v[244:251], v7
  s_waitcnt vmcnt(0)
  v_cmp_u_f32 vcc, v20, v23
  s_cbranch_vccnz m_22_f1_0
  s_branch m_22_n1_0
m_22_p0_1:
  buffer_load_dwordx4 v[24:27], v2, s[24:27], s57 offen offset:1024 sc1
  s_waitcnt vmcnt(2)
  v_cmp_u_f32 vcc, v28, v31
  s_cbranch_vccnz m_22_p2_2
m_22_s2_2:
  v_smfmac_f32_16x16x64_bf16 v[36:39], v[28:31], v[76:83], v7
  v_smfmac_f32_16x16x64_bf16 v[40:43], v[28:31], v[108:115], v7
  v_smfmac_f32_16x16x64_bf16 v[44:47], v[28:31], v[140:147], v7
  s_waitcnt vmcnt(1)
  v_cmp_u_f32 vcc, v32, v35
  v_smfmac_f32_16x16x64_bf16 v[48:51], v[28:31], v[172:179], v7
  s_cbranch_vccnz m_22_p2_3
m_22_s2_3:
  v_smfmac_f32_16x16x64_bf16 v[36:39], v[32:35], v[84:91], v7
  v_smfmac_f32_16x16x64_bf16 v[40:43], v[32:35], v[116:123], v7
  v_smfmac_f32_16x16x64_bf16 v[44:47], v[32:35], v[148:155], v7
  v_smfmac_f32_16x16x64_bf16 v[48:51], v[32:35], v[180:187], v7
  v_smfmac_f32_16x16x64_bf16 v[52:55], v[20:23], v[188:195], v7
  v_smfmac_f32_16x16x64_bf16 v[56:59], v[20:23], v[220:227], v7
  v_smfmac_f32_16x16x64_bf16 v[52:55], v[28:31], v[204:211], v7
  v_smfmac_f32_16x16x64_bf16 v[56:59], v[28:31], v[236:243], v7
  v_smfmac_f32_16x16x64_bf16 v[52:55], v[32:35], v[212:219], v7
  v_smfmac_f32_16x16x64_bf16 v[56:59], v[32:35], v[244:251], v7
  s_waitcnt vmcnt(0)
  v_cmp_u_f32 vcc, v24, v27
  s_cbranch_vccnz m_22_f2_1
  s_branch m_22_n2_1
m_22_p1_1:
  buffer_load_dwordx4 v[24:27], v2, s[24:27], s57 offen offset:1024 sc1
  s_waitcnt vmcnt(3)
  v_cmp_u_f32 vcc, v28, v31
  s_cbranch_vccnz m_22_p3_2
m_22_s3_2:
  v_smfmac_f32_16x16x64_bf16 v[36:39], v[28:31], v[76:83], v7
  v_smfmac_f32_16x16x64_bf16 v[40:43], v[28:31], v[108:115], v7
  v_smfmac_f32_16x16x64_bf16 v[44:47], v[28:31], v[140:147], v7
  s_waitcnt vmcnt(2)
  v_cmp_u_f32 vcc, v32, v35
  v_smfmac_f32_16x16x64_bf16 v[48:51], v[28:31], v[172:179], v7
  s_cbranch_vccnz m_22_p3_3
m_22_s3_3:
  v_smfmac_f32_16x16x64_bf16 v[36:39], v[32:35], v[84:91], v7
  v_smfmac_f32_16x16x64_bf16 v[40:43], v[32:35], v[116:123], v7
  v_smfmac_f32_16x16x64_bf16 v[44:47], v[32:35], v[148:155], v7
  v_smfmac_f32_16x16x64_bf16 v[48:51], v[32:35], v[180:187], v7
  v_smfmac_f32_16x16x64_bf16 v[52:55], v[28:31], v[204:211], v7
  v_smfmac_f32_16x16x64_bf16 v[56:59], v[28:31], v[236:243], v7
  v_smfmac_f32_16x16x64_bf16 v[52:55], v[32:35], v[212:219], v7
  v_smfmac_f32_16x16x64_bf16 v[56:59], v[32:35], v[244:251], v7
  s_waitcnt vmcnt(1)
  v_cmp_u_f32 vcc, v20, v23
  s_cbranch_vccnz m_22_f3_0
  s_branch m_22_n3_0
m_22_p0_2:
  buffer_load_dwordx4 v[28:31], v2, s[24:27], s57 offen offset:2048 sc1
  s_waitcnt vmcnt(1)
  v_cmp_u_f32 vcc, v32, v35
  s_cbranch_vccnz m_22_p4_3
m_22_s4_3:
  v_smfmac_f32_16x16x64_bf16 v[36:39], v[32:35], v[84:91], v7
  v_smfmac_f32_16x16x64_bf16 v[40:43], v[32:35], v[116:123], v7
  v_smfmac_f32_16x16x64_bf16 v[44:47], v[32:35], v[148:155], v7
  v_smfmac_f32_16x16x64_bf16 v[48:51], v[32:35], v[180:187], v7
  v_smfmac_f32_16x16x64_bf16 v[52:55], v[20:23], v[188:195], v7
  v_smfmac_f32_16x16x64_bf16 v[56:59], v[20:23], v[220:227], v7
  v_smfmac_f32_16x16x64_bf16 v[52:55], v[24:27], v[196:203], v7
  v_smfmac_f32_16x16x64_bf16 v[56:59], v[24:27], v[228:235], v7
  v_smfmac_f32_16x16x64_bf16 v[52:55], v[32:35], v[212:219], v7
  v_smfmac_f32_16x16x64_bf16 v[56:59], v[32:35], v[244:251], v7
  s_waitcnt vmcnt(0)
  v_cmp_u_f32 vcc, v28, v31
  s_cbranch_vccnz m_22_f4_2
  s_branch m_22_n4_2
m_22_p1_2:
  buffer_load_dwordx4 v[28:31], v2, s[24:27], s57 offen offset:2048 sc1
  s_waitcnt vmcnt(2)
  v_cmp_u_f32 vcc, v32, v35
  s_cbranch_vccnz m_22_p5_3
m_22_s5_3:
  v_smfmac_f32_16x16x64_bf16 v[36:39], v[32:35], v[84:91], v7
  v_smfmac_f32_16x16x64_bf16 v[40:43], v[32:35], v[116:123], v7
  v_smfmac_f32_16x16x64_bf16 v[44:47], v[32:35], v[148:155], v7
  v_smfmac_f32_16x16x64_bf16 v[48:51], v[32:35], v[180:187], v7
  v_smfmac_f32_16x16x64_bf16 v[52:55], v[24:27], v[196:203], v7
  v_smfmac_f32_16x16x64_bf16 v[56:59], v[24:27], v[228:235], v7
  v_smfmac_f32_16x16x64_bf16 v[52:55], v[32:35], v[212:219], v7
  v_smfmac_f32_16x16x64_bf16 v[56:59], v[32:35], v[244:251], v7
  s_waitcnt vmcnt(1)
  v_cmp_u_f32 vcc, v20, v23
  s_cbranch_vccnz m_22_f5_0
  s_branch m_22_n5_0
m_22_p2_2:
  buffer_load_dwordx4 v[28:31], v2, s[24:27], s57 offen offset:2048 sc1
  s_waitcnt vmcnt(2)
  v_cmp_u_f32 vcc, v32, v35
  s_cbranch_vccnz m_22_p6_3
m_22_s6_3:
  v_smfmac_f32_16x16x64_bf16 v[36:39], v[32:35], v[84:91], v7
  v_smfmac_f32_16x16x64_bf16 v[40:43], v[32:35], v[116:123], v7
  v_smfmac_f32_16x16x64_bf16 v[44:47], v[32:35], v[148:155], v7
  v_smfmac_f32_16x16x64_bf16 v[48:51], v[32:35], v[180:187], v7
  v_smfmac_f32_16x16x64_bf16 v[52:55], v[20:23], v[188:195], v7
  v_smfmac_f32_16x16x64_bf16 v[56:59], v[20:23], v[220:227], v7
  v_smfmac_f32_16x16x64_bf16 v[52:55], v[32:35], v[212:219], v7
  v_smfmac_f32_16x16x64_bf16 v[56:59], v[32:35], v[244:251], v7
  s_waitcnt vmcnt(1)
  v_cmp_u_f32 vcc, v24, v27
  s_cbranch_vccnz m_22_f6_1
  s_branch m_22_n6_1
m_22_p3_2:
  buffer_load_dwordx4 v[28:31], v2, s[24:27], s57 offen offset:2048 sc1
  s_waitcnt vmcnt(3)
  v_cmp_u_f32 vcc, v32, v35
  s_cbranch_vccnz m_22_p7_3
m_22_s7_3:
  v_smfmac_f32_16x16x64_bf16 v[36:39], v[32:35], v[84:91], v7
  v_smfmac_f32_16x16x64_bf16 v[40:43], v[32:35], v[116:123], v7
  v_smfmac_f32_16x16x64_bf16 v[44:47], v[32:35], v[148:155], v7
  v_smfmac_f32_16x16x64_bf16 v[48:51], v[32:35], v[180:187], v7
  v_smfmac_f32_16x16x64_bf16 v[52:55], v[32:35], v[212:219], v7
  v_smfmac_f32_16x16x64_bf16 v[56:59], v[32:35], v[244:251], v7
  s_waitcnt vmcnt(2)
  v_cmp_u_f32 vcc, v20, v23
  s_cbranch_vccnz m_22_f7_0
  s_branch m_22_n7_0
m_22_p0_3:
  buffer_load_dwordx4 v[32:35], v2, s[24:27], s57 offen offset:3072 sc1
  s_sub_u32 s43, s43, 1
  s_cbranch_scc1 fused_kernel_fin
  v_smfmac_f32_16x16x64_bf16 v[52:55], v[20:23], v[188:195], v7
  v_smfmac_f32_16x16x64_bf16 v[56:59], v[20:23], v[220:227], v7
  v_smfmac_f32_16x16x64_bf16 v[52:55], v[24:27], v[196:203], v7
  v_smfmac_f32_16x16x64_bf16 v[56:59], v[24:27], v[228:235], v7
  v_smfmac_f32_16x16x64_bf16 v[52:55], v[28:31], v[204:211], v7
  v_smfmac_f32_16x16x64_bf16 v[56:59], v[28:31], v[236:243], v7
  s_waitcnt vmcnt(0)
  v_cmp_u_f32 vcc, v32, v35
  s_cbranch_vccnz m_22_f8_3
  s_branch m_22_n8_3
m_22_p1_3:
  buffer_load_dwordx4 v[32:35], v2, s[24:27], s57 offen offset:3072 sc1
  s_sub_u32 s43, s43, 1
  s_cbranch_scc1 fused_kernel_fin
  v_smfmac_f32_16x16x64_bf16 v[52:55], v[24:27], v[196:203], v7
  v_smfmac_f32_16x16x64_bf16 v[56:59], v[24:27], v[228:235], v7
  v_smfmac_f32_16x16x64_bf16 v[52:55], v[28:31], v[204:211], v7
  v_smfmac_f32_16x16x64_bf16 v[56:59], v[28:31], v[236:243], v7
  s_waitcnt vmcnt(1)
  v_cmp_u_f32 vcc, v20, v23
  s_cbranch_vccnz m_22_f9_0
  s_branch m_22_n9_0
m_22_p2_3:
  buffer_load_dwordx4 v[32:35], v2, s[24:27], s57 offen offset:3072 sc1
  s_sub_u32 s43, s43, 1
  s_cbranch_scc1 fused_kernel_fin
  v_smfmac_f32_16x16x64_bf16 v[52:55], v[20:23], v[188:195], v7
  v_smfmac_f32_16x16x64_bf16 v[56:59], v[20:23], v[220:227], v7
  v_smfmac_f32_16x16x64_bf16 v[52:55], v[28:31], v[204:211], v7
  v_smfmac_f32_16x16x64_bf16 v[56:59], v[28:31], v[236:243], v7
  s_waitcnt vmcnt(1)
  v_cmp_u_f32 vcc, v24, v27
  s_cbranch_vccnz m_22_f10_1
  s_branch m_22_n10_1
m_22_p3_3:
  buffer_load_dwordx4 v[32:35], v2, s[24:27], s57 offen offset:3072 sc1
  s_sub_u32 s43, s43, 1
  s_cbranch_scc1 fused_kernel_fin
  v_smfmac_f32_16x16x64_bf16 v[52:55], v[28:31], v[204:211], v7
  v_smfmac_f32_16x16x64_bf16 v[56:59], v[28:31], v[236:243], v7
  s_waitcnt vmcnt(2)
  v_cmp_u_f32 vcc, v20, v23
  s_cbranch_vccnz m_22_f11_0
  s_branch m_22_n11_0
m_22_p4_3:
  buffer_load_dwordx4 v[32:35], v2, s[24:27], s57 offen offset:3072 sc1
  s_sub_u32 s43, s43, 1
  s_cbranch_scc1 fused_kernel_fin
  v_smfmac_f32_16x16x64_bf16 v[52:55], v[20:23], v[188:195], v7
  v_smfmac_f32_16x16x64_bf16 v[56:59], v[20:23], v[220:227], v7
  v_smfmac_f32_16x16x64_bf16 v[52:55], v[24:27], v[196:203], v7
  v_smfmac_f32_16x16x64_bf16 v[56:59], v[24:27], v[228:235], v7
  s_waitcnt vmcnt(1)
  v_cmp_u_f32 vcc, v28, v31
  s_cbranch_vccnz m_22_f12_2
  s_branch m_22_n12_2
m_22_p5_3:
  buffer_load_dwordx4 v[32:35], v2, s[24:27], s57 offen offset:3072 sc1
  s_sub_u32 s43, s43, 1
  s_cbranch_scc1 fused_kernel_fin
  v_smfmac_f32_16x16x64_bf16 v[52:55], v[24:27], v[196:203], v7
  v_smfmac_f32_16x16x64_bf16 v[56:59], v[24:27], v[228:235], v7
  s_waitcnt vmcnt(2)
  v_cmp_u_f32 vcc, v20, v23
  s_cbranch_vccnz m_22_f13_0
  s_branch m_22_n13_0
m_22_p6_3:
  buffer_load_dwordx4 v[32:35], v2, s[24:27], s57 offen offset:3072 sc1
  s_sub_u32 s43, s43, 1
  s_cbranch_scc1 fused_kernel_fin
  v_smfmac_f32_16x16x64_bf16 v[52:55], v[20:23], v[188:195], v7
  v_smfmac_f32_16x16x64_bf16 v[56:59], v[20:23], v[220:227], v7
  s_waitcnt vmcnt(2)
  v_cmp_u_f32 vcc, v24, v27
  s_cbranch_vccnz m_22_f14_1
  s_branch m_22_n14_1
m_22_p7_3:
  buffer_load_dwordx4 v[32:35], v2, s[24:27], s57 offen offset:3072 sc1
  s_sub_u32 s43, s43, 1
  s_cbranch_scc1 fused_kernel_fin
  s_waitcnt vmcnt(3)
  v_cmp_u_f32 vcc, v20, v23
  s_cbranch_vccnz m_22_f15_0
  s_branch m_22_n15_0
m_22_f15_0:
  buffer_load_dwordx4 v[20:23], v2, s[24:27], s57 offen offset:0 sc1
  s_waitcnt vmcnt(3)
  v_cmp_u_f32 vcc, v24, v27
  s_cbranch_vccz m_22_n15_1
m_22_f15_1:
  buffer_load_dwordx4 v[24:27], v2, s[24:27], s57 offen offset:1024 sc1
  s_waitcnt vmcnt(3)
  v_cmp_u_f32 vcc, v28, v31
  s_cbranch_vccz m_22_n15_2
m_22_f15_2:
  buffer_load_dwordx4 v[28:31], v2, s[24:27], s57 offen offset:2048 sc1
  s_waitcnt vmcnt(3)
  v_cmp_u_f32 vcc, v32, v35
  s_cbranch_vccz m_22_n15_3
m_22_f15_3:
  buffer_load_dwordx4 v[32:35], v2, s[24:27], s57 offen offset:3072 sc1
  s_sub_u32 s43, s43, 1
  s_cbranch_scc1 fused_kernel_fin
  s_waitcnt vmcnt(3)
  v_cmp_u_f32 vcc, v20, v23
  s_cbranch_vccnz m_22_f15_0
m_22_n15_0:
  v_smfmac_f32_16x16x64_bf16 v[36:39], v[20:23], v[60:67], v7
  v_smfmac_f32_16x16x64_bf16 v[40:43], v[20:23], v[92:99], v7
  v_smfmac_f32_16x16x64_bf16 v[44:47], v[20:23], v[124:131], v7
  v_smfmac_f32_16x16x64_bf16 v[48:51], v[20:23], v[156:163], v7
  v_smfmac_f32_16x16x64_bf16 v[52:55], v[20:23], v[188:195], v7
  s_waitcnt vmcnt(2)
  v_cmp_u_f32 vcc, v24, v27
  v_smfmac_f32_16x16x64_bf16 v[56:59], v[20:23], v[220:227], v7
  s_cbranch_vccnz m_22_f14_1
m_22_n14_1:
  v_smfmac_f32_16x16x64_bf16 v[36:39], v[24:27], v[68:75], v7
  v_smfmac_f32_16x16x64_bf16 v[40:43], v[24:27], v[100:107], v7
  v_smfmac_f32_16x16x64_bf16 v[44:47], v[24:27], v[132:139], v7
  v_smfmac_f32_16x16x64_bf16 v[48:51], v[24:27], v[164:171], v7
  v_smfmac_f32_16x16x64_bf16 v[52:55], v[24:27], v[196:203], v7
  s_waitcnt vmcnt(1)
  v_cmp_u_f32 vcc, v28, v31
  v_smfmac_f32_16x16x64_bf16 v[56:59], v[24:27], v[228:235], v7
  s_cbranch_vccnz m_22_f12_2
m_22_n12_2:
  v_smfmac_f32_16x16x64_bf16 v[36:39], v[28:31], v[76:83], v7
  v_smfmac_f32_16x16x64_bf16 v[40:43], v[28:31], v[108:115], v7
  v_smfmac_f32_16x16x64_bf16 v[44:47], v[28:31], v[140:147], v7
  v_smfmac_f32_16x16x64_bf16 v[48:51], v[28:31], v[172:179], v7
  v_smfmac_f32_16x16x64_bf16 v[52:55], v[28:31], v[204:211], v7
  s_waitcnt vmcnt(0)
  v_cmp_u_f32 vcc, v32, v35
  v_smfmac_f32_16x16x64_bf16 v[56:59], v[28:31], v[236:243], v7
  s_cbranch_vccnz m_22_f8_3
m_22_n8_3:
  v_smfmac_f32_16x16x64_bf16 v[36:39], v[32:35], v[84:91], v7
  buffer_load_dwordx4 v2, s[24:27], s58 offen offset:0 lds
  v_smfmac_f32_16x16x64_bf16 v[40:43], v[32:35], v[116:123], v7
  buffer_load_dwordx4 v2, s[24:27], s58 offen offset:1024 lds
  v_smfmac_f32_16x16x64_bf16 v[44:47], v[32:35], v[148:155], v7
  s_nop 3
  v_add_f32 v36, v36, v38
  v_add_f32 v37, v37, v39
  v_cvt_pk_bf16_f32 v38, v36, v37
  ds_write_b32 v4, v38 offset:0
  v_smfmac_f32_16x16x64_bf16 v[48:51], v[32:35], v[180:187], v7
  v_add_f32 v40, v40, v42
  v_add_f32 v41, v41, v43
  v_cvt_pk_bf16_f32 v42, v40, v41
  ds_write_b32 v4, v42 offset:640
  v_smfmac_f32_16x16x64_bf16 v[52:55], v[32:35], v[212:219], v7
  v_add_f32 v44, v44, v46
  v_add_f32 v45, v45, v47
  v_cvt_pk_bf16_f32 v46, v44, v45
  ds_write_b32 v4, v46 offset:2560
  v_smfmac_f32_16x16x64_bf16 v[56:59], v[32:35], v[244:251], v7
  v_add_f32 v48, v48, v50
  v_add_f32 v49, v49, v51
  v_cvt_pk_bf16_f32 v50, v48, v49
  ds_write_b32 v4, v50 offset:3200
  v_add_f32 v52, v52, v54
  v_add_f32 v53, v53, v55
  ds_write2_b32 v5, v52, v53 offset0:0 offset1:16
  s_nop 0
  v_add_f32 v56, v56, v58
  v_add_f32 v57, v57, v59
  ds_write2_b32 v5, v56, v57 offset0:128 offset1:144
  buffer_load_dwordx4 v2, s[24:27], s58 offen offset:2048 lds
  buffer_load_dwordx4 v2, s[24:27], s58 offen offset:3072 lds
  s_branch b_post_13
m_22_n15_1:
  v_smfmac_f32_16x16x64_bf16 v[36:39], v[24:27], v[68:75], v7
  v_smfmac_f32_16x16x64_bf16 v[40:43], v[24:27], v[100:107], v7
  v_smfmac_f32_16x16x64_bf16 v[44:47], v[24:27], v[132:139], v7
  v_smfmac_f32_16x16x64_bf16 v[48:51], v[24:27], v[164:171], v7
  v_smfmac_f32_16x16x64_bf16 v[52:55], v[24:27], v[196:203], v7
  s_waitcnt vmcnt(2)
  v_cmp_u_f32 vcc, v28, v31
  v_smfmac_f32_16x16x64_bf16 v[56:59], v[24:27], v[228:235], v7
  s_cbranch_vccnz m_22_f13_2
m_22_n13_2:
  v_smfmac_f32_16x16x64_bf16 v[36:39], v[28:31], v[76:83], v7
  v_smfmac_f32_16x16x64_bf16 v[40:43], v[28:31], v[108:115], v7
  v_smfmac_f32_16x16x64_bf16 v[44:47], v[28:31], v[140:147], v7
  v_smfmac_f32_16x16x64_bf16 v[48:51], v[28:31], v[172:179], v7
  v_smfmac_f32_16x16x64_bf16 v[52:55], v[28:31], v[204:211], v7
  s_waitcnt vmcnt(1)
  v_cmp_u_f32 vcc, v32, v35
  v_smfmac_f32_16x16x64_bf16 v[56:59], v[28:31], v[236:243], v7
  s_cbranch_vccnz m_22_f9_3
m_22_n9_3:
  v_smfmac_f32_16x16x64_bf16 v[36:39], v[32:35], v[84:91], v7
  v_smfmac_f32_16x16x64_bf16 v[40:43], v[32:35], v[116:123], v7
  v_smfmac_f32_16x16x64_bf16 v[44:47], v[32:35], v[148:155], v7
  v_smfmac_f32_16x16x64_bf16 v[48:51], v[32:35], v[180:187], v7
  v_smfmac_f32_16x16x64_bf16 v[52:55], v[32:35], v[212:219], v7
  s_waitcnt vmcnt(0)
  v_cmp_u_f32 vcc, v20, v23
  v_smfmac_f32_16x16x64_bf16 v[56:59], v[32:35], v[244:251], v7
  s_cbranch_vccnz m_22_f1_0
m_22_n1_0:
  v_smfmac_f32_16x16x64_bf16 v[36:39], v[20:23], v[60:67], v7
  buffer_load_dwordx4 v2, s[24:27], s58 offen offset:0 lds
  v_smfmac_f32_16x16x64_bf16 v[40:43], v[20:23], v[92:99], v7
  buffer_load_dwordx4 v2, s[24:27], s58 offen offset:1024 lds
  v_smfmac_f32_16x16x64_bf16 v[44:47], v[20:23], v[124:131], v7
  s_nop 3
  v_add_f32 v36, v36, v38
  v_add_f32 v37, v37, v39
  v_cvt_pk_bf16_f32 v38, v36, v37
  ds_write_b32 v4, v38 offset:0
  v_smfmac_f32_16x16x64_bf16 v[48:51], v[20:23], v[156:163], v7
  v_add_f32 v40, v40, v42
  v_add_f32 v41, v41, v43
  v_cvt_pk_bf16_f32 v42, v40, v41
  ds_write_b32 v4, v42 offset:640
  v_smfmac_f32_16x16x64_bf16 v[52:55], v[20:23], v[188:195], v7
  v_add_f32 v44, v44, v46
  v_add_f32 v45, v45, v47
  v_cvt_pk_bf16_f32 v46, v44, v45
  ds_write_b32 v4, v46 offset:2560
  v_smfmac_f32_16x16x64_bf16 v[56:59], v[20:23], v[220:227], v7
  v_add_f32 v48, v48, v50
  v_add_f32 v49, v49, v51
  v_cvt_pk_bf16_f32 v50, v48, v49
  ds_write_b32 v4, v50 offset:3200
  v_add_f32 v52, v52, v54
  v_add_f32 v53, v53, v55
  ds_write2_b32 v5, v52, v53 offset0:0 offset1:16
  s_nop 0
  v_add_f32 v56, v56, v58
  v_add_f32 v57, v57, v59
  ds_write2_b32 v5, v56, v57 offset0:128 offset1:144
  buffer_load_dwordx4 v2, s[24:27], s58 offen offset:2048 lds
  buffer_load_dwordx4 v2, s[24:27], s58 offen offset:3072 lds
  s_branch b_post_13
m_22_n15_2:
  v_smfmac_f32_16x16x64_bf16 v[36:39], v[28:31], v[76:83], v7
  v_smfmac_f32_16x16x64_bf16 v[40:43], v[28:31], v[108:115], v7
  v_smfmac_f32_16x16x64_bf16 v[44:47], v[28:31], v[140:147], v7
  v_smfmac_f32_16x16x64_bf16 v[48:51], v[28:31], v[172:179], v7
  v_smfmac_f32_16x16x64_bf16 v[52:55], v[28:31], v[204:211], v7
  s_waitcnt vmcnt(2)
  v_cmp_u_f32 vcc, v32, v35
  v_smfmac_f32_16x16x64_bf16 v[56:59], v[28:31], v[236:243], v7
  s_cbranch_vccnz m_22_f11_3
m_22_n11_3:
  v_smfmac_f32_16x16x64_bf16 v[36:39], v[32:35], v[84:91], v7
  v_smfmac_f32_16x16x64_bf16 v[40:43], v[32:35], v[116:123], v7
  v_smfmac_f32_16x16x64_bf16 v[44:47], v[32:35], v[148:155], v7
  v_smfmac_f32_16x16x64_bf16 v[48:51], v[32:35], v[180:187], v7
  v_smfmac_f32_16x16x64_bf16 v[52:55], v[32:35], v[212:219], v7
  s_waitcnt vmcnt(1)
  v_cmp_u_f32 vcc, v20, v23
  v_smfmac_f32_16x16x64_bf16 v[56:59], v[32:35], v[244:251], v7
  s_cbranch_vccnz m_22_f3_0
m_22_n3_0:
  v_smfmac_f32_16x16x64_bf16 v[36:39], v[20:23], v[60:67], v7
  v_smfmac_f32_16x16x64_bf16 v[40:43], v[20:23], v[92:99], v7
  v_smfmac_f32_16x16x64_bf16 v[44:47], v[20:23], v[124:131], v7
  v_smfmac_f32_16x16x64_bf16 v[48:51], v[20:23], v[156:163], v7
  v_smfmac_f32_16x16x64_bf16 v[52:55], v[20:23], v[188:195], v7
  s_waitcnt vmcnt(0)
  v_cmp_u_f32 vcc, v24, v27
  v_smfmac_f32_16x16x64_bf16 v[56:59], v[20:23], v[220:227], v7
  s_cbranch_vccnz m_22_f2_1
m_22_n2_1:
  v_smfmac_f32_16x16x64_bf16 v[36:39], v[24:27], v[68:75], v7
  buffer_load_dwordx4 v2, s[24:27], s58 offen offset:0 lds
  v_smfmac_f32_16x16x64_bf16 v[40:43], v[24:27], v[100:107], v7
  buffer_load_dwordx4 v2, s[24:27], s58 offen offset:1024 lds
  v_smfmac_f32_16x16x64_bf16 v[44:47], v[24:27], v[132:139], v7
  s_nop 3
  v_add_f32 v36, v36, v38
  v_add_f32 v37, v37, v39
  v_cvt_pk_bf16_f32 v38, v36, v37
  ds_write_b32 v4, v38 offset:0
  v_smfmac_f32_16x16x64_bf16 v[48:51], v[24:27], v[164:171], v7
  v_add_f32 v40, v40, v42
  v_add_f32 v41, v41, v43
  v_cvt_pk_bf16_f32 v42, v40, v41
  ds_write_b32 v4, v42 offset:640
  v_smfmac_f32_16x16x64_bf16 v[52:55], v[24:27], v[196:203], v7
  v_add_f32 v44, v44, v46
  v_add_f32 v45, v45, v47
  v_cvt_pk_bf16_f32 v46, v44, v45
  ds_write_b32 v4, v46 offset:2560
  v_smfmac_f32_16x16x64_bf16 v[56:59], v[24:27], v[228:235], v7
  v_add_f32 v48, v48, v50
  v_add_f32 v49, v49, v51
  v_cvt_pk_bf16_f32 v50, v48, v49
  ds_write_b32 v4, v50 offset:3200
  v_add_f32 v52, v52, v54
  v_add_f32 v53, v53, v55
  ds_write2_b32 v5, v52, v53 offset0:0 offset1:16
  s_nop 0
  v_add_f32 v56, v56, v58
  v_add_f32 v57, v57, v59
  ds_write2_b32 v5, v56, v57 offset0:128 offset1:144
  buffer_load_dwordx4 v2, s[24:27], s58 offen offset:2048 lds
  buffer_load_dwordx4 v2, s[24:27], s58 offen offset:3072 lds
  s_branch b_post_13
m_22_n15_3:
  v_smfmac_f32_16x16x64_bf16 v[36:39], v[32:35], v[84:91], v7
  v_smfmac_f32_16x16x64_bf16 v[40:43], v[32:35], v[116:123], v7
  v_smfmac_f32_16x16x64_bf16 v[44:47], v[32:35], v[148:155], v7
  v_smfmac_f32_16x16x64_bf16 v[48:51], v[32:35], v[180:187], v7
  v_smfmac_f32_16x16x64_bf16 v[52:55], v[32:35], v[212:219], v7
  s_waitcnt vmcnt(2)
  v_cmp_u_f32 vcc, v20, v23
  v_smfmac_f32_16x16x64_bf16 v[56:59], v[32:35], v[244:251], v7
  s_cbranch_vccnz m_22_f7_0
m_22_n7_0:
  v_smfmac_f32_16x16x64_bf16 v[36:39], v[20:23], v[60:67], v7
  v_smfmac_f32_16x16x64_bf16 v[40:43], v[20:23], v[92:99], v7
  v_smfmac_f32_16x16x64_bf16 v[44:47], v[20:23], v[124:131], v7
  v_smfmac_f32_16x16x64_bf16 v[48:51], v[20:23], v[156:163], v7
  v_smfmac_f32_16x16x64_bf16 v[52:55], v[20:23], v[188:195], v7
  s_waitcnt vmcnt(1)
  v_cmp_u_f32 vcc, v24, v27
  v_smfmac_f32_16x16x64_bf16 v[56:59], v[20:23], v[220:227], v7
  s_cbranch_vccnz m_22_f6_1
m_22_n6_1:
  v_smfmac_f32_16x16x64_bf16 v[36:39], v[24:27], v[68:75], v7
  v_smfmac_f32_16x16x64_bf16 v[40:43], v[24:27], v[100:107], v7
  v_smfmac_f32_16x16x64_bf16 v[44:47], v[24:27], v[132:139], v7
  v_smfmac_f32_16x16x64_bf16 v[48:51], v[24:27], v[164:171], v7
  v_smfmac_f32_16x16x64_bf16 v[52:55], v[24:27], v[196:203], v7
  s_waitcnt vmcnt(0)
  v_cmp_u_f32 vcc, v28, v31
  v_smfmac_f32_16x16x64_bf16 v[56:59], v[24:27], v[228:235], v7
  s_cbranch_vccnz m_22_f4_2
m_22_n4_2:
  v_smfmac_f32_16x16x64_bf16 v[36:39], v[28:31], v[76:83], v7
  buffer_load_dwordx4 v2, s[24:27], s58 offen offset:0 lds
  v_smfmac_f32_16x16x64_bf16 v[40:43], v[28:31], v[108:115], v7
  buffer_load_dwordx4 v2, s[24:27], s58 offen offset:1024 lds
  v_smfmac_f32_16x16x64_bf16 v[44:47], v[28:31], v[140:147], v7
  s_nop 3
  v_add_f32 v36, v36, v38
  v_add_f32 v37, v37, v39
  v_cvt_pk_bf16_f32 v38, v36, v37
  ds_write_b32 v4, v38 offset:0
  v_smfmac_f32_16x16x64_bf16 v[48:51], v[28:31], v[172:179], v7
  v_add_f32 v40, v40, v42
  v_add_f32 v41, v41, v43
  v_cvt_pk_bf16_f32 v42, v40, v41
  ds_write_b32 v4, v42 offset:640
  v_smfmac_f32_16x16x64_bf16 v[52:55], v[28:31], v[204:211], v7
  v_add_f32 v44, v44, v46
  v_add_f32 v45, v45, v47
  v_cvt_pk_bf16_f32 v46, v44, v45
  ds_write_b32 v4, v46 offset:2560
  v_smfmac_f32_16x16x64_bf16 v[56:59], v[28:31], v[236:243], v7
  v_add_f32 v48, v48, v50
  v_add_f32 v49, v49, v51
  v_cvt_pk_bf16_f32 v50, v48, v49
  ds_write_b32 v4, v50 offset:3200
  v_add_f32 v52, v52, v54
  v_add_f32 v53, v53, v55
  ds_write2_b32 v5, v52, v53 offset0:0 offset1:16
  s_nop 0
  v_add_f32 v56, v56, v58
  v_add_f32 v57, v57, v59
  ds_write2_b32 v5, v56, v57 offset0:128 offset1:144
  buffer_load_dwordx4 v2, s[24:27], s58 offen offset:2048 lds
  buffer_load_dwordx4 v2, s[24:27], s58 offen offset:3072 lds
  s_branch b_post_13
m_22_f14_1:
  buffer_load_dwordx4 v[24:27], v2, s[24:27], s57 offen offset:1024 sc1
  s_waitcnt vmcnt(2)
  v_cmp_u_f32 vcc, v28, v31
  s_cbranch_vccz m_22_n14_2
m_22_f14_2:
  buffer_load_dwordx4 v[28:31], v2, s[24:27], s57 offen offset:2048 sc1
  s_waitcnt vmcnt(2)
  v_cmp_u_f32 vcc, v32, v35
  s_cbranch_vccz m_22_n14_3
m_22_f14_3:
  buffer_load_dwordx4 v[32:35], v2, s[24:27], s57 offen offset:3072 sc1
  s_sub_u32 s43, s43, 1
  s_cbranch_scc1 fused_kernel_fin
  s_waitcnt vmcnt(2)
  v_cmp_u_f32 vcc, v24, v27
  s_cbranch_vccnz m_22_f14_1
  s_branch m_22_n14_1
m_22_n14_2:
  v_smfmac_f32_16x16x64_bf16 v[36:39], v[28:31], v[76:83], v7
  v_smfmac_f32_16x16x64_bf16 v[40:43], v[28:31], v[108:115], v7
  v_smfmac_f32_16x16x64_bf16 v[44:47], v[28:31], v[140:147], v7
  v_smfmac_f32_16x16x64_bf16 v[48:51], v[28:31], v[172:179], v7
  v_smfmac_f32_16x16x64_bf16 v[52:55], v[28:31], v[204:211], v7
  s_waitcnt vmcnt(1)
  v_cmp_u_f32 vcc, v32, v35
  v_smfmac_f32_16x16x64_bf16 v[56:59], v[28:31], v[236:243], v7
  s_cbranch_vccnz m_22_f10_3
m_22_n10_3:
  v_smfmac_f32_16x16x64_bf16 v[36:39], v[32:35], v[84:91], v7
  v_smfmac_f32_16x16x64_bf16 v[40:43], v[32:35], v[116:123], v7
  v_smfmac_f32_16x16x64_bf16 v[44:47], v[32:35], v[148:155], v7
  v_smfmac_f32_16x16x64_bf16 v[48:51], v[32:35], v[180:187], v7
  v_smfmac_f32_16x16x64_bf16 v[52:55], v[32:35], v[212:219], v7
  s_waitcnt vmcnt(0)
  v_cmp_u_f32 vcc, v24, v27
  v_smfmac_f32_16x16x64_bf16 v[56:59], v[32:35], v[244:251], v7
  s_cbranch_vccnz m_22_f2_1
  s_branch m_22_n2_1
m_22_n14_3:
  v_smfmac_f32_16x16x64_bf16 v[36:39], v[32:35], v[84:91], v7
  v_smfmac_f32_16x16x64_bf16 v[40:43], v[32:35], v[116:123], v7
  v_smfmac_f32_16x16x64_bf16 v[44:47], v[32:35], v[148:155], v7
  v_smfmac_f32_16x16x64_bf16 v[48:51], v[32:35], v[180:187], v7
  v_smfmac_f32_16x16x64_bf16 v[52:55], v[32:35], v[212:219], v7
  s_waitcnt vmcnt(1)
  v_cmp_u_f32 vcc, v24, v27
  v_smfmac_f32_16x16x64_bf16 v[56:59], v[32:35], v[244:251], v7
  s_cbranch_vccnz m_22_f6_1
  s_branch m_22_n6_1
m_22_f13_0:
  buffer_load_dwordx4 v[20:23], v2, s[24:27], s57 offen offset:0 sc1
  s_waitcnt vmcnt(2)
  v_cmp_u_f32 vcc, v28, v31
  s_cbranch_vccz m_22_n13_2
m_22_f13_2:
  buffer_load_dwordx4 v[28:31], v2, s[24:27], s57 offen offset:2048 sc1
  s_waitcnt vmcnt(2)
  v_cmp_u_f32 vcc, v32, v35
  s_cbranch_vccz m_22_n13_3
m_22_f13_3:
  buffer_load_dwordx4 v[32:35], v2, s[24:27], s57 offen offset:3072 sc1
  s_sub_u32 s43, s43, 1
  s_cbranch_scc1 fused_kernel_fin
  s_waitcnt vmcnt(2)
  v_cmp_u_f32 vcc, v20, v23
  s_cbranch_vccnz m_22_f13_0
m_22_n13_0:
  v_smfmac_f32_16x16x64_bf16 v[36:39], v[20:23], v[60:67], v7
  v_smfmac_f32_16x16x64_bf16 v[40:43], v[20:23], v[92:99], v7
  v_smfmac_f32_16x16x64_bf16 v[44:47], v[20:23], v[124:131], v7
  v_smfmac_f32_16x16x64_bf16 v[48:51], v[20:23], v[156:163], v7
  v_smfmac_f32_16x16x64_bf16 v[52:55], v[20:23], v[188:195], v7
  s_waitcnt vmcnt(1)
  v_cmp_u_f32 vcc, v28, v31
  v_smfmac_f32_16x16x64_bf16 v[56:59], v[20:23], v[220:227], v7
  s_cbranch_vccnz m_22_f12_2
  s_branch m_22_n12_2
m_22_n13_3:
  v_smfmac_f32_16x16x64_bf16 v[36:39], v[32:35], v[84:91], v7
  v_smfmac_f32_16x16x64_bf16 v[40:43], v[32:35], v[116:123], v7
  v_smfmac_f32_16x16x64_bf16 v[44:47], v[32:35], v[148:155], v7
  v_smfmac_f32_16x16x64_bf16 v[48:51], v[32:35], v[180:187], v7
  v_smfmac_f32_16x16x64_bf16 v[52:55], v[32:35], v[212:219], v7
  s_waitcnt vmcnt(1)
  v_cmp_u_f32 vcc, v20, v23
  v_smfmac_f32_16x16x64_bf16 v[56:59], v[32:35], v[244:251], v7
  s_cbranch_vccnz m_22_f5_0
m_22_n5_0:
  v_smfmac_f32_16x16x64_bf16 v[36:39], v[20:23], v[60:67], v7
  v_smfmac_f32_16x16x64_bf16 v[40:43], v[20:23], v[92:99], v7
  v_smfmac_f32_16x16x64_bf16 v[44:47], v[20:23], v[124:131], v7
  v_smfmac_f32_16x16x64_bf16 v[48:51], v[20:23], v[156:163], v7
  v_smfmac_f32_16x16x64_bf16 v[52:55], v[20:23], v[188:195], v7
  s_waitcnt vmcnt(0)
  v_cmp_u_f32 vcc, v28, v31
  v_smfmac_f32_16x16x64_bf16 v[56:59], v[20:23], v[220:227], v7
  s_cbranch_vccnz m_22_f4_2
  s_branch m_22_n4_2
m_22_f12_2:
  buffer_load_dwordx4 v[28:31], v2, s[24:27], s57 offen offset:2048 sc1
  s_waitcnt vmcnt(1)
  v_cmp_u_f32 vcc, v32, v35
  s_cbranch_vccz m_22_n12_3
m_22_f12_3:
  buffer_load_dwordx4 v[32:35], v2, s[24:27], s57 offen offset:3072 sc1
  s_sub_u32 s43, s43, 1
  s_cbranch_scc1 fused_kernel_fin
  s_waitcnt vmcnt(1)
  v_cmp_u_f32 vcc, v28, v31
  s_cbranch_vccnz m_22_f12_2
  s_branch m_22_n12_2
m_22_n12_3:
  v_smfmac_f32_16x16x64_bf16 v[36:39], v[32:35], v[84:91], v7
  v_smfmac_f32_16x16x64_bf16 v[40:43], v[32:35], v[116:123], v7
  v_smfmac_f32_16x16x64_bf16 v[44:47], v[32:35], v[148:155], v7
  v_smfmac_f32_16x16x64_bf16 v[48:51], v[32:35], v[180:187], v7
  v_smfmac_f32_16x16x64_bf16 v[52:55], v[32:35], v[212:219], v7
  s_waitcnt vmcnt(0)
  v_cmp_u_f32 vcc, v28, v31
  v_smfmac_f32_16x16x64_bf16 v[56:59], v[32:35], v[244:251], v7
  s_cbranch_vccnz m_22_f4_2
  s_branch m_22_n4_2
m_22_f11_0:
  buffer_load_dwordx4 v[20:23], v2, s[24:27], s57 offen offset:0 sc1
  s_waitcnt vmcnt(2)
  v_cmp_u_f32 vcc, v24, v27
  s_cbranch_vccz m_22_n11_1
m_22_f11_1:
  buffer_load_dwordx4 v[24:27], v2, s[24:27], s57 offen offset:1024 sc1
  s_waitcnt vmcnt(2)
  v_cmp_u_f32 vcc, v32, v35
  s_cbranch_vccz m_22_n11_3
m_22_f11_3:
  buffer_load_dwordx4 v[32:35], v2, s[24:27], s57 offen offset:3072 sc1
  s_sub_u32 s43, s43, 1
  s_cbranch_scc1 fused_kernel_fin
  s_waitcnt vmcnt(2)
  v_cmp_u_f32 vcc, v20, v23
  s_cbranch_vccnz m_22_f11_0
m_22_n11_0:
  v_smfmac_f32_16x16x64_bf16 v[36:39], v[20:23], v[60:67], v7
  v_smfmac_f32_16x16x64_bf16 v[40:43], v[20:23], v[92:99], v7
  v_smfmac_f32_16x16x64_bf16 v[44:47], v[20:23], v[124:131], v7
  v_smfmac_f32_16x16x64_bf16 v[48:51], v[20:23], v[156:163], v7
  v_smfmac_f32_16x16x64_bf16 v[52:55], v[20:23], v[188:195], v7
  s_waitcnt vmcnt(1)
  v_cmp_u_f32 vcc, v24, v27
  v_smfmac_f32_16x16x64_bf16 v[56:59], v[20:23], v[220:227], v7
  s_cbranch_vccnz m_22_f10_1
m_22_n10_1:
  v_smfmac_f32_16x16x64_bf16 v[36:39], v[24:27], v[68:75], v7
  v_smfmac_f32_16x16x64_bf16 v[40:43], v[24:27], v[100:107], v7
  v_smfmac_f32_16x16x64_bf16 v[44:47], v[24:27], v[132:139], v7
  v_smfmac_f32_16x16x64_bf16 v[48:51], v[24:27], v[164:171], v7
  v_smfmac_f32_16x16x64_bf16 v[52:55], v[24:27], v[196:203], v7
  s_waitcnt vmcnt(0)
  v_cmp_u_f32 vcc, v32, v35
  v_smfmac_f32_16x16x64_bf16 v[56:59], v[24:27], v[228:235], v7
  s_cbranch_vccnz m_22_f8_3
  s_branch m_22_n8_3
m_22_n11_1:
  v_smfmac_f32_16x16x64_bf16 v[36:39], v[24:27], v[68:75], v7
  v_smfmac_f32_16x16x64_bf16 v[40:43], v[24:27], v[100:107], v7
  v_smfmac_f32_16x16x64_bf16 v[44:47], v[24:27], v[132:139], v7
  v_smfmac_f32_16x16x64_bf16 v[48:51], v[24:27], v[164:171], v7
  v_smfmac_f32_16x16x64_bf16 v[52:55], v[24:27], v[196:203], v7
  s_waitcnt vmcnt(1)
  v_cmp_u_f32 vcc, v32, v35
  v_smfmac_f32_16x16x64_bf16 v[56:59], v[24:27], v[228:235], v7
  s_cbranch_vccnz m_22_f9_3
  s_branch m_22_n9_3
m_22_f10_1:
  buffer_load_dwordx4 v[24:27], v2, s[24:27], s57 offen offset:1024 sc1
  s_waitcnt vmcnt(1)
  v_cmp_u_f32 vcc, v32, v35
  s_cbranch_vccz m_22_n10_3
m_22_f10_3:
  buffer_load_dwordx4 v[32:35], v2, s[24:27], s57 offen offset:3072 sc1
  s_sub_u32 s43, s43, 1
  s_cbranch_scc1 fused_kernel_fin
  s_waitcnt vmcnt(1)
  v_cmp_u_f32 vcc, v24, v27
  s_cbranch_vccnz m_22_f10_1
  s_branch m_22_n10_1
m_22_f9_0:
  buffer_load_dwordx4 v[20:23], v2, s[24:27], s57 offen offset:0 sc1
  s_waitcnt vmcnt(1)
  v_cmp_u_f32 vcc, v32, v35
  s_cbranch_vccz m_22_n9_3
m_22_f9_3:
  buffer_load_dwordx4 v[32:35], v2, s[24:27], s57 offen offset:3072 sc1
  s_sub_u32 s43, s43, 1
  s_cbranch_scc1 fused_kernel_fin
  s_waitcnt vmcnt(1)
  v_cmp_u_f32 vcc, v20, v23
  s_cbranch_vccnz m_22_f9_0
m_22_n9_0:
  v_smfmac_f32_16x16x64_bf16 v[36:39], v[20:23], v[60:67], v7
  v_smfmac_f32_16x16x64_bf16 v[40:43], v[20:23], v[92:99], v7
  v_smfmac_f32_16x16x64_bf16 v[44:47], v[20:23], v[124:131], v7
  v_smfmac_f32_16x16x64_bf16 v[48:51], v[20:23], v[156:163], v7
  v_smfmac_f32_16x16x64_bf16 v[52:55], v[20:23], v[188:195], v7
  s_waitcnt vmcnt(0)
  v_cmp_u_f32 vcc, v32, v35
  v_smfmac_f32_16x16x64_bf16 v[56:59], v[20:23], v[220:227], v7
  s_cbranch_vccnz m_22_f8_3
  s_branch m_22_n8_3
m_22_f8_3:
  buffer_load_dwordx4 v[32:35], v2, s[24:27], s57 offen offset:3072 sc1
  s_sub_u32 s43, s43, 1
  s_cbranch_scc1 fused_kernel_fin
  s_waitcnt vmcnt(0)
  v_cmp_u_f32 vcc, v32, v35
  s_cbranch_vccnz m_22_f8_3
  s_branch m_22_n8_3
m_22_f7_0:
  buffer_load_dwordx4 v[20:23], v2, s[24:27], s57 offen offset:0 sc1
  s_waitcnt vmcnt(2)
  v_cmp_u_f32 vcc, v24, v27
  s_cbranch_vccz m_22_n7_1
m_22_f7_1:
  buffer_load_dwordx4 v[24:27], v2, s[24:27], s57 offen offset:1024 sc1
  s_waitcnt vmcnt(2)
  v_cmp_u_f32 vcc, v28, v31
  s_cbranch_vccz m_22_n7_2
m_22_f7_2:
  buffer_load_dwordx4 v[28:31], v2, s[24:27], s57 offen offset:2048 sc1
  s_sub_u32 s43, s43, 1
  s_cbranch_scc1 fused_kernel_fin
  s_waitcnt vmcnt(2)
  v_cmp_u_f32 vcc, v20, v23
  s_cbranch_vccnz m_22_f7_0
  s_branch m_22_n7_0
m_22_n7_1:
  v_smfmac_f32_16x16x64_bf16 v[36:39], v[24:27], v[68:75], v7
  v_smfmac_f32_16x16x64_bf16 v[40:43], v[24:27], v[100:107], v7
  v_smfmac_f32_16x16x64_bf16 v[44:47], v[24:27], v[132:139], v7
  v_smfmac_f32_16x16x64_bf16 v[48:51], v[24:27], v[164:171], v7
  v_smfmac_f32_16x16x64_bf16 v[52:55], v[24:27], v[196:203], v7
  s_waitcnt vmcnt(1)
  v_cmp_u_f32 vcc, v28, v31
  v_smfmac_f32_16x16x64_bf16 v[56:59], v[24:27], v[228:235], v7
  s_cbranch_vccnz m_22_f5_2
m_22_n5_2:
  v_smfmac_f32_16x16x64_bf16 v[36:39], v[28:31], v[76:83], v7
  v_smfmac_f32_16x16x64_bf16 v[40:43], v[28:31], v[108:115], v7
  v_smfmac_f32_16x16x64_bf16 v[44:47], v[28:31], v[140:147], v7
  v_smfmac_f32_16x16x64_bf16 v[48:51], v[28:31], v[172:179], v7
  v_smfmac_f32_16x16x64_bf16 v[52:55], v[28:31], v[204:211], v7
  s_waitcnt vmcnt(0)
  v_cmp_u_f32 vcc, v20, v23
  v_smfmac_f32_16x16x64_bf16 v[56:59], v[28:31], v[236:243], v7
  s_cbranch_vccnz m_22_f1_0
  s_branch m_22_n1_0
m_22_n7_2:
  v_smfmac_f32_16x16x64_bf16 v[36:39], v[28:31], v[76:83], v7
  v_smfmac_f32_16x16x64_bf16 v[40:43], v[28:31], v[108:115], v7
  v_smfmac_f32_16x16x64_bf16 v[44:47], v[28:31], v[140:147], v7
  v_smfmac_f32_16x16x64_bf16 v[48:51], v[28:31], v[172:179], v7
  v_smfmac_f32_16x16x64_bf16 v[52:55], v[28:31], v[204:211], v7
  s_waitcnt vmcnt(1)
  v_cmp_u_f32 vcc, v20, v23
  v_smfmac_f32_16x16x64_bf16 v[56:59], v[28:31], v[236:243], v7
  s_cbranch_vccnz m_22_f3_0
  s_branch m_22_n3_0
m_22_f6_1:
  buffer_load_dwordx4 v[24:27], v2, s[24:27], s57 offen offset:1024 sc1
  s_waitcnt vmcnt(1)
  v_cmp_u_f32 vcc, v28, v31
  s_cbranch_vccz m_22_n6_2
m_22_f6_2:
  buffer_load_dwordx4 v[28:31], v2, s[24:27], s57 offen offset:2048 sc1
  s_sub_u32 s43, s43, 1
  s_cbranch_scc1 fused_kernel_fin
  s_waitcnt vmcnt(1)
  v_cmp_u_f32 vcc, v24, v27
  s_cbranch_vccnz m_22_f6_1
  s_branch m_22_n6_1
m_22_n6_2:
  v_smfmac_f32_16x16x64_bf16 v[36:39], v[28:31], v[76:83], v7
  v_smfmac_f32_16x16x64_bf16 v[40:43], v[28:31], v[108:115], v7
  v_smfmac_f32_16x16x64_bf16 v[44:47], v[28:31], v[140:147], v7
  v_smfmac_f32_16x16x64_bf16 v[48:51], v[28:31], v[172:179], v7
  v_smfmac_f32_16x16x64_bf16 v[52:55], v[28:31], v[204:211], v7
  s_waitcnt vmcnt(0)
  v_cmp_u_f32 vcc, v24, v27
  v_smfmac_f32_16x16x64_bf16 v[56:59], v[28:31], v[236:243], v7
  s_cbranch_vccnz m_22_f2_1
  s_branch m_22_n2_1
m_22_f5_0:
  buffer_load_dwordx4 v[20:23], v2, s[24:27], s57 offen offset:0 sc1
  s_waitcnt vmcnt(1)
  v_cmp_u_f32 vcc, v28, v31
  s_cbranch_vccz m_22_n5_2
m_22_f5_2:
  buffer_load_dwordx4 v[28:31], v2, s[24:27], s57 offen offset:2048 sc1
  s_sub_u32 s43, s43, 1
  s_cbranch_scc1 fused_kernel_fin
  s_waitcnt vmcnt(1)
  v_cmp_u_f32 vcc, v20, v23
  s_cbranch_vccnz m_22_f5_0
  s_branch m_22_n5_0
m_22_f4_2:
  buffer_load_dwordx4 v[28:31], v2, s[24:27], s57 offen offset:2048 sc1
  s_sub_u32 s43, s43, 1
  s_cbranch_scc1 fused_kernel_fin
  s_waitcnt vmcnt(0)
  v_cmp_u_f32 vcc, v28, v31
  s_cbranch_vccnz m_22_f4_2
  s_branch m_22_n4_2
m_22_f3_0:
  buffer_load_dwordx4 v[20:23], v2, s[24:27], s57 offen offset:0 sc1
  s_waitcnt vmcnt(1)
  v_cmp_u_f32 vcc, v24, v27
  s_cbranch_vccz m_22_n3_1
m_22_f3_1:
  buffer_load_dwordx4 v[24:27], v2, s[24:27], s57 offen offset:1024 sc1
  s_sub_u32 s43, s43, 1
  s_cbranch_scc1 fused_kernel_fin
  s_waitcnt vmcnt(1)
  v_cmp_u_f32 vcc, v20, v23
  s_cbranch_vccnz m_22_f3_0
  s_branch m_22_n3_0
m_22_n3_1:
  v_smfmac_f32_16x16x64_bf16 v[36:39], v[24:27], v[68:75], v7
  v_smfmac_f32_16x16x64_bf16 v[40:43], v[24:27], v[100:107], v7
  v_smfmac_f32_16x16x64_bf16 v[44:47], v[24:27], v[132:139], v7
  v_smfmac_f32_16x16x64_bf16 v[48:51], v[24:27], v[164:171], v7
  v_smfmac_f32_16x16x64_bf16 v[52:55], v[24:27], v[196:203], v7
  s_waitcnt vmcnt(0)
  v_cmp_u_f32 vcc, v20, v23
  v_smfmac_f32_16x16x64_bf16 v[56:59], v[24:27], v[228:235], v7
  s_cbranch_vccnz m_22_f1_0
  s_branch m_22_n1_0
m_22_f2_1:
  buffer_load_dwordx4 v[24:27], v2, s[24:27], s57 offen offset:1024 sc1
  s_sub_u32 s43, s43, 1
  s_cbranch_scc1 fused_kernel_fin
  s_waitcnt vmcnt(0)
  v_cmp_u_f32 vcc, v24, v27
  s_cbranch_vccnz m_22_f2_1
  s_branch m_22_n2_1
m_22_f1_0:
  buffer_load_dwordx4 v[20:23], v2, s[24:27], s57 offen offset:0 sc1
  s_sub_u32 s43, s43, 1
  s_cbranch_scc1 fused_kernel_fin
  s_waitcnt vmcnt(0)
  v_cmp_u_f32 vcc, v20, v23
  s_cbranch_vccnz m_22_f1_0
  s_branch m_22_n1_0
b_top_29:
  s_cmp_lg_u32 s40, 63
  s_cbranch_scc1 b_top_29n
  s_buffer_load_dword s66, s[24:27], s65 glc
b_top_29n:
  s_sleep 3
  s_cbranch_vccnz b_pg_39
b_pg2_40:
  s_sleep 7
  s_setprio 2
  buffer_load_dwordx4 v[24:27], v2, s[24:27], s56 offen sc1
  s_sleep 2
  s_mov_b32 m0, s59
  s_nop 0
  buffer_load_dwordx4 v2, s[24:27], s58 offen offset:0 lds
  buffer_load_dwordx4 v2, s[24:27], s58 offen offset:1024 lds
  buffer_load_dwordx4 v2, s[24:27], s58 offen offset:2048 lds
  buffer_load_dwordx4 v2, s[24:27], s58 offen offset:3072 lds
  s_add_u32 m0, s59, 4096
  s_add_u32 s58, s58, 4096
  buffer_store_dword v10, v9, s[24:27], s44 offen sc1
  buffer_store_dwordx2 v[10:11], v0, s[24:27], s45 offen sc1
  s_waitcnt vmcnt(6)
  v_mfma_f32_16x16x32_bf16 v[28:31], v[16:19], v[24:27], 0
  s_nop 7
  v_add_f32_dpp v28, v28, v28 row_ror:8 row_mask:0xf bank_mask:0xf
  v_add_f32_dpp v29, v29, v29 row_ror:8 row_mask:0xf bank_mask:0xf
  v_cmp_u_f32 vcc, v28, v28
  v_cvt_pk_bf16_f32 v12, v28, v29
  s_cbranch_vccnz b_pa_30
b_pa_30x:
  buffer_store_dword v12, v9, s[24:27], s68 offen sc1
b_pa_30y:
  s_sleep 3
b_pa_30z:
  buffer_load_dwordx4 v[20:23], v2, s[24:27], s57 offen offset:0 sc1
  buffer_load_dwordx4 v[24:27], v2, s[24:27], s57 offen offset:1024 sc1
  buffer_load_dwordx4 v[28:31], v2, s[24:27], s57 offen offset:2048 sc1
  buffer_load_dwordx4 v[32:35], v2, s[24:27], s57 offen offset:3072 sc1
  s_waitcnt vmcnt(3)
  v_cmp_u_f32 vcc, v20, v23
  s_cbranch_vccnz m_41_p0_0
b_ent1_8:
m_41_s0_0:
  v_smfmac_f32_16x16x64_bf16 v[36:39], v[20:23], v[60:67], v7
  v_smfmac_f32_16x16x64_bf16 v[40:43], v[20:23], v[92:99], v7
  v_smfmac_f32_16x16x64_bf16 v[44:47], v[20:23], v[124:131], v7
  s_waitcnt vmcnt(2)
  v_cmp_u_f32 vcc, v24, v27
  v_smfmac_f32_16x16x64_bf16 v[48:51], v[20:23], v[156:163], v7
  s_cbranch_vccnz m_41_p0_1
m_41_s0_1:
  v_smfmac_f32_16x16x64_bf16 v[36:39], v[24:27], v[68:75], v7
  v_smfmac_f32_16x16x64_bf16 v[40:43], v[24:27], v[100:107], v7
  v_smfmac_f32_16x16x64_bf16 v[44:47], v[24:27], v[132:139], v7
  s_waitcnt vmcnt(1)
  v_cmp_u_f32 vcc, v28, v31
  v_smfmac_f32_16x16x64_bf16 v[48:51], v[24:27], v[164:171], v7
  s_cbranch_vccnz m_41_p0_2
m_41_s0_2:
  v_smfmac_f32_16x16x64_bf16 v[36:39], v[28:31], v[76:83], v7
  v_smfmac_f32_16x16x64_bf16 v[40:43], v[28:31], v[108:115], v7
  v_smfmac_f32_16x16x64_bf16 v[44:47], v[28:31], v[140:147], v7
  s_waitcnt vmcnt(0)
  v_cmp_u_f32 vcc, v32, v35
  v_smfmac_f32_16x16x64_bf16 v[48:51], v[28:31], v[172:179], v7
  s_cbranch_vccnz m_41_p0_3
m_41_s0_3:
  v_smfmac_f32_16x16x64_bf16 v[36:39], v[32:35], v[84:91], v7
  buffer_load_dwordx4 v2, s[24:27], s58 offen offset:0 lds
  v_smfmac_f32_16x16x64_bf16 v[40:43], v[32:35], v[116:123], v7
  buffer_load_dwordx4 v2, s[24:27], s58 offen offset:1024 lds
  v_smfmac_f32_16x16x64_bf16 v[44:47], v[32:35], v[148:155], v7
  v_smfmac_f32_16x16x64_bf16 v[48:51], v[32:35], v[180:187], v7
  v_smfmac_f32_16x16x64_bf16 v[52:55], v[20:23], v[188:195], v7
  s_nop 1
  v_add_f32 v36, v36, v38
  v_add_f32 v37, v37, v39
  v_cvt_pk_bf16_f32 v38, v36, v37
  v_smfmac_f32_16x16x64_bf16 v[56:59], v[20:23], v[220:227], v7
  ds_write_b32 v4, v38 offset:0
  v_add_f32 v40, v40, v42
  v_add_f32 v41, v41, v43
  v_smfmac_f32_16x16x64_bf16 v[52:55], v[24:27], v[196:203], v7
  v_cvt_pk_bf16_f32 v42, v40, v41
  ds_write_b32 v4, v42 offset:640
  v_add_f32 v44, v44, v46
  v_smfmac_f32_16x16x64_bf16 v[56:59], v[24:27], v[228:235], v7
  v_add_f32 v45, v45, v47
  v_cvt_pk_bf16_f32 v46, v44, v45
  ds_write_b32 v4, v46 offset:2560
  v_smfmac_f32_16x16x64_bf16 v[52:55], v[28:31], v[204:211], v7
  v_add_f32 v48, v48, v50
  v_add_f32 v49, v49, v51
  v_cvt_pk_bf16_f32 v50, v48, v49
  v_smfmac_f32_16x16x64_bf16 v[56:59], v[28:31], v[236:243], v7
  ds_write_b32 v4, v50 offset:3200
  v_smfmac_f32_16x16x64_bf16 v[52:55], v[32:35], v[212:219], v7
  v_smfmac_f32_16x16x64_bf16 v[56:59], v[32:35], v[244:251], v7
  buffer_load_dwordx4 v2, s[24:27], s58 offen offset:2048 lds
  buffer_load_dwordx4 v2, s[24:27], s58 offen offset:3072 lds
  s_nop 4
  v_add_f32 v52, v52, v54
  v_add_f32 v53, v53, v55
  ds_write2_b32 v5, v52, v53 offset0:0 offset1:16
  v_add_f32 v56, v56, v58
  v_add_f32 v57, v57, v59
  ds_write2_b32 v5, v56, v57 offset0:128 offset1:144
b_post_32:
  s_waitcnt lgkmcnt(0)
  s_barrier
  ds_read2st64_b32 v[20:21], v6 offset0:0 offset1:4
  ds_read2st64_b32 v[22:23], v6 offset0:8 offset1:12
  s_add_u32 s40, s40, 1
  s_waitcnt lgkmcnt(1)
  v_add_f32 v20, v20, v21
  s_waitcnt lgkmcnt(0)
  v_add_f32 v22, v22, v23
  v_add_f32 v20, v20, v22
  v_cvt_pk_bf16_f32 v12, v20, v20
  buffer_store_short v12, v3, s[24:27], s70 offen sc1
  s_setprio 0
  ds_read_b32 v254, v8
  v_add_u32 v1, s73, v2
  s_lshr_b32 s44, s73, 3
  s_and_b32 s44, s44, 2048
  v_add_u32 v13, s44, v0
  s_xor_b32 s73, s73, 16384
  ds_read_b128 v[20:23], v1 offset:0
  ds_read_b64 v[44:45], v13 offset:28672
  ds_read_b128 v[24:27], v1 offset:4096
  ds_read_b64 v[46:47], v13 offset:29184
  ds_read_b128 v[28:31], v1 offset:8192
  ds_read_b64 v[48:49], v13 offset:29696
  ds_read_b128 v[32:35], v1 offset:12288
  ds_read_b64 v[50:51], v13 offset:30208
  s_waitcnt lgkmcnt(6)
  v_lshlrev_b32 v52, 16, v20
  v_and_b32 v20, 0xffff0000, v20
  v_lshlrev_b32 v53, 16, v21
  v_and_b32 v21, 0xffff0000, v21
  v_lshlrev_b32 v54, 16, v22
  v_and_b32 v22, 0xffff0000, v22
  v_lshlrev_b32 v55, 16, v23
  v_and_b32 v23, 0xffff0000, v23
  v_mul_f32 v36, v52, v44
  v_mul_f32 v37, v20, v44
  v_mul_f32 v38, v53, v44
  v_mul_f32 v39, v21, v44
  v_mul_f32 v40, v54, v45
  v_mul_f32 v41, v22, v45
  v_mul_f32 v42, v55, v45
  v_mul_f32 v43, v23, v45
  s_waitcnt lgkmcnt(4)
  v_lshlrev_b32 v52, 16, v24
  v_and_b32 v24, 0xffff0000, v24
  v_lshlrev_b32 v53, 16, v25
  v_and_b32 v25, 0xffff0000, v25
  v_lshlrev_b32 v54, 16, v26
  v_and_b32 v26, 0xffff0000, v26
  v_lshlrev_b32 v55, 16, v27
  v_and_b32 v27, 0xffff0000, v27
  v_fmac_f32 v36, v52, v46
  v_fmac_f32 v37, v24, v46
  v_fmac_f32 v38, v53, v46
  v_fmac_f32 v39, v25, v46
  v_fmac_f32 v40, v54, v47
  v_fmac_f32 v41, v26, v47
  v_fmac_f32 v42, v55, v47
  v_fmac_f32 v43, v27, v47
  s_waitcnt lgkmcnt(2)
  v_lshlrev_b32 v52, 16, v28
  v_and_b32 v28, 0xffff0000, v28
  v_lshlrev_b32 v53, 16, v29
  v_and_b32 v29, 0xffff0000, v29
  v_lshlrev_b32 v54, 16, v30
  v_and_b32 v30, 0xffff0000, v30
  v_lshlrev_b32 v55, 16, v31
  v_and_b32 v31, 0xffff0000, v31
  v_fmac_f32 v36, v52, v48
  v_fmac_f32 v37, v28, v48
  v_fmac_f32 v38, v53, v48
  v_fmac_f32 v39, v29, v48
  v_fmac_f32 v40, v54, v49
  v_fmac_f32 v41, v30, v49
  v_fmac_f32 v42, v55, v49
  v_fmac_f32 v43, v31, v49
  s_waitcnt lgkmcnt(0)
  v_lshlrev_b32 v52, 16, v32
  v_and_b32 v32, 0xffff0000, v32
  v_lshlrev_b32 v53, 16, v33
  v_and_b32 v33, 0xffff0000, v33
  v_lshlrev_b32 v54, 16, v34
  v_and_b32 v34, 0xffff0000, v34
  v_lshlrev_b32 v55, 16, v35
  v_and_b32 v35, 0xffff0000, v35
  v_fmac_f32 v36, v52, v50
  v_fmac_f32 v37, v32, v50
  v_fmac_f32 v38, v53, v50
  v_fmac_f32 v39, v33, v50
  v_fmac_f32 v40, v54, v51
  v_fmac_f32 v41, v34, v51
  v_fmac_f32 v42, v55, v51
  v_fmac_f32 v43, v35, v51
  v_cvt_pk_bf16_f32 v20, v36, v37
  v_cvt_pk_bf16_f32 v21, v38, v39
  v_cvt_pk_bf16_f32 v22, v40, v41
  v_cvt_pk_bf16_f32 v23, v42, v43
  v_mov_b32 v36, 0
  v_mov_b32 v37, 0
  v_mov_b32 v38, 0
  v_mov_b32 v39, 0
  v_mov_b32 v40, 0
  v_mov_b32 v41, 0
  v_mov_b32 v42, 0
  v_mov_b32 v43, 0
  v_mov_b32 v44, 0
  v_mov_b32 v45, 0
  v_mov_b32 v46, 0
  v_mov_b32 v47, 0
  v_mov_b32 v48, 0
  v_mov_b32 v49, 0
  v_mov_b32 v50, 0
  v_mov_b32 v51, 0
  v_mov_b32 v52, 0
  v_mov_b32 v53, 0
  v_mov_b32 v54, 0
  v_mov_b32 v55, 0
  v_mov_b32 v56, 0
  v_mov_b32 v57, 0
  v_mov_b32 v58, 0
  v_mov_b32 v59, 0
  s_add_u32 s44, s67, s42
  s_add_u32 s45, s71, s42
  s_add_u32 s46, s49, s42
  s_add_u32 s56, s54, s41
  s_add_u32 s41, s41, 262144
  s_and_b32 s41, s41, 786432
  s_xor_b32 s42, s41, 524288
  s_add_u32 s57, s55, s41
  s_add_u32 s68, s67, s41
  s_add_u32 s70, s69, s41
  s_add_u32 s58, s58, 258048
  s_xor_b32 s59, s59, 32768
  v_readlane_b32 s50, v254, 63
  s_lshl_b32 s47, s40, 18
  s_add_u32 s47, s47, 262144
  s_max_u32 s64, s64, s47
  s_cmp_lt_u32 s64, s50
  s_cselect_b32 s48, s64, 1073741824
  s_cselect_b32 s52, 262144, 0
  s_add_u32 s64, s64, s52
  s_add_u32 s47, s47, 524288
  s_min_u32 s52, s47, s50
  s_cmp_lt_u32 s64, s52
  s_cselect_b32 s52, 2, 0
  s_cmp_eq_u32 s20, 0
  s_cbranch_scc1 b_ck_42
b_ck_42x:
  s_waitcnt vmcnt(0)
b_f_31:
  ds_read_b32 v1, v8
  s_sub_u32 s43, s43, 1
  s_cbranch_scc1 fused_kernel_fin
  s_waitcnt lgkmcnt(0)
  v_cmp_gt_u32 vcc, s40, v1
  s_cbranch_vccnz b_f_31
  buffer_load_dword v253, v252, s[24:27], s48 offen
  buffer_store_dwordx4 v[20:23], v2, s[24:27], s72 offen sc1
  buffer_store_dword v10, v14, s[24:27], s46 offen sc1
  s_cmp_lg_u32 s52, 0
  s_cbranch_scc1 b_ac_46
b_b2_43:
  s_barrier
  s_add_u32 s72, s72, 65536
  s_bitset0_b32 s72, 30
  s_cmp_eq_u32 s40, 64
  s_cbranch_scc0 b_top_29
  s_branch b_fin_9
b_ac_46:
  s_and_b32 vcc_lo, s52, 1
  s_bitcmp0_b32 s52, 2
  s_cbranch_scc1 b_ac_461
  s_buffer_load_dword s62, s[24:27], s61 glc
b_ac_461:
  s_bitcmp0_b32 s52, 1
  s_cbranch_scc1 b_ac_462
  buffer_load_dword v253, v252, s[24:27], s64 offen
  s_add_u32 s64, s64, 262144
b_ac_462:
  s_bitcmp0_b32 s52, 3
  s_cbranch_scc1 b_b2_43
b_rw_47:
  buffer_load_dword v1, off, s[24:27], s61 sc1
  s_sub_u32 s43, s43, 1
  s_cbranch_scc1 fused_kernel_fin
  s_waitcnt vmcnt(0)
  v_cmp_gt_u32 vcc, 12, v1
  s_cbranch_vccnz b_rw_47
  s_mov_b32 s62, 0
  s_add_u32 s61, s61, 128
  s_add_u32 s47, s50, 1048576
  s_cmp_eq_u32 s47, 16777216
  s_cselect_b32 s47, 33554432, s47
  v_mov_b32 v1, 24608
  v_mov_b32 v12, s47
  ds_write_b32 v1, v12
  s_and_b32 vcc_lo, s52, 1
  s_waitcnt lgkmcnt(0)
  s_branch b_b2_43
b_ck_42:
  s_add_u32 s47, s47, 262144
  s_cmp_ge_u32 s47, s50
  s_cbranch_scc1 b_ck_421
b_ck_422:
  s_and_b32 s47, s40, 7
  s_cmp_gt_u32 s40, 57
  s_cselect_b32 s47, 2, s47
  s_cmp_eq_u32 s47, 2
  s_addc_u32 s52, s52, 0
  s_branch b_ck_42x
b_ck_421:
  s_cmp_ge_u32 s62, 12
  s_cbranch_scc1 b_c3_45
  s_sub_u32 s47, s47, 786432
  s_cmp_ge_u32 s47, s50
  s_cbranch_scc1 b_c2_44
  s_bitset1_b32 s52, 2
  s_branch b_ck_422
b_c2_44:
  s_bitset1_b32 s52, 3
  s_branch b_ck_422
b_c3_45:
  s_mov_b32 s62, 0
  s_add_u32 s61, s61, 128
  s_add_u32 s47, s50, 1048576
  s_cmp_eq_u32 s47, 16777216
  s_cselect_b32 s47, 33554432, s47
  v_mov_b32 v1, 24608
  v_mov_b32 v12, s47
  ds_write_b32 v1, v12
  s_branch b_ck_422
b_pg_39:
  s_sub_u32 s47, s40, 2
  v_mov_b32 v1, s47
  s_mov_b64 exec, 1
  buffer_store_dword v1, off, s[24:27], s63 sc1
  s_mov_b64 exec, -1
  s_branch b_pg2_40
b_pa_30:
  buffer_load_dwordx4 v[24:27], v2, s[24:27], s56 offen sc1
  s_sub_u32 s43, s43, 1
  s_cbranch_scc1 fused_kernel_fin
  s_waitcnt vmcnt(0)
  v_mfma_f32_16x16x32_bf16 v[28:31], v[16:19], v[24:27], 0
  s_nop 7
  v_add_f32_dpp v28, v28, v28 row_ror:8 row_mask:0xf bank_mask:0xf
  v_add_f32_dpp v29, v29, v29 row_ror:8 row_mask:0xf bank_mask:0xf
  v_cmp_u_f32 vcc, v28, v28
  v_cvt_pk_bf16_f32 v12, v28, v29
  s_cbranch_vccnz b_pa_30
  buffer_store_dword v12, v9, s[24:27], s68 offen sc1
  s_sleep 2
  s_branch b_pa_30z
m_41_p0_0:
  buffer_load_dwordx4 v[20:23], v2, s[24:27], s57 offen offset:0 sc1
  s_waitcnt vmcnt(3)
  v_cmp_u_f32 vcc, v24, v27
  s_cbranch_vccnz m_41_p1_1
m_41_s1_1:
  v_smfmac_f32_16x16x64_bf16 v[36:39], v[24:27], v[68:75], v7
  v_smfmac_f32_16x16x64_bf16 v[40:43], v[24:27], v[100:107], v7
  v_smfmac_f32_16x16x64_bf16 v[44:47], v[24:27], v[132:139], v7
  s_waitcnt vmcnt(2)
  v_cmp_u_f32 vcc, v28, v31
  v_smfmac_f32_16x16x64_bf16 v[48:51], v[24:27], v[164:171], v7
  s_cbranch_vccnz m_41_p1_2
m_41_s1_2:
  v_smfmac_f32_16x16x64_bf16 v[36:39], v[28:31], v[76:83], v7
  v_smfmac_f32_16x16x64_bf16 v[40:43], v[28:31], v[108:115], v7
  v_smfmac_f32_16x16x64_bf16 v[44:47], v[28:31], v[140:147], v7
  s_waitcnt vmcnt(1)
  v_cmp_u_f32 vcc, v32, v35
  v_smfmac_f32_16x16x64_bf16 v[48:51], v[28:31], v[172:179], v7
  s_cbranch_vccnz m_41_p1_3
m_41_s1_3:
  v_smfmac_f32_16x16x64_bf16 v[36:39], v[32:35], v[84:91], v7
  v_smfmac_f32_16x16x64_bf16 v[40:43], v[32:35], v[116:123], v7
  v_smfmac_f32_16x16x64_bf16 v[44:47], v[32:35], v[148:155], v7
  v_smfmac_f32_16x16x64_bf16 v[48:51], v[32:35], v[180:187], v7
  v_smfmac_f32_16x16x64_bf16 v[52:55], v[24:27], v[196:203], v7
  v_smfmac_f32_16x16x64_bf16 v[56:59], v[24:27], v[228:235], v7
  v_smfmac_f32_16x16x64_bf16 v[52:55], v[28:31], v[204:211], v7
  v_smfmac_f32_16x16x64_bf16 v[56:59], v[28:31], v[236:243], v7
  v_smfmac_f32_16x16x64_bf16 v[52:55], v[32:35], v[212:219], v7
  v_smfmac_f32_16x16x64_bf16 v[56:59], v[32:35], v[244:251], v7
  s_waitcnt vmcnt(0)
  v_cmp_u_f32 vcc, v20, v23
  s_cbranch_vccnz m_41_f1_0
  s_branch m_41_n1_0
m_41_p0_1:
  buffer_load_dwordx4 v[24:27], v2, s[24:27], s57 offen offset:1024 sc1
  s_waitcnt vmcnt(2)
  v_cmp_u_f32 vcc, v28, v31
  s_cbranch_vccnz m_41_p2_2
m_41_s2_2:
  v_smfmac_f32_16x16x64_bf16 v[36:39], v[28:31], v[76:83], v7
  v_smfmac_f32_16x16x64_bf16 v[40:43], v[28:31], v[108:115], v7
  v_smfmac_f32_16x16x64_bf16 v[44:47], v[28:31], v[140:147], v7
  s_waitcnt vmcnt(1)
  v_cmp_u_f32 vcc, v32, v35
  v_smfmac_f32_16x16x64_bf16 v[48:51], v[28:31], v[172:179], v7
  s_cbranch_vccnz m_41_p2_3
m_41_s2_3:
  v_smfmac_f32_16x16x64_bf16 v[36:39], v[32:35], v[84:91], v7
  v_smfmac_f32_16x16x64_bf16 v[40:43], v[32:35], v[116:123], v7
  v_smfmac_f32_16x16x64_bf16 v[44:47], v[32:35], v[148:155], v7
  v_smfmac_f32_16x16x64_bf16 v[48:51], v[32:35], v[180:187], v7
  v_smfmac_f32_16x16x64_bf16 v[52:55], v[20:23], v[188:195], v7
  v_smfmac_f32_16x16x64_bf16 v[56:59], v[20:23], v[220:227], v7
  v_smfmac_f32_16x16x64_bf16 v[52:55], v[28:31], v[204:211], v7
  v_smfmac_f32_16x16x64_bf16 v[56:59], v[28:31], v[236:243], v7
  v_smfmac_f32_16x16x64_bf16 v[52:55], v[32:35], v[212:219], v7
  v_smfmac_f32_16x16x64_bf16 v[56:59], v[32:35], v[244:251], v7
  s_waitcnt vmcnt(0)
  v_cmp_u_f32 vcc, v24, v27
  s_cbranch_vccnz m_41_f2_1
  s_branch m_41_n2_1
m_41_p1_1:
  buffer_load_dwordx4 v[24:27], v2, s[24:27], s57 offen offset:1024 sc1
  s_waitcnt vmcnt(3)
  v_cmp_u_f32 vcc, v28, v31
  s_cbranch_vccnz m_41_p3_2
m_41_s3_2:
  v_smfmac_f32_16x16x64_bf16 v[36:39], v[28:31], v[76:83], v7
  v_smfmac_f32_16x16x64_bf16 v[40:43], v[28:31], v[108:115], v7
  v_smfmac_f32_16x16x64_bf16 v[44:47], v[28:31], v[140:147], v7
  s_waitcnt vmcnt(2)
  v_cmp_u_f32 vcc, v32, v35
  v_smfmac_f32_16x16x64_bf16 v[48:51], v[28:31], v[172:179], v7
  s_cbranch_vccnz m_41_p3_3
m_41_s3_3:
  v_smfmac_f32_16x16x64_bf16 v[36:39], v[32:35], v[84:91], v7
  v_smfmac_f32_16x16x64_bf16 v[40:43], v[32:35], v[116:123], v7
  v_smfmac_f32_16x16x64_bf16 v[44:47], v[32:35], v[148:155], v7
  v_smfmac_f32_16x16x64_bf16 v[48:51], v[32:35], v[180:187], v7
  v_smfmac_f32_16x16x64_bf16 v[52:55], v[28:31], v[204:211], v7
  v_smfmac_f32_16x16x64_bf16 v[56:59], v[28:31], v[236:243], v7
  v_smfmac_f32_16x16x64_bf16 v[52:55], v[32:35], v[212:219], v7
  v_smfmac_f32_16x16x64_bf16 v[56:59], v[32:35], v[244:251], v7
  s_waitcnt vmcnt(1)
  v_cmp_u_f32 vcc, v20, v23
  s_cbranch_vccnz m_41_f3_0
  s_branch m_41_n3_0
m_41_p0_2:
  buffer_load_dwordx4 v[28:31], v2, s[24:27], s57 offen offset:2048 sc1
  s_waitcnt vmcnt(1)
  v_cmp_u_f32 vcc, v32, v35
  s_cbranch_vccnz m_41_p4_3
m_41_s4_3:
  v_smfmac_f32_16x16x64_bf16 v[36:39], v[32:35], v[84:91], v7
  v_smfmac_f32_16x16x64_bf16 v[40:43], v[32:35], v[116:123], v7
  v_smfmac_f32_16x16x64_bf16 v[44:47], v[32:35], v[148:155], v7
  v_smfmac_f32_16x16x64_bf16 v[48:51], v[32:35], v[180:187], v7
  v_smfmac_f32_16x16x64_bf16 v[52:55], v[20:23], v[188:195], v7
  v_smfmac_f32_16x16x64_bf16 v[56:59], v[20:23], v[220:227], v7
  v_smfmac_f32_16x16x64_bf16 v[52:55], v[24:27], v[196:203], v7
  v_smfmac_f32_16x16x64_bf16 v[56:59], v[24:27], v[228:235], v7
  v_smfmac_f32_16x16x64_bf16 v[52:55], v[32:35], v[212:219], v7
  v_smfmac_f32_16x16x64_bf16 v[56:59], v[32:35], v[244:251], v7
  s_waitcnt vmcnt(0)
  v_cmp_u_f32 vcc, v28, v31
  s_cbranch_vccnz m_41_f4_2
  s_branch m_41_n4_2
m_41_p1_2:
  buffer_load_dwordx4 v[28:31], v2, s[24:27], s57 offen offset:2048 sc1
  s_waitcnt vmcnt(2)
  v_cmp_u_f32 vcc, v32, v35
  s_cbranch_vccnz m_41_p5_3
m_41_s5_3:
  v_smfmac_f32_16x16x64_bf16 v[36:39], v[32:35], v[84:91], v7
  v_smfmac_f32_16x16x64_bf16 v[40:43], v[32:35], v[116:123], v7
  v_smfmac_f32_16x16x64_bf16 v[44:47], v[32:35], v[148:155], v7
  v_smfmac_f32_16x16x64_bf16 v[48:51], v[32:35], v[180:187], v7
  v_smfmac_f32_16x16x64_bf16 v[52:55], v[24:27], v[196:203], v7
  v_smfmac_f32_16x16x64_bf16 v[56:59], v[24:27], v[228:235], v7
  v_smfmac_f32_16x16x64_bf16 v[52:55], v[32:35], v[212:219], v7
  v_smfmac_f32_16x16x64_bf16 v[56:59], v[32:35], v[244:251], v7
  s_waitcnt vmcnt(1)
  v_cmp_u_f32 vcc, v20, v23
  s_cbranch_vccnz m_41_f5_0
  s_branch m_41_n5_0
m_41_p2_2:
  buffer_load_dwordx4 v[28:31], v2, s[24:27], s57 offen offset:2048 sc1
  s_waitcnt vmcnt(2)
  v_cmp_u_f32 vcc, v32, v35
  s_cbranch_vccnz m_41_p6_3
m_41_s6_3:
  v_smfmac_f32_16x16x64_bf16 v[36:39], v[32:35], v[84:91], v7
  v_smfmac_f32_16x16x64_bf16 v[40:43], v[32:35], v[116:123], v7
  v_smfmac_f32_16x16x64_bf16 v[44:47], v[32:35], v[148:155], v7
  v_smfmac_f32_16x16x64_bf16 v[48:51], v[32:35], v[180:187], v7
  v_smfmac_f32_16x16x64_bf16 v[52:55], v[20:23], v[188:195], v7
  v_smfmac_f32_16x16x64_bf16 v[56:59], v[20:23], v[220:227], v7
  v_smfmac_f32_16x16x64_bf16 v[52:55], v[32:35], v[212:219], v7
  v_smfmac_f32_16x16x64_bf16 v[56:59], v[32:35], v[244:251], v7
  s_waitcnt vmcnt(1)
  v_cmp_u_f32 vcc, v24, v27
  s_cbranch_vccnz m_41_f6_1
  s_branch m_41_n6_1
m_41_p3_2:
  buffer_load_dwordx4 v[28:31], v2, s[24:27], s57 offen offset:2048 sc1
  s_waitcnt vmcnt(3)
  v_cmp_u_f32 vcc, v32, v35
  s_cbranch_vccnz m_41_p7_3
m_41_s7_3:
  v_smfmac_f32_16x16x64_bf16 v[36:39], v[32:35], v[84:91], v7
  v_smfmac_f32_16x16x64_bf16 v[40:43], v[32:35], v[116:123], v7
  v_smfmac_f32_16x16x64_bf16 v[44:47], v[32:35], v[148:155], v7
  v_smfmac_f32_16x16x64_bf16 v[48:51], v[32:35], v[180:187], v7
  v_smfmac_f32_16x16x64_bf16 v[52:55], v[32:35], v[212:219], v7
  v_smfmac_f32_16x16x64_bf16 v[56:59], v[32:35], v[244:251], v7
  s_waitcnt vmcnt(2)
  v_cmp_u_f32 vcc, v20, v23
  s_cbranch_vccnz m_41_f7_0
  s_branch m_41_n7_0
m_41_p0_3:
  buffer_load_dwordx4 v[32:35], v2, s[24:27], s57 offen offset:3072 sc1
  s_sub_u32 s43, s43, 1
  s_cbranch_scc1 fused_kernel_fin
  v_smfmac_f32_16x16x64_bf16 v[52:55], v[20:23], v[188:195], v7
  v_smfmac_f32_16x16x64_bf16 v[56:59], v[20:23], v[220:227], v7
  v_smfmac_f32_16x16x64_bf16 v[52:55], v[24:27], v[196:203], v7
  v_smfmac_f32_16x16x64_bf16 v[56:59], v[24:27], v[228:235], v7
  v_smfmac_f32_16x16x64_bf16 v[52:55], v[28:31], v[204:211], v7
  v_smfmac_f32_16x16x64_bf16 v[56:59], v[28:31], v[236:243], v7
  s_waitcnt vmcnt(0)
  v_cmp_u_f32 vcc, v32, v35
  s_cbranch_vccnz m_41_f8_3
  s_branch m_41_n8_3
m_41_p1_3:
  buffer_load_dwordx4 v[32:35], v2, s[24:27], s57 offen offset:3072 sc1
  s_sub_u32 s43, s43, 1
  s_cbranch_scc1 fused_kernel_fin
  v_smfmac_f32_16x16x64_bf16 v[52:55], v[24:27], v[196:203], v7
  v_smfmac_f32_16x16x64_bf16 v[56:59], v[24:27], v[228:235], v7
  v_smfmac_f32_16x16x64_bf16 v[52:55], v[28:31], v[204:211], v7
  v_smfmac_f32_16x16x64_bf16 v[56:59], v[28:31], v[236:243], v7
  s_waitcnt vmcnt(1)
  v_cmp_u_f32 vcc, v20, v23
  s_cbranch_vccnz m_41_f9_0
  s_branch m_41_n9_0
m_41_p2_3:
  buffer_load_dwordx4 v[32:35], v2, s[24:27], s57 offen offset:3072 sc1
  s_sub_u32 s43, s43, 1
  s_cbranch_scc1 fused_kernel_fin
  v_smfmac_f32_16x16x64_bf16 v[52:55], v[20:23], v[188:195], v7
  v_smfmac_f32_16x16x64_bf16 v[56:59], v[20:23], v[220:227], v7
  v_smfmac_f32_16x16x64_bf16 v[52:55], v[28:31], v[204:211], v7
  v_smfmac_f32_16x16x64_bf16 v[56:59], v[28:31], v[236:243], v7
  s_waitcnt vmcnt(1)
  v_cmp_u_f32 vcc, v24, v27
  s_cbranch_vccnz m_41_f10_1
  s_branch m_41_n10_1
m_41_p3_3:
  buffer_load_dwordx4 v[32:35], v2, s[24:27], s57 offen offset:3072 sc1
  s_sub_u32 s43, s43, 1
  s_cbranch_scc1 fused_kernel_fin
  v_smfmac_f32_16x16x64_bf16 v[52:55], v[28:31], v[204:211], v7
  v_smfmac_f32_16x16x64_bf16 v[56:59], v[28:31], v[236:243], v7
  s_waitcnt vmcnt(2)
  v_cmp_u_f32 vcc, v20, v23
  s_cbranch_vccnz m_41_f11_0
  s_branch m_41_n11_0
m_41_p4_3:
  buffer_load_dwordx4 v[32:35], v2, s[24:27], s57 offen offset:3072 sc1
  s_sub_u32 s43, s43, 1
  s_cbranch_scc1 fused_kernel_fin
  v_smfmac_f32_16x16x64_bf16 v[52:55], v[20:23], v[188:195], v7
  v_smfmac_f32_16x16x64_bf16 v[56:59], v[20:23], v[220:227], v7
  v_smfmac_f32_16x16x64_bf16 v[52:55], v[24:27], v[196:203], v7
  v_smfmac_f32_16x16x64_bf16 v[56:59], v[24:27], v[228:235], v7
  s_waitcnt vmcnt(1)
  v_cmp_u_f32 vcc, v28, v31
  s_cbranch_vccnz m_41_f12_2
  s_branch m_41_n12_2
m_41_p5_3:
  buffer_load_dwordx4 v[32:35], v2, s[24:27], s57 offen offset:3072 sc1
  s_sub_u32 s43, s43, 1
  s_cbranch_scc1 fused_kernel_fin
  v_smfmac_f32_16x16x64_bf16 v[52:55], v[24:27], v[196:203], v7
  v_smfmac_f32_16x16x64_bf16 v[56:59], v[24:27], v[228:235], v7
  s_waitcnt vmcnt(2)
  v_cmp_u_f32 vcc, v20, v23
  s_cbranch_vccnz m_41_f13_0
  s_branch m_41_n13_0
m_41_p6_3:
  buffer_load_dwordx4 v[32:35], v2, s[24:27], s57 offen offset:3072 sc1
  s_sub_u32 s43, s43, 1
  s_cbranch_scc1 fused_kernel_fin
  v_smfmac_f32_16x16x64_bf16 v[52:55], v[20:23], v[188:195], v7
  v_smfmac_f32_16x16x64_bf16 v[56:59], v[20:23], v[220:227], v7
  s_waitcnt vmcnt(2)
  v_cmp_u_f32 vcc, v24, v27
  s_cbranch_vccnz m_41_f14_1
  s_branch m_41_n14_1
m_41_p7_3:
  buffer_load_dwordx4 v[32:35], v2, s[24:27], s57 offen offset:3072 sc1
  s_sub_u32 s43, s43, 1
  s_cbranch_scc1 fused_kernel_fin
  s_waitcnt vmcnt(3)
  v_cmp_u_f32 vcc, v20, v23
  s_cbranch_vccnz m_41_f15_0
  s_branch m_41_n15_0
m_41_f15_0:
  buffer_load_dwordx4 v[20:23], v2, s[24:27], s57 offen offset:0 sc1
  s_waitcnt vmcnt(3)
  v_cmp_u_f32 vcc, v24, v27
  s_cbranch_vccz m_41_n15_1
m_41_f15_1:
  buffer_load_dwordx4 v[24:27], v2, s[24:27], s57 offen offset:1024 sc1
  s_waitcnt vmcnt(3)
  v_cmp_u_f32 vcc, v28, v31
  s_cbranch_vccz m_41_n15_2
m_41_f15_2:
  buffer_load_dwordx4 v[28:31], v2, s[24:27], s57 offen offset:2048 sc1
  s_waitcnt vmcnt(3)
  v_cmp_u_f32 vcc, v32, v35
  s_cbranch_vccz m_41_n15_3
m_41_f15_3:
  buffer_load_dwordx4 v[32:35], v2, s[24:27], s57 offen offset:3072 sc1
  s_sub_u32 s43, s43, 1
  s_cbranch_scc1 fused_kernel_fin
  s_waitcnt vmcnt(3)
  v_cmp_u_f32 vcc, v20, v23
  s_cbranch_vccnz m_41_f15_0
m_41_n15_0:
  v_smfmac_f32_16x16x64_bf16 v[36:39], v[20:23], v[60:67], v7
  v_smfmac_f32_16x16x64_bf16 v[40:43], v[20:23], v[92:99], v7
  v_smfmac_f32_16x16x64_bf16 v[44:47], v[20:23], v[124:131], v7
  v_smfmac_f32_16x16x64_bf16 v[48:51], v[20:23], v[156:163], v7
  v_smfmac_f32_16x16x64_bf16 v[52:55], v[20:23], v[188:195], v7
  s_waitcnt vmcnt(2)
  v_cmp_u_f32 vcc, v24, v27
  v_smfmac_f32_16x16x64_bf16 v[56:59], v[20:23], v[220:227], v7
  s_cbranch_vccnz m_41_f14_1
m_41_n14_1:
  v_smfmac_f32_16x16x64_bf16 v[36:39], v[24:27], v[68:75], v7
  v_smfmac_f32_16x16x64_bf16 v[40:43], v[24:27], v[100:107], v7
  v_smfmac_f32_16x16x64_bf16 v[44:47], v[24:27], v[132:139], v7
  v_smfmac_f32_16x16x64_bf16 v[48:51], v[24:27], v[164:171], v7
  v_smfmac_f32_16x16x64_bf16 v[52:55], v[24:27], v[196:203], v7
  s_waitcnt vmcnt(1)
  v_cmp_u_f32 vcc, v28, v31
  v_smfmac_f32_16x16x64_bf16 v[56:59], v[24:27], v[228:235], v7
  s_cbranch_vccnz m_41_f12_2
m_41_n12_2:
  v_smfmac_f32_16x16x64_bf16 v[36:39], v[28:31], v[76:83], v7
  v_smfmac_f32_16x16x64_bf16 v[40:43], v[28:31], v[108:115], v7
  v_smfmac_f32_16x16x64_bf16 v[44:47], v[28:31], v[140:147], v7
  v_smfmac_f32_16x16x64_bf16 v[48:51], v[28:31], v[172:179], v7
  v_smfmac_f32_16x16x64_bf16 v[52:55], v[28:31], v[204:211], v7
  s_waitcnt vmcnt(0)
  v_cmp_u_f32 vcc, v32, v35
  v_smfmac_f32_16x16x64_bf16 v[56:59], v[28:31], v[236:243], v7
  s_cbranch_vccnz m_41_f8_3
m_41_n8_3:
  v_smfmac_f32_16x16x64_bf16 v[36:39], v[32:35], v[84:91], v7
  buffer_load_dwordx4 v2, s[24:27], s58 offen offset:0 lds
  v_smfmac_f32_16x16x64_bf16 v[40:43], v[32:35], v[116:123], v7
  buffer_load_dwordx4 v2, s[24:27], s58 offen offset:1024 lds
  v_smfmac_f32_16x16x64_bf16 v[44:47], v[32:35], v[148:155], v7
  s_nop 3
  v_add_f32 v36, v36, v38
  v_add_f32 v37, v37, v39
  v_cvt_pk_bf16_f32 v38, v36, v37
  ds_write_b32 v4, v38 offset:0
  v_smfmac_f32_16x16x64_bf16 v[48:51], v[32:35], v[180:187], v7
  v_add_f32 v40, v40, v42
  v_add_f32 v41, v41, v43
  v_cvt_pk_bf16_f32 v42, v40, v41
  ds_write_b32 v4, v42 offset:640
  v_smfmac_f32_16x16x64_bf16 v[52:55], v[32:35], v[212:219], v7
  v_add_f32 v44, v44, v46
  v_add_f32 v45, v45, v47
  v_cvt_pk_bf16_f32 v46, v44, v45
  ds_write_b32 v4, v46 offset:2560
  v_smfmac_f32_16x16x64_bf16 v[56:59], v[32:35], v[244:251], v7
  v_add_f32 v48, v48, v50
  v_add_f32 v49, v49, v51
  v_cvt_pk_bf16_f32 v50, v48, v49
  ds_write_b32 v4, v50 offset:3200
  v_add_f32 v52, v52, v54
  v_add_f32 v53, v53, v55
  ds_write2_b32 v5, v52, v53 offset0:0 offset1:16
  s_nop 0
  v_add_f32 v56, v56, v58
  v_add_f32 v57, v57, v59
  ds_write2_b32 v5, v56, v57 offset0:128 offset1:144
  buffer_load_dwordx4 v2, s[24:27], s58 offen offset:2048 lds
  buffer_load_dwordx4 v2, s[24:27], s58 offen offset:3072 lds
  s_branch b_post_32
m_41_n15_1:
  v_smfmac_f32_16x16x64_bf16 v[36:39], v[24:27], v[68:75], v7
  v_smfmac_f32_16x16x64_bf16 v[40:43], v[24:27], v[100:107], v7
  v_smfmac_f32_16x16x64_bf16 v[44:47], v[24:27], v[132:139], v7
  v_smfmac_f32_16x16x64_bf16 v[48:51], v[24:27], v[164:171], v7
  v_smfmac_f32_16x16x64_bf16 v[52:55], v[24:27], v[196:203], v7
  s_waitcnt vmcnt(2)
  v_cmp_u_f32 vcc, v28, v31
  v_smfmac_f32_16x16x64_bf16 v[56:59], v[24:27], v[228:235], v7
  s_cbranch_vccnz m_41_f13_2
m_41_n13_2:
  v_smfmac_f32_16x16x64_bf16 v[36:39], v[28:31], v[76:83], v7
  v_smfmac_f32_16x16x64_bf16 v[40:43], v[28:31], v[108:115], v7
  v_smfmac_f32_16x16x64_bf16 v[44:47], v[28:31], v[140:147], v7
  v_smfmac_f32_16x16x64_bf16 v[48:51], v[28:31], v[172:179], v7
  v_smfmac_f32_16x16x64_bf16 v[52:55], v[28:31], v[204:211], v7
  s_waitcnt vmcnt(1)
  v_cmp_u_f32 vcc, v32, v35
  v_smfmac_f32_16x16x64_bf16 v[56:59], v[28:31], v[236:243], v7
  s_cbranch_vccnz m_41_f9_3
m_41_n9_3:
  v_smfmac_f32_16x16x64_bf16 v[36:39], v[32:35], v[84:91], v7
  v_smfmac_f32_16x16x64_bf16 v[40:43], v[32:35], v[116:123], v7
  v_smfmac_f32_16x16x64_bf16 v[44:47], v[32:35], v[148:155], v7
  v_smfmac_f32_16x16x64_bf16 v[48:51], v[32:35], v[180:187], v7
  v_smfmac_f32_16x16x64_bf16 v[52:55], v[32:35], v[212:219], v7
  s_waitcnt vmcnt(0)
  v_cmp_u_f32 vcc, v20, v23
  v_smfmac_f32_16x16x64_bf16 v[56:59], v[32:35], v[244:251], v7
  s_cbranch_vccnz m_41_f1_0
m_41_n1_0:
  v_smfmac_f32_16x16x64_bf16 v[36:39], v[20:23], v[60:67], v7
  buffer_load_dwordx4 v2, s[24:27], s58 offen offset:0 lds
  v_smfmac_f32_16x16x64_bf16 v[40:43], v[20:23], v[92:99], v7
  buffer_load_dwordx4 v2, s[24:27], s58 offen offset:1024 lds
  v_smfmac_f32_16x16x64_bf16 v[44:47], v[20:23], v[124:131], v7
  s_nop 3
  v_add_f32 v36, v36, v38
  v_add_f32 v37, v37, v39
  v_cvt_pk_bf16_f32 v38, v36, v37
  ds_write_b32 v4, v38 offset:0
  v_smfmac_f32_16x16x64_bf16 v[48:51], v[20:23], v[156:163], v7
  v_add_f32 v40, v40, v42
  v_add_f32 v41, v41, v43
  v_cvt_pk_bf16_f32 v42, v40, v41
  ds_write_b32 v4, v42 offset:640
  v_smfmac_f32_16x16x64_bf16 v[52:55], v[20:23], v[188:195], v7
  v_add_f32 v44, v44, v46
  v_add_f32 v45, v45, v47
  v_cvt_pk_bf16_f32 v46, v44, v45
  ds_write_b32 v4, v46 offset:2560
  v_smfmac_f32_16x16x64_bf16 v[56:59], v[20:23], v[220:227], v7
  v_add_f32 v48, v48, v50
  v_add_f32 v49, v49, v51
  v_cvt_pk_bf16_f32 v50, v48, v49
  ds_write_b32 v4, v50 offset:3200
  v_add_f32 v52, v52, v54
  v_add_f32 v53, v53, v55
  ds_write2_b32 v5, v52, v53 offset0:0 offset1:16
  s_nop 0
  v_add_f32 v56, v56, v58
  v_add_f32 v57, v57, v59
  ds_write2_b32 v5, v56, v57 offset0:128 offset1:144
  buffer_load_dwordx4 v2, s[24:27], s58 offen offset:2048 lds
  buffer_load_dwordx4 v2, s[24:27], s58 offen offset:3072 lds
  s_branch b_post_32
m_41_n15_2:
  v_smfmac_f32_16x16x64_bf16 v[36:39], v[28:31], v[76:83], v7
  v_smfmac_f32_16x16x64_bf16 v[40:43], v[28:31], v[108:115], v7
  v_smfmac_f32_16x16x64_bf16 v[44:47], v[28:31], v[140:147], v7
  v_smfmac_f32_16x16x64_bf16 v[48:51], v[28:31], v[172:179], v7
  v_smfmac_f32_16x16x64_bf16 v[52:55], v[28:31], v[204:211], v7
  s_waitcnt vmcnt(2)
  v_cmp_u_f32 vcc, v32, v35
  v_smfmac_f32_16x16x64_bf16 v[56:59], v[28:31], v[236:243], v7
  s_cbranch_vccnz m_41_f11_3
m_41_n11_3:
  v_smfmac_f32_16x16x64_bf16 v[36:39], v[32:35], v[84:91], v7
  v_smfmac_f32_16x16x64_bf16 v[40:43], v[32:35], v[116:123], v7
  v_smfmac_f32_16x16x64_bf16 v[44:47], v[32:35], v[148:155], v7
  v_smfmac_f32_16x16x64_bf16 v[48:51], v[32:35], v[180:187], v7
  v_smfmac_f32_16x16x64_bf16 v[52:55], v[32:35], v[212:219], v7
  s_waitcnt vmcnt(1)
  v_cmp_u_f32 vcc, v20, v23
  v_smfmac_f32_16x16x64_bf16 v[56:59], v[32:35], v[244:251], v7
  s_cbranch_vccnz m_41_f3_0
m_41_n3_0:
  v_smfmac_f32_16x16x64_bf16 v[36:39], v[20:23], v[60:67], v7
  v_smfmac_f32_16x16x64_bf16 v[40:43], v[20:23], v[92:99], v7
  v_smfmac_f32_16x16x64_bf16 v[44:47], v[20:23], v[124:131], v7
  v_smfmac_f32_16x16x64_bf16 v[48:51], v[20:23], v[156:163], v7
  v_smfmac_f32_16x16x64_bf16 v[52:55], v[20:23], v[188:195], v7
  s_waitcnt vmcnt(0)
  v_cmp_u_f32 vcc, v24, v27
  v_smfmac_f32_16x16x64_bf16 v[56:59], v[20:23], v[220:227], v7
  s_cbranch_vccnz m_41_f2_1
m_41_n2_1:
  v_smfmac_f32_16x16x64_bf16 v[36:39], v[24:27], v[68:75], v7
  buffer_load_dwordx4 v2, s[24:27], s58 offen offset:0 lds
  v_smfmac_f32_16x16x64_bf16 v[40:43], v[24:27], v[100:107], v7
  buffer_load_dwordx4 v2, s[24:27], s58 offen offset:1024 lds
  v_smfmac_f32_16x16x64_bf16 v[44:47], v[24:27], v[132:139], v7
  s_nop 3
  v_add_f32 v36, v36, v38
  v_add_f32 v37, v37, v39
  v_cvt_pk_bf16_f32 v38, v36, v37
  ds_write_b32 v4, v38 offset:0
  v_smfmac_f32_16x16x64_bf16 v[48:51], v[24:27], v[164:171], v7
  v_add_f32 v40, v40, v42
  v_add_f32 v41, v41, v43
  v_cvt_pk_bf16_f32 v42, v40, v41
  ds_write_b32 v4, v42 offset:640
  v_smfmac_f32_16x16x64_bf16 v[52:55], v[24:27], v[196:203], v7
  v_add_f32 v44, v44, v46
  v_add_f32 v45, v45, v47
  v_cvt_pk_bf16_f32 v46, v44, v45
  ds_write_b32 v4, v46 offset:2560
  v_smfmac_f32_16x16x64_bf16 v[56:59], v[24:27], v[228:235], v7
  v_add_f32 v48, v48, v50
  v_add_f32 v49, v49, v51
  v_cvt_pk_bf16_f32 v50, v48, v49
  ds_write_b32 v4, v50 offset:3200
  v_add_f32 v52, v52, v54
  v_add_f32 v53, v53, v55
  ds_write2_b32 v5, v52, v53 offset0:0 offset1:16
  s_nop 0
  v_add_f32 v56, v56, v58
  v_add_f32 v57, v57, v59
  ds_write2_b32 v5, v56, v57 offset0:128 offset1:144
  buffer_load_dwordx4 v2, s[24:27], s58 offen offset:2048 lds
  buffer_load_dwordx4 v2, s[24:27], s58 offen offset:3072 lds
  s_branch b_post_32
m_41_n15_3:
  v_smfmac_f32_16x16x64_bf16 v[36:39], v[32:35], v[84:91], v7
  v_smfmac_f32_16x16x64_bf16 v[40:43], v[32:35], v[116:123], v7
  v_smfmac_f32_16x16x64_bf16 v[44:47], v[32:35], v[148:155], v7
  v_smfmac_f32_16x16x64_bf16 v[48:51], v[32:35], v[180:187], v7
  v_smfmac_f32_16x16x64_bf16 v[52:55], v[32:35], v[212:219], v7
  s_waitcnt vmcnt(2)
  v_cmp_u_f32 vcc, v20, v23
  v_smfmac_f32_16x16x64_bf16 v[56:59], v[32:35], v[244:251], v7
  s_cbranch_vccnz m_41_f7_0
m_41_n7_0:
  v_smfmac_f32_16x16x64_bf16 v[36:39], v[20:23], v[60:67], v7
  v_smfmac_f32_16x16x64_bf16 v[40:43], v[20:23], v[92:99], v7
  v_smfmac_f32_16x16x64_bf16 v[44:47], v[20:23], v[124:131], v7
  v_smfmac_f32_16x16x64_bf16 v[48:51], v[20:23], v[156:163], v7
  v_smfmac_f32_16x16x64_bf16 v[52:55], v[20:23], v[188:195], v7
  s_waitcnt vmcnt(1)
  v_cmp_u_f32 vcc, v24, v27
  v_smfmac_f32_16x16x64_bf16 v[56:59], v[20:23], v[220:227], v7
  s_cbranch_vccnz m_41_f6_1
m_41_n6_1:
  v_smfmac_f32_16x16x64_bf16 v[36:39], v[24:27], v[68:75], v7
  v_smfmac_f32_16x16x64_bf16 v[40:43], v[24:27], v[100:107], v7
  v_smfmac_f32_16x16x64_bf16 v[44:47], v[24:27], v[132:139], v7
  v_smfmac_f32_16x16x64_bf16 v[48:51], v[24:27], v[164:171], v7
  v_smfmac_f32_16x16x64_bf16 v[52:55], v[24:27], v[196:203], v7
  s_waitcnt vmcnt(0)
  v_cmp_u_f32 vcc, v28, v31
  v_smfmac_f32_16x16x64_bf16 v[56:59], v[24:27], v[228:235], v7
  s_cbranch_vccnz m_41_f4_2
m_41_n4_2:
  v_smfmac_f32_16x16x64_bf16 v[36:39], v[28:31], v[76:83], v7
  buffer_load_dwordx4 v2, s[24:27], s58 offen offset:0 lds
  v_smfmac_f32_16x16x64_bf16 v[40:43], v[28:31], v[108:115], v7
  buffer_load_dwordx4 v2, s[24:27], s58 offen offset:1024 lds
  v_smfmac_f32_16x16x64_bf16 v[44:47], v[28:31], v[140:147], v7
  s_nop 3
  v_add_f32 v36, v36, v38
  v_add_f32 v37, v37, v39
  v_cvt_pk_bf16_f32 v38, v36, v37
  ds_write_b32 v4, v38 offset:0
  v_smfmac_f32_16x16x64_bf16 v[48:51], v[28:31], v[172:179], v7
  v_add_f32 v40, v40, v42
  v_add_f32 v41, v41, v43
  v_cvt_pk_bf16_f32 v42, v40, v41
  ds_write_b32 v4, v42 offset:640
  v_smfmac_f32_16x16x64_bf16 v[52:55], v[28:31], v[204:211], v7
  v_add_f32 v44, v44, v46
  v_add_f32 v45, v45, v47
  v_cvt_pk_bf16_f32 v46, v44, v45
  ds_write_b32 v4, v46 offset:2560
  v_smfmac_f32_16x16x64_bf16 v[56:59], v[28:31], v[236:243], v7
  v_add_f32 v48, v48, v50
  v_add_f32 v49, v49, v51
  v_cvt_pk_bf16_f32 v50, v48, v49
  ds_write_b32 v4, v50 offset:3200
  v_add_f32 v52, v52, v54
  v_add_f32 v53, v53, v55
  ds_write2_b32 v5, v52, v53 offset0:0 offset1:16
  s_nop 0
  v_add_f32 v56, v56, v58
  v_add_f32 v57, v57, v59
  ds_write2_b32 v5, v56, v57 offset0:128 offset1:144
  buffer_load_dwordx4 v2, s[24:27], s58 offen offset:2048 lds
  buffer_load_dwordx4 v2, s[24:27], s58 offen offset:3072 lds
  s_branch b_post_32
m_41_f14_1:
  buffer_load_dwordx4 v[24:27], v2, s[24:27], s57 offen offset:1024 sc1
  s_waitcnt vmcnt(2)
  v_cmp_u_f32 vcc, v28, v31
  s_cbranch_vccz m_41_n14_2
m_41_f14_2:
  buffer_load_dwordx4 v[28:31], v2, s[24:27], s57 offen offset:2048 sc1
  s_waitcnt vmcnt(2)
  v_cmp_u_f32 vcc, v32, v35
  s_cbranch_vccz m_41_n14_3
m_41_f14_3:
  buffer_load_dwordx4 v[32:35], v2, s[24:27], s57 offen offset:3072 sc1
  s_sub_u32 s43, s43, 1
  s_cbranch_scc1 fused_kernel_fin
  s_waitcnt vmcnt(2)
  v_cmp_u_f32 vcc, v24, v27
  s_cbranch_vccnz m_41_f14_1
  s_branch m_41_n14_1
m_41_n14_2:
  v_smfmac_f32_16x16x64_bf16 v[36:39], v[28:31], v[76:83], v7
  v_smfmac_f32_16x16x64_bf16 v[40:43], v[28:31], v[108:115], v7
  v_smfmac_f32_16x16x64_bf16 v[44:47], v[28:31], v[140:147], v7
  v_smfmac_f32_16x16x64_bf16 v[48:51], v[28:31], v[172:179], v7
  v_smfmac_f32_16x16x64_bf16 v[52:55], v[28:31], v[204:211], v7
  s_waitcnt vmcnt(1)
  v_cmp_u_f32 vcc, v32, v35
  v_smfmac_f32_16x16x64_bf16 v[56:59], v[28:31], v[236:243], v7
  s_cbranch_vccnz m_41_f10_3
m_41_n10_3:
  v_smfmac_f32_16x16x64_bf16 v[36:39], v[32:35], v[84:91], v7
  v_smfmac_f32_16x16x64_bf16 v[40:43], v[32:35], v[116:123], v7
  v_smfmac_f32_16x16x64_bf16 v[44:47], v[32:35], v[148:155], v7
  v_smfmac_f32_16x16x64_bf16 v[48:51], v[32:35], v[180:187], v7
  v_smfmac_f32_16x16x64_bf16 v[52:55], v[32:35], v[212:219], v7
  s_waitcnt vmcnt(0)
  v_cmp_u_f32 vcc, v24, v27
  v_smfmac_f32_16x16x64_bf16 v[56:59], v[32:35], v[244:251], v7
  s_cbranch_vccnz m_41_f2_1
  s_branch m_41_n2_1
m_41_n14_3:
  v_smfmac_f32_16x16x64_bf16 v[36:39], v[32:35], v[84:91], v7
  v_smfmac_f32_16x16x64_bf16 v[40:43], v[32:35], v[116:123], v7
  v_smfmac_f32_16x16x64_bf16 v[44:47], v[32:35], v[148:155], v7
  v_smfmac_f32_16x16x64_bf16 v[48:51], v[32:35], v[180:187], v7
  v_smfmac_f32_16x16x64_bf16 v[52:55], v[32:35], v[212:219], v7
  s_waitcnt vmcnt(1)
  v_cmp_u_f32 vcc, v24, v27
  v_smfmac_f32_16x16x64_bf16 v[56:59], v[32:35], v[244:251], v7
  s_cbranch_vccnz m_41_f6_1
  s_branch m_41_n6_1
m_41_f13_0:
  buffer_load_dwordx4 v[20:23], v2, s[24:27], s57 offen offset:0 sc1
  s_waitcnt vmcnt(2)
  v_cmp_u_f32 vcc, v28, v31
  s_cbranch_vccz m_41_n13_2
m_41_f13_2:
  buffer_load_dwordx4 v[28:31], v2, s[24:27], s57 offen offset:2048 sc1
  s_waitcnt vmcnt(2)
  v_cmp_u_f32 vcc, v32, v35
  s_cbranch_vccz m_41_n13_3
m_41_f13_3:
  buffer_load_dwordx4 v[32:35], v2, s[24:27], s57 offen offset:3072 sc1
  s_sub_u32 s43, s43, 1
  s_cbranch_scc1 fused_kernel_fin
  s_waitcnt vmcnt(2)
  v_cmp_u_f32 vcc, v20, v23
  s_cbranch_vccnz m_41_f13_0
m_41_n13_0:
  v_smfmac_f32_16x16x64_bf16 v[36:39], v[20:23], v[60:67], v7
  v_smfmac_f32_16x16x64_bf16 v[40:43], v[20:23], v[92:99], v7
  v_smfmac_f32_16x16x64_bf16 v[44:47], v[20:23], v[124:131], v7
  v_smfmac_f32_16x16x64_bf16 v[48:51], v[20:23], v[156:163], v7
  v_smfmac_f32_16x16x64_bf16 v[52:55], v[20:23], v[188:195], v7
  s_waitcnt vmcnt(1)
  v_cmp_u_f32 vcc, v28, v31
  v_smfmac_f32_16x16x64_bf16 v[56:59], v[20:23], v[220:227], v7
  s_cbranch_vccnz m_41_f12_2
  s_branch m_41_n12_2
m_41_n13_3:
  v_smfmac_f32_16x16x64_bf16 v[36:39], v[32:35], v[84:91], v7
  v_smfmac_f32_16x16x64_bf16 v[40:43], v[32:35], v[116:123], v7
  v_smfmac_f32_16x16x64_bf16 v[44:47], v[32:35], v[148:155], v7
  v_smfmac_f32_16x16x64_bf16 v[48:51], v[32:35], v[180:187], v7
  v_smfmac_f32_16x16x64_bf16 v[52:55], v[32:35], v[212:219], v7
  s_waitcnt vmcnt(1)
  v_cmp_u_f32 vcc, v20, v23
  v_smfmac_f32_16x16x64_bf16 v[56:59], v[32:35], v[244:251], v7
  s_cbranch_vccnz m_41_f5_0
m_41_n5_0:
  v_smfmac_f32_16x16x64_bf16 v[36:39], v[20:23], v[60:67], v7
  v_smfmac_f32_16x16x64_bf16 v[40:43], v[20:23], v[92:99], v7
  v_smfmac_f32_16x16x64_bf16 v[44:47], v[20:23], v[124:131], v7
  v_smfmac_f32_16x16x64_bf16 v[48:51], v[20:23], v[156:163], v7
  v_smfmac_f32_16x16x64_bf16 v[52:55], v[20:23], v[188:195], v7
  s_waitcnt vmcnt(0)
  v_cmp_u_f32 vcc, v28, v31
  v_smfmac_f32_16x16x64_bf16 v[56:59], v[20:23], v[220:227], v7
  s_cbranch_vccnz m_41_f4_2
  s_branch m_41_n4_2
m_41_f12_2:
  buffer_load_dwordx4 v[28:31], v2, s[24:27], s57 offen offset:2048 sc1
  s_waitcnt vmcnt(1)
  v_cmp_u_f32 vcc, v32, v35
  s_cbranch_vccz m_41_n12_3
m_41_f12_3:
  buffer_load_dwordx4 v[32:35], v2, s[24:27], s57 offen offset:3072 sc1
  s_sub_u32 s43, s43, 1
  s_cbranch_scc1 fused_kernel_fin
  s_waitcnt vmcnt(1)
  v_cmp_u_f32 vcc, v28, v31
  s_cbranch_vccnz m_41_f12_2
  s_branch m_41_n12_2
m_41_n12_3:
  v_smfmac_f32_16x16x64_bf16 v[36:39], v[32:35], v[84:91], v7
  v_smfmac_f32_16x16x64_bf16 v[40:43], v[32:35], v[116:123], v7
  v_smfmac_f32_16x16x64_bf16 v[44:47], v[32:35], v[148:155], v7
  v_smfmac_f32_16x16x64_bf16 v[48:51], v[32:35], v[180:187], v7
  v_smfmac_f32_16x16x64_bf16 v[52:55], v[32:35], v[212:219], v7
  s_waitcnt vmcnt(0)
  v_cmp_u_f32 vcc, v28, v31
  v_smfmac_f32_16x16x64_bf16 v[56:59], v[32:35], v[244:251], v7
  s_cbranch_vccnz m_41_f4_2
  s_branch m_41_n4_2
m_41_f11_0:
  buffer_load_dwordx4 v[20:23], v2, s[24:27], s57 offen offset:0 sc1
  s_waitcnt vmcnt(2)
  v_cmp_u_f32 vcc, v24, v27
  s_cbranch_vccz m_41_n11_1
m_41_f11_1:
  buffer_load_dwordx4 v[24:27], v2, s[24:27], s57 offen offset:1024 sc1
  s_waitcnt vmcnt(2)
  v_cmp_u_f32 vcc, v32, v35
  s_cbranch_vccz m_41_n11_3
m_41_f11_3:
  buffer_load_dwordx4 v[32:35], v2, s[24:27], s57 offen offset:3072 sc1
  s_sub_u32 s43, s43, 1
  s_cbranch_scc1 fused_kernel_fin
  s_waitcnt vmcnt(2)
  v_cmp_u_f32 vcc, v20, v23
  s_cbranch_vccnz m_41_f11_0
m_41_n11_0:
  v_smfmac_f32_16x16x64_bf16 v[36:39], v[20:23], v[60:67], v7
  v_smfmac_f32_16x16x64_bf16 v[40:43], v[20:23], v[92:99], v7
  v_smfmac_f32_16x16x64_bf16 v[44:47], v[20:23], v[124:131], v7
  v_smfmac_f32_16x16x64_bf16 v[48:51], v[20:23], v[156:163], v7
  v_smfmac_f32_16x16x64_bf16 v[52:55], v[20:23], v[188:195], v7
  s_waitcnt vmcnt(1)
  v_cmp_u_f32 vcc, v24, v27
  v_smfmac_f32_16x16x64_bf16 v[56:59], v[20:23], v[220:227], v7
  s_cbranch_vccnz m_41_f10_1
m_41_n10_1:
  v_smfmac_f32_16x16x64_bf16 v[36:39], v[24:27], v[68:75], v7
  v_smfmac_f32_16x16x64_bf16 v[40:43], v[24:27], v[100:107], v7
  v_smfmac_f32_16x16x64_bf16 v[44:47], v[24:27], v[132:139], v7
  v_smfmac_f32_16x16x64_bf16 v[48:51], v[24:27], v[164:171], v7
  v_smfmac_f32_16x16x64_bf16 v[52:55], v[24:27], v[196:203], v7
  s_waitcnt vmcnt(0)
  v_cmp_u_f32 vcc, v32, v35
  v_smfmac_f32_16x16x64_bf16 v[56:59], v[24:27], v[228:235], v7
  s_cbranch_vccnz m_41_f8_3
  s_branch m_41_n8_3
m_41_n11_1:
  v_smfmac_f32_16x16x64_bf16 v[36:39], v[24:27], v[68:75], v7
  v_smfmac_f32_16x16x64_bf16 v[40:43], v[24:27], v[100:107], v7
  v_smfmac_f32_16x16x64_bf16 v[44:47], v[24:27], v[132:139], v7
  v_smfmac_f32_16x16x64_bf16 v[48:51], v[24:27], v[164:171], v7
  v_smfmac_f32_16x16x64_bf16 v[52:55], v[24:27], v[196:203], v7
  s_waitcnt vmcnt(1)
  v_cmp_u_f32 vcc, v32, v35
  v_smfmac_f32_16x16x64_bf16 v[56:59], v[24:27], v[228:235], v7
  s_cbranch_vccnz m_41_f9_3
  s_branch m_41_n9_3
m_41_f10_1:
  buffer_load_dwordx4 v[24:27], v2, s[24:27], s57 offen offset:1024 sc1
  s_waitcnt vmcnt(1)
  v_cmp_u_f32 vcc, v32, v35
  s_cbranch_vccz m_41_n10_3
m_41_f10_3:
  buffer_load_dwordx4 v[32:35], v2, s[24:27], s57 offen offset:3072 sc1
  s_sub_u32 s43, s43, 1
  s_cbranch_scc1 fused_kernel_fin
  s_waitcnt vmcnt(1)
  v_cmp_u_f32 vcc, v24, v27
  s_cbranch_vccnz m_41_f10_1
  s_branch m_41_n10_1
m_41_f9_0:
  buffer_load_dwordx4 v[20:23], v2, s[24:27], s57 offen offset:0 sc1
  s_waitcnt vmcnt(1)
  v_cmp_u_f32 vcc, v32, v35
  s_cbranch_vccz m_41_n9_3
m_41_f9_3:
  buffer_load_dwordx4 v[32:35], v2, s[24:27], s57 offen offset:3072 sc1
  s_sub_u32 s43, s43, 1
  s_cbranch_scc1 fused_kernel_fin
  s_waitcnt vmcnt(1)
  v_cmp_u_f32 vcc, v20, v23
  s_cbranch_vccnz m_41_f9_0
m_41_n9_0:
  v_smfmac_f32_16x16x64_bf16 v[36:39], v[20:23], v[60:67], v7
  v_smfmac_f32_16x16x64_bf16 v[40:43], v[20:23], v[92:99], v7
  v_smfmac_f32_16x16x64_bf16 v[44:47], v[20:23], v[124:131], v7
  v_smfmac_f32_16x16x64_bf16 v[48:51], v[20:23], v[156:163], v7
  v_smfmac_f32_16x16x64_bf16 v[52:55], v[20:23], v[188:195], v7
  s_waitcnt vmcnt(0)
  v_cmp_u_f32 vcc, v32, v35
  v_smfmac_f32_16x16x64_bf16 v[56:59], v[20:23], v[220:227], v7
  s_cbranch_vccnz m_41_f8_3
  s_branch m_41_n8_3
m_41_f8_3:
  buffer_load_dwordx4 v[32:35], v2, s[24:27], s57 offen offset:3072 sc1
  s_sub_u32 s43, s43, 1
  s_cbranch_scc1 fused_kernel_fin
  s_waitcnt vmcnt(0)
  v_cmp_u_f32 vcc, v32, v35
  s_cbranch_vccnz m_41_f8_3
  s_branch m_41_n8_3
m_41_f7_0:
  buffer_load_dwordx4 v[20:23], v2, s[24:27], s57 offen offset:0 sc1
  s_waitcnt vmcnt(2)
  v_cmp_u_f32 vcc, v24, v27
  s_cbranch_vccz m_41_n7_1
m_41_f7_1:
  buffer_load_dwordx4 v[24:27], v2, s[24:27], s57 offen offset:1024 sc1
  s_waitcnt vmcnt(2)
  v_cmp_u_f32 vcc, v28, v31
  s_cbranch_vccz m_41_n7_2
m_41_f7_2:
  buffer_load_dwordx4 v[28:31], v2, s[24:27], s57 offen offset:2048 sc1
  s_sub_u32 s43, s43, 1
  s_cbranch_scc1 fused_kernel_fin
  s_waitcnt vmcnt(2)
  v_cmp_u_f32 vcc, v20, v23
  s_cbranch_vccnz m_41_f7_0
  s_branch m_41_n7_0
m_41_n7_1:
  v_smfmac_f32_16x16x64_bf16 v[36:39], v[24:27], v[68:75], v7
  v_smfmac_f32_16x16x64_bf16 v[40:43], v[24:27], v[100:107], v7
  v_smfmac_f32_16x16x64_bf16 v[44:47], v[24:27], v[132:139], v7
  v_smfmac_f32_16x16x64_bf16 v[48:51], v[24:27], v[164:171], v7
  v_smfmac_f32_16x16x64_bf16 v[52:55], v[24:27], v[196:203], v7
  s_waitcnt vmcnt(1)
  v_cmp_u_f32 vcc, v28, v31
  v_smfmac_f32_16x16x64_bf16 v[56:59], v[24:27], v[228:235], v7
  s_cbranch_vccnz m_41_f5_2
m_41_n5_2:
  v_smfmac_f32_16x16x64_bf16 v[36:39], v[28:31], v[76:83], v7
  v_smfmac_f32_16x16x64_bf16 v[40:43], v[28:31], v[108:115], v7
  v_smfmac_f32_16x16x64_bf16 v[44:47], v[28:31], v[140:147], v7
  v_smfmac_f32_16x16x64_bf16 v[48:51], v[28:31], v[172:179], v7
  v_smfmac_f32_16x16x64_bf16 v[52:55], v[28:31], v[204:211], v7
  s_waitcnt vmcnt(0)
  v_cmp_u_f32 vcc, v20, v23
  v_smfmac_f32_16x16x64_bf16 v[56:59], v[28:31], v[236:243], v7
  s_cbranch_vccnz m_41_f1_0
  s_branch m_41_n1_0
m_41_n7_2:
  v_smfmac_f32_16x16x64_bf16 v[36:39], v[28:31], v[76:83], v7
  v_smfmac_f32_16x16x64_bf16 v[40:43], v[28:31], v[108:115], v7
  v_smfmac_f32_16x16x64_bf16 v[44:47], v[28:31], v[140:147], v7
  v_smfmac_f32_16x16x64_bf16 v[48:51], v[28:31], v[172:179], v7
  v_smfmac_f32_16x16x64_bf16 v[52:55], v[28:31], v[204:211], v7
  s_waitcnt vmcnt(1)
  v_cmp_u_f32 vcc, v20, v23
  v_smfmac_f32_16x16x64_bf16 v[56:59], v[28:31], v[236:243], v7
  s_cbranch_vccnz m_41_f3_0
  s_branch m_41_n3_0
m_41_f6_1:
  buffer_load_dwordx4 v[24:27], v2, s[24:27], s57 offen offset:1024 sc1
  s_waitcnt vmcnt(1)
  v_cmp_u_f32 vcc, v28, v31
  s_cbranch_vccz m_41_n6_2
m_41_f6_2:
  buffer_load_dwordx4 v[28:31], v2, s[24:27], s57 offen offset:2048 sc1
  s_sub_u32 s43, s43, 1
  s_cbranch_scc1 fused_kernel_fin
  s_waitcnt vmcnt(1)
  v_cmp_u_f32 vcc, v24, v27
  s_cbranch_vccnz m_41_f6_1
  s_branch m_41_n6_1
m_41_n6_2:
  v_smfmac_f32_16x16x64_bf16 v[36:39], v[28:31], v[76:83], v7
  v_smfmac_f32_16x16x64_bf16 v[40:43], v[28:31], v[108:115], v7
  v_smfmac_f32_16x16x64_bf16 v[44:47], v[28:31], v[140:147], v7
  v_smfmac_f32_16x16x64_bf16 v[48:51], v[28:31], v[172:179], v7
  v_smfmac_f32_16x16x64_bf16 v[52:55], v[28:31], v[204:211], v7
  s_waitcnt vmcnt(0)
  v_cmp_u_f32 vcc, v24, v27
  v_smfmac_f32_16x16x64_bf16 v[56:59], v[28:31], v[236:243], v7
  s_cbranch_vccnz m_41_f2_1
  s_branch m_41_n2_1
m_41_f5_0:
  buffer_load_dwordx4 v[20:23], v2, s[24:27], s57 offen offset:0 sc1
  s_waitcnt vmcnt(1)
  v_cmp_u_f32 vcc, v28, v31
  s_cbranch_vccz m_41_n5_2
m_41_f5_2:
  buffer_load_dwordx4 v[28:31], v2, s[24:27], s57 offen offset:2048 sc1
  s_sub_u32 s43, s43, 1
  s_cbranch_scc1 fused_kernel_fin
  s_waitcnt vmcnt(1)
  v_cmp_u_f32 vcc, v20, v23
  s_cbranch_vccnz m_41_f5_0
  s_branch m_41_n5_0
m_41_f4_2:
  buffer_load_dwordx4 v[28:31], v2, s[24:27], s57 offen offset:2048 sc1
  s_sub_u32 s43, s43, 1
  s_cbranch_scc1 fused_kernel_fin
  s_waitcnt vmcnt(0)
  v_cmp_u_f32 vcc, v28, v31
  s_cbranch_vccnz m_41_f4_2
  s_branch m_41_n4_2
m_41_f3_0:
  buffer_load_dwordx4 v[20:23], v2, s[24:27], s57 offen offset:0 sc1
  s_waitcnt vmcnt(1)
  v_cmp_u_f32 vcc, v24, v27
  s_cbranch_vccz m_41_n3_1
m_41_f3_1:
  buffer_load_dwordx4 v[24:27], v2, s[24:27], s57 offen offset:1024 sc1
  s_sub_u32 s43, s43, 1
  s_cbranch_scc1 fused_kernel_fin
  s_waitcnt vmcnt(1)
  v_cmp_u_f32 vcc, v20, v23
  s_cbranch_vccnz m_41_f3_0
  s_branch m_41_n3_0
m_41_n3_1:
  v_smfmac_f32_16x16x64_bf16 v[36:39], v[24:27], v[68:75], v7
  v_smfmac_f32_16x16x64_bf16 v[40:43], v[24:27], v[100:107], v7
  v_smfmac_f32_16x16x64_bf16 v[44:47], v[24:27], v[132:139], v7
  v_smfmac_f32_16x16x64_bf16 v[48:51], v[24:27], v[164:171], v7
  v_smfmac_f32_16x16x64_bf16 v[52:55], v[24:27], v[196:203], v7
  s_waitcnt vmcnt(0)
  v_cmp_u_f32 vcc, v20, v23
  v_smfmac_f32_16x16x64_bf16 v[56:59], v[24:27], v[228:235], v7
  s_cbranch_vccnz m_41_f1_0
  s_branch m_41_n1_0
m_41_f2_1:
  buffer_load_dwordx4 v[24:27], v2, s[24:27], s57 offen offset:1024 sc1
  s_sub_u32 s43, s43, 1
  s_cbranch_scc1 fused_kernel_fin
  s_waitcnt vmcnt(0)
  v_cmp_u_f32 vcc, v24, v27
  s_cbranch_vccnz m_41_f2_1
  s_branch m_41_n2_1
m_41_f1_0:
  buffer_load_dwordx4 v[20:23], v2, s[24:27], s57 offen offset:0 sc1
  s_sub_u32 s43, s43, 1
  s_cbranch_scc1 fused_kernel_fin
  s_waitcnt vmcnt(0)
  v_cmp_u_f32 vcc, v20, v23
  s_cbranch_vccnz m_41_f1_0
  s_branch m_41_n1_0
b_fin_9:
  s_and_b32 s44, s21, 1
  s_lshr_b32 s70, s21, 1
  s_lshl_b32 s54, s20, 1
  s_lshl_b32 s45, s44, 0
  s_add_u32 s54, s54, s45
  s_add_u32 s54, s54, 60
  s_cmp_ge_u32 s20, 2
  s_cbranch_scc1 t_w_48b
  s_lshl_b32 s55, s54, 16
  s_lshl_b32 s45, s22, 12
  s_add_u32 s55, s55, s45
  s_lshl_b32 s45, s70, 10
  s_add_u32 s55, s55, s45
  s_add_u32 s55, s55, 83886080
  s_lshl_b32 s56, s54, 16
  s_lshl_b32 s45, s22, 7
  s_add_u32 s56, s56, s45
  s_lshl_b32 s45, s70, 5
  s_add_u32 s56, s56, s45
  s_lshl_b32 s68, s54, 7
  s_add_u32 s68, s68, 54796288
  v_lshrrev_b32 v112, 4, v2
  v_and_b32 v113, 15, v112
  v_lshlrev_b32 v99, 11, v113
  v_and_b32 v113, 48, v112
  v_lshrrev_b32 v113, 1, v113
  v_lshl_add_u32 v99, v113, 0, v99
  v_and_b32 v113, 15, v112
  v_lshlrev_b32 v100, 2, v113
  s_cmp_ge_u32 s66, 8
  s_cbranch_scc0 t_w_48
t_w_48x:
  s_add_u32 s45, s56, 71303168
  s_add_u32 s46, s56, 71335936
  buffer_load_dword v96, v100, s[24:27], s68 offen offset:0
  buffer_load_dwordx2 v[92:93], v99, s[24:27], s45 offen
  buffer_load_dword v97, v100, s[24:27], s68 offen offset:64
  buffer_load_dwordx2 v[94:95], v99, s[24:27], s46 offen
  s_cmp_eq_u32 s54, 63
  s_cbranch_scc1 t_w_48b
  s_mov_b32 s45, s55
  buffer_load_dwordx4 v[60:63], v2, s[24:27], s45 offen sc1
  s_add_u32 s45, s45, 4194304
  buffer_load_dwordx4 v[64:67], v2, s[24:27], s45 offen sc1
  s_add_u32 s45, s45, 4194304
  buffer_load_dwordx4 v[68:71], v2, s[24:27], s45 offen sc1
  s_add_u32 s45, s45, 4194304
  buffer_load_dwordx4 v[72:75], v2, s[24:27], s45 offen sc1
  s_add_u32 s45, s45, 4194304
  buffer_load_dwordx4 v[76:79], v2, s[24:27], s45 offen sc1
  s_add_u32 s45, s45, 4194304
  buffer_load_dwordx4 v[80:83], v2, s[24:27], s45 offen sc1
  s_add_u32 s45, s45, 4194304
  buffer_load_dwordx4 v[84:87], v2, s[24:27], s45 offen sc1
  s_add_u32 s45, s45, 4194304
  buffer_load_dwordx4 v[88:91], v2, s[24:27], s45 offen sc1
t_w_48b:
  s_barrier
  v_add_u32 v1, s73, v2
  s_lshr_b32 s44, s73, 3
  s_and_b32 s44, s44, 2048
  v_add_u32 v13, s44, v0
  s_xor_b32 s73, s73, 16384
  ds_read_b128 v[20:23], v1 offset:0
  ds_read_b64 v[44:45], v13 offset:28672
  ds_read_b128 v[24:27], v1 offset:4096
  ds_read_b64 v[46:47], v13 offset:29184
  ds_read_b128 v[28:31], v1 offset:8192
  ds_read_b64 v[48:49], v13 offset:29696
  ds_read_b128 v[32:35], v1 offset:12288
  ds_read_b64 v[50:51], v13 offset:30208
  s_waitcnt lgkmcnt(6)
  v_lshlrev_b32 v52, 16, v20
  v_and_b32 v20, 0xffff0000, v20
  v_lshlrev_b32 v53, 16, v21
  v_and_b32 v21, 0xffff0000, v21
  v_lshlrev_b32 v54, 16, v22
  v_and_b32 v22, 0xffff0000, v22
  v_lshlrev_b32 v55, 16, v23
  v_and_b32 v23, 0xffff0000, v23
  v_mul_f32 v36, v52, v44
  v_mul_f32 v37, v20, v44
  v_mul_f32 v38, v53, v44
  v_mul_f32 v39, v21, v44
  v_mul_f32 v40, v54, v45
  v_mul_f32 v41, v22, v45
  v_mul_f32 v42, v55, v45
  v_mul_f32 v43, v23, v45
  s_waitcnt lgkmcnt(4)
  v_lshlrev_b32 v52, 16, v24
  v_and_b32 v24, 0xffff0000, v24
  v_lshlrev_b32 v53, 16, v25
  v_and_b32 v25, 0xffff0000, v25
  v_lshlrev_b32 v54, 16, v26
  v_and_b32 v26, 0xffff0000, v26
  v_lshlrev_b32 v55, 16, v27
  v_and_b32 v27, 0xffff0000, v27
  v_fmac_f32 v36, v52, v46
  v_fmac_f32 v37, v24, v46
  v_fmac_f32 v38, v53, v46
  v_fmac_f32 v39, v25, v46
  v_fmac_f32 v40, v54, v47
  v_fmac_f32 v41, v26, v47
  v_fmac_f32 v42, v55, v47
  v_fmac_f32 v43, v27, v47
  s_waitcnt lgkmcnt(2)
  v_lshlrev_b32 v52, 16, v28
  v_and_b32 v28, 0xffff0000, v28
  v_lshlrev_b32 v53, 16, v29
  v_and_b32 v29, 0xffff0000, v29
  v_lshlrev_b32 v54, 16, v30
  v_and_b32 v30, 0xffff0000, v30
  v_lshlrev_b32 v55, 16, v31
  v_and_b32 v31, 0xffff0000, v31
  v_fmac_f32 v36, v52, v48
  v_fmac_f32 v37, v28, v48
  v_fmac_f32 v38, v53, v48
  v_fmac_f32 v39, v29, v48
  v_fmac_f32 v40, v54, v49
  v_fmac_f32 v41, v30, v49
  v_fmac_f32 v42, v55, v49
  v_fmac_f32 v43, v31, v49
  s_waitcnt lgkmcnt(0)
  v_lshlrev_b32 v52, 16, v32
  v_and_b32 v32, 0xffff0000, v32
  v_lshlrev_b32 v53, 16, v33
  v_and_b32 v33, 0xffff0000, v33
  v_lshlrev_b32 v54, 16, v34
  v_and_b32 v34, 0xffff0000, v34
  v_lshlrev_b32 v55, 16, v35
  v_and_b32 v35, 0xffff0000, v35
  v_fmac_f32 v36, v52, v50
  v_fmac_f32 v37, v32, v50
  v_fmac_f32 v38, v53, v50
  v_fmac_f32 v39, v33, v50
  v_fmac_f32 v40, v54, v51
  v_fmac_f32 v41, v34, v51
  v_fmac_f32 v42, v55, v51
  v_fmac_f32 v43, v35, v51
  v_cvt_pk_bf16_f32 v20, v36, v37
  v_cvt_pk_bf16_f32 v21, v38, v39
  v_cvt_pk_bf16_f32 v22, v40, v41
  v_cvt_pk_bf16_f32 v23, v42, v43
  buffer_store_dwordx4 v[20:23], v2, s[24:27], s72 offen sc1
  s_cmp_gt_u32 s54, 63
  s_cbranch_scc1 fused_kernel_done
  s_waitcnt vmcnt(1)
  s_cmp_eq_u32 s54, 63
  s_cbranch_scc0 t_c_50
  s_sleep 8
  s_branch t_r_49
t_w_48:
  buffer_load_dword v98, off, s[24:27], s65 sc1
  s_sub_u32 s43, s43, 1
  s_cbranch_scc1 fused_kernel_fin
  s_waitcnt vmcnt(0)
  v_cmp_gt_u32 vcc, 8, v98
  s_cbranch_vccz t_w_48x
  s_sleep 8
  s_branch t_w_48
t_r_49:
  s_mov_b32 s45, s55
  buffer_load_dwordx4 v[60:63], v2, s[24:27], s45 offen sc1
  s_add_u32 s45, s45, 4194304
  buffer_load_dwordx4 v[64:67], v2, s[24:27], s45 offen sc1
  s_add_u32 s45, s45, 4194304
  buffer_load_dwordx4 v[68:71], v2, s[24:27], s45 offen sc1
  s_add_u32 s45, s45, 4194304
  buffer_load_dwordx4 v[72:75], v2, s[24:27], s45 offen sc1
  s_add_u32 s45, s45, 4194304
  buffer_load_dwordx4 v[76:79], v2, s[24:27], s45 offen sc1
  s_add_u32 s45, s45, 4194304
  buffer_load_dwordx4 v[80:83], v2, s[24:27], s45 offen sc1
  s_add_u32 s45, s45, 4194304
  buffer_load_dwordx4 v[84:87], v2, s[24:27], s45 offen sc1
  s_add_u32 s45, s45, 4194304
  buffer_load_dwordx4 v[88:91], v2, s[24:27], s45 offen sc1
  s_sub_u32 s43, s43, 1
  s_cbranch_scc1 fused_kernel_fin
t_c_50:
  s_waitcnt vmcnt(7)
  v_lshlrev_b32 v104, 16, v60
  v_and_b32 v105, 0xffff0000, v60
  v_lshlrev_b32 v106, 16, v61
  v_and_b32 v107, 0xffff0000, v61
  v_lshlrev_b32 v108, 16, v62
  v_and_b32 v109, 0xffff0000, v62
  v_lshlrev_b32 v110, 16, v63
  v_and_b32 v111, 0xffff0000, v63
  s_waitcnt vmcnt(6)
  v_lshlrev_b32 v112, 16, v64
  v_and_b32 v64, 0xffff0000, v64
  v_add_f32 v104, v104, v112
  v_add_f32 v105, v105, v64
  v_lshlrev_b32 v113, 16, v65
  v_and_b32 v65, 0xffff0000, v65
  v_add_f32 v106, v106, v113
  v_add_f32 v107, v107, v65
  v_lshlrev_b32 v112, 16, v66
  v_and_b32 v66, 0xffff0000, v66
  v_add_f32 v108, v108, v112
  v_add_f32 v109, v109, v66
  v_lshlrev_b32 v113, 16, v67
  v_and_b32 v67, 0xffff0000, v67
  v_add_f32 v110, v110, v113
  v_add_f32 v111, v111, v67
  s_waitcnt vmcnt(5)
  v_lshlrev_b32 v112, 16, v68
  v_and_b32 v68, 0xffff0000, v68
  v_add_f32 v104, v104, v112
  v_add_f32 v105, v105, v68
  v_lshlrev_b32 v113, 16, v69
  v_and_b32 v69, 0xffff0000, v69
  v_add_f32 v106, v106, v113
  v_add_f32 v107, v107, v69
  v_lshlrev_b32 v112, 16, v70
  v_and_b32 v70, 0xffff0000, v70
  v_add_f32 v108, v108, v112
  v_add_f32 v109, v109, v70
  v_lshlrev_b32 v113, 16, v71
  v_and_b32 v71, 0xffff0000, v71
  v_add_f32 v110, v110, v113
  v_add_f32 v111, v111, v71
  s_waitcnt vmcnt(4)
  v_lshlrev_b32 v112, 16, v72
  v_and_b32 v72, 0xffff0000, v72
  v_add_f32 v104, v104, v112
  v_add_f32 v105, v105, v72
  v_lshlrev_b32 v113, 16, v73
  v_and_b32 v73, 0xffff0000, v73
  v_add_f32 v106, v106, v113
  v_add_f32 v107, v107, v73
  v_lshlrev_b32 v112, 16, v74
  v_and_b32 v74, 0xffff0000, v74
  v_add_f32 v108, v108, v112
  v_add_f32 v109, v109, v74
  v_lshlrev_b32 v113, 16, v75
  v_and_b32 v75, 0xffff0000, v75
  v_add_f32 v110, v110, v113
  v_add_f32 v111, v111, v75
  s_waitcnt vmcnt(3)
  v_lshlrev_b32 v112, 16, v76
  v_and_b32 v76, 0xffff0000, v76
  v_add_f32 v104, v104, v112
  v_add_f32 v105, v105, v76
  v_lshlrev_b32 v113, 16, v77
  v_and_b32 v77, 0xffff0000, v77
  v_add_f32 v106, v106, v113
  v_add_f32 v107, v107, v77
  v_lshlrev_b32 v112, 16, v78
  v_and_b32 v78, 0xffff0000, v78
  v_add_f32 v108, v108, v112
  v_add_f32 v109, v109, v78
  v_lshlrev_b32 v113, 16, v79
  v_and_b32 v79, 0xffff0000, v79
  v_add_f32 v110, v110, v113
  v_add_f32 v111, v111, v79
  s_waitcnt vmcnt(2)
  v_lshlrev_b32 v112, 16, v80
  v_and_b32 v80, 0xffff0000, v80
  v_add_f32 v104, v104, v112
  v_add_f32 v105, v105, v80
  v_lshlrev_b32 v113, 16, v81
  v_and_b32 v81, 0xffff0000, v81
  v_add_f32 v106, v106, v113
  v_add_f32 v107, v107, v81
  v_lshlrev_b32 v112, 16, v82
  v_and_b32 v82, 0xffff0000, v82
  v_add_f32 v108, v108, v112
  v_add_f32 v109, v109, v82
  v_lshlrev_b32 v113, 16, v83
  v_and_b32 v83, 0xffff0000, v83
  v_add_f32 v110, v110, v113
  v_add_f32 v111, v111, v83
  s_waitcnt vmcnt(1)
  v_lshlrev_b32 v112, 16, v84
  v_and_b32 v84, 0xffff0000, v84
  v_add_f32 v104, v104, v112
  v_add_f32 v105, v105, v84
  v_lshlrev_b32 v113, 16, v85
  v_and_b32 v85, 0xffff0000, v85
  v_add_f32 v106, v106, v113
  v_add_f32 v107, v107, v85
  v_lshlrev_b32 v112, 16, v86
  v_and_b32 v86, 0xffff0000, v86
  v_add_f32 v108, v108, v112
  v_add_f32 v109, v109, v86
  v_lshlrev_b32 v113, 16, v87
  v_and_b32 v87, 0xffff0000, v87
  v_add_f32 v110, v110, v113
  v_add_f32 v111, v111, v87
  s_waitcnt vmcnt(0)
  v_lshlrev_b32 v112, 16, v88
  v_and_b32 v88, 0xffff0000, v88
  v_add_f32 v104, v104, v112
  v_add_f32 v105, v105, v88
  v_lshlrev_b32 v113, 16, v89
  v_and_b32 v89, 0xffff0000, v89
  v_add_f32 v106, v106, v113
  v_add_f32 v107, v107, v89
  v_lshlrev_b32 v112, 16, v90
  v_and_b32 v90, 0xffff0000, v90
  v_add_f32 v108, v108, v112
  v_add_f32 v109, v109, v90
  v_lshlrev_b32 v113, 16, v91
  v_and_b32 v91, 0xffff0000, v91
  v_add_f32 v110, v110, v113
  v_add_f32 v111, v111, v91
  v_cmp_u_f32 vcc, v104, v106
  v_cmp_u_f32 s[46:47], v108, v110
  s_nop 0
  s_or_b64 vcc, vcc, s[46:47]
  s_cbranch_scc1 t_r_49
  v_lshlrev_b32 v112, 16, v92
  v_and_b32 v92, 0xffff0000, v92
  v_fma_f32 v104, v104, v96, v112
  v_fma_f32 v105, v105, v96, v92
  v_lshlrev_b32 v113, 16, v93
  v_and_b32 v93, 0xffff0000, v93
  v_fma_f32 v106, v106, v96, v113
  v_fma_f32 v107, v107, v96, v93
  v_lshlrev_b32 v112, 16, v94
  v_and_b32 v94, 0xffff0000, v94
  v_fma_f32 v108, v108, v97, v112
  v_fma_f32 v109, v109, v97, v94
  v_lshlrev_b32 v113, 16, v95
  v_and_b32 v95, 0xffff0000, v95
  v_fma_f32 v110, v110, v97, v113
  v_fma_f32 v111, v111, v97, v95
  v_cvt_pk_bf16_f32 v92, v104, v105
  v_cvt_pk_bf16_f32 v93, v106, v107
  v_cvt_pk_bf16_f32 v94, v108, v109
  v_cvt_pk_bf16_f32 v95, v110, v111
  s_add_u32 s45, s56, 32768
  buffer_store_dwordx2 v[92:93], v99, s[32:35], s56 offen sc1
  buffer_store_dwordx2 v[94:95], v99, s[32:35], s45 offen sc1
  s_branch fused_kernel_done
fused_kernel_c:
  s_and_b32 s44, s22, 14
  s_cmp_lg_u32 s44, 6
  s_cbranch_scc1 fused_kernel_c1
  s_barrier
fused_kernel_c1:
  s_load_dwordx2 s[28:29], s[0:1], 104
  s_sub_u32 s49, s20, 4
  v_and_b32 v1, 63, v0
  v_lshlrev_b32 v4, 4, v1
  v_lshlrev_b32 v0, 3, v1
  s_lshl_b32 s44, s21, 2
  s_add_u32 s44, s44, s49
  s_lshl_b32 s45, s44, 18
  s_lshl_b32 s46, s22, 7
  s_add_u32 s45, s45, s46
  v_and_b32 v2, 56, v1
  v_lshlrev_b32 v11, 8, v2
  v_and_b32 v2, 7, v1
  v_lshl_add_u32 v11, v2, 4, v11
  v_add_u32 v11, s45, v11
  s_lshl_b32 s68, s49, 14
  s_add_u32 s68, s68, 98304
  s_and_b32 s85, s85, 0xffff
  s_mov_b32 s86, 8388608
  s_mov_b32 s87, 0x20000
  v_and_b32 v2, 12, v1
  v_lshlrev_b32 v10, 5, v2
  v_and_b32 v2, 48, v1
  v_lshl_add_u32 v10, v2, 6, v10
  v_and_b32 v2, 3, v1
  v_lshl_add_u32 v10, v2, 3, v10
  v_add_u32 v10, s68, v10
  s_lshl_b32 s54, s44, 13
  s_add_u32 s54, s54, 118489088
  s_lshl_b32 s58, s44, 11
  s_add_u32 s58, s58, 134283264
  s_mov_b32 s59, 0x3e0293ee
  s_lshl_b32 s44, s21, 4
  s_add_u32 s44, s44, s22
  v_and_b32 v2, 1, v1
  v_lshlrev_b32 v5, 4, v2
  v_and_b32 v2, 2, v1
  v_lshl_add_u32 v5, v2, 5, v5
  v_and_b32 v2, 4, v1
  v_lshl_add_u32 v5, v2, 5, v5
  v_and_b32 v2, 8, v1
  v_lshl_add_u32 v5, v2, 7, v5
  v_and_b32 v2, 48, v1
  v_lshl_add_u32 v5, v2, 4, v5
  s_lshl_b32 s45, s49, 5
  s_add_u32 s45, s45, 16777216
  s_cmp_lt_u32 s49, 2
  s_cselect_b32 s45, s45, 0
  s_cselect_b64 vcc, -1, 0
  s_lshl_b32 s46, s44, 11
  s_add_u32 s48, s45, s46
  v_cndmask_b32 v5, v4, v5, vcc
  v_and_b32 v2, 13, v1
  v_lshlrev_b32 v8, 4, v2
  v_and_b32 v2, 16, v1
  v_lshrrev_b32 v2, 1, v2
  v_lshl_add_u32 v8, v2, 0, v8
  v_and_b32 v2, 32, v1
  v_lshl_add_u32 v8, v2, 5, v8
  v_and_b32 v2, 15, v1
  v_lshlrev_b32 v3, 4, v2
  v_and_b32 v2, 16, v1
  v_lshl_add_u32 v3, v2, 6, v3
  v_and_b32 v2, 32, v1
  v_lshrrev_b32 v2, 2, v2
  v_lshl_add_u32 v3, v2, 0, v3
  v_cndmask_b32 v8, v3, v8, vcc
  v_and_b32 v2, 15, v1
  v_lshlrev_b32 v3, 3, v2
  v_and_b32 v2, 48, v1
  v_lshrrev_b32 v2, 3, v2
  v_lshl_add_u32 v3, v2, 0, v3
  s_and_b32 s46, s44, 3
  s_lshl_b32 s45, s49, 5
  s_add_u32 s45, s45, 2048
  s_cmp_lt_u32 s49, 2
  s_cselect_b32 s45, s45, 4096
  s_lshl_b32 s47, s46, 8
  s_add_u32 s45, s45, s47
  s_lshl_b32 s47, s46, 7
  s_add_u32 s47, s47, 6144
  s_cmp_eq_u32 s49, 2
  s_cselect_b32 s45, s47, s45
  s_cselect_b64 vcc, -1, 0
  s_lshr_b32 s46, s44, 2
  s_lshl_b32 s46, s46, 13
  s_add_u32 s46, s46, 118489088
  s_add_u32 s45, s45, s46
  v_cndmask_b32 v8, v8, v3, vcc
  v_add_u32 v8, s45, v8
  v_and_b32 v2, 12, v1
  v_lshlrev_b32 v7, 3, v2
  v_and_b32 v2, 12, v1
  v_lshl_add_u32 v7, v2, 1, v7
  v_and_b32 v2, 48, v1
  v_lshl_add_u32 v7, v2, 4, v7
  v_and_b32 v2, 48, v1
  v_lshl_add_u32 v7, v2, 2, v7
  v_and_b32 v2, 3, v1
  v_lshl_add_u32 v7, v2, 3, v7
  s_lshl_b32 s45, s49, 13
  s_add_u32 s45, s45, 65536
  v_add_u32 v6, s45, v4
  s_lshl_b32 s45, s49, 12
  s_add_u32 s45, s45, 32768
  v_add_u32 v15, s45, v4
  s_lshl_b32 s45, s49, 9
  s_add_u32 s45, s45, 28672
  v_add_u32 v16, s45, v0
  s_lshl_b32 s45, s49, 11
  s_add_u32 s45, s45, 16384
  v_and_b32 v2, 1, v1
  v_lshlrev_b32 v9, 2, v2
  v_and_b32 v2, 12, v1
  v_lshl_add_u32 v9, v2, 3, v9
  v_and_b32 v2, 2, v1
  v_lshl_add_u32 v9, v2, 6, v9
  v_and_b32 v2, 48, v1
  v_lshrrev_b32 v2, 1, v2
  v_lshl_add_u32 v9, v2, 0, v9
  v_add_u32 v9, s45, v9
  s_lshl_b32 s45, s49, 2
  s_add_u32 s45, s45, 24576
  v_mov_b32 v13, s45
  v_mov_b32 v14, 0
  v_mov_b32 v242, 0x3e0293ee
  v_mov_b32 v243, 0x3e0293ee
  v_and_b32 v2, 2, v1
  v_cmp_ne_u32 s[52:53], 0, v2
  v_mov_b32 v2, 0x4444
  v_mov_b32 v3, 0xeeee
  v_cndmask_b32 v12, v2, v3, s[52:53]
  v_and_b32 v40, 1, v1
  v_cmp_ne_u32 vcc, 0, v40
  s_nop 1
  v_cndmask_b32 v2, v2, v3, vcc
  v_lshl_or_b32 v12, v2, 16, v12
  v_and_b32 v2, 1, v1
  v_lshlrev_b32 v3, 4, v2
  v_mov_b32 v2, 0x3f80
  v_lshlrev_b32 v3, v3, v2
  v_and_b32 v2, 6, v1
  v_cmp_eq_u32 vcc, 0, v2
  s_nop 1
  v_cndmask_b32 v32, 0, v3, vcc
  v_cmp_eq_u32 vcc, 2, v2
  s_nop 1
  v_cndmask_b32 v33, 0, v3, vcc
  v_cmp_eq_u32 vcc, 4, v2
  s_nop 1
  v_cndmask_b32 v34, 0, v3, vcc
  v_cmp_eq_u32 vcc, 6, v2
  s_nop 1
  v_cndmask_b32 v35, 0, v3, vcc
  v_and_b32 v2, 8, v1
  v_cmp_ne_u32 vcc, 0, v2
  s_nop 1
  v_cndmask_b32 v36, 0, v32, vcc
  v_sub_u32 v32, v32, v36
  v_cndmask_b32 v37, 0, v33, vcc
  v_sub_u32 v33, v33, v37
  v_cndmask_b32 v38, 0, v34, vcc
  v_sub_u32 v34, v34, v38
  v_cndmask_b32 v39, 0, v35, vcc
  v_sub_u32 v35, v35, v39
  v_and_b32 v2, 4, v1
  v_lshlrev_b32 v3, 2, v2
  v_mov_b32 v2, 0x3f80
  v_lshlrev_b32 v3, v3, v2
  v_cndmask_b32 v21, 0, v3, vcc
  v_sub_u32 v20, v3, v21
  v_mov_b32 v140, 0
  v_mov_b32 v141, 0
  v_mov_b32 v148, 0
  v_mov_b32 v149, 0
  v_mov_b32 v156, 0
  v_mov_b32 v157, 0
  v_mov_b32 v164, 0
  v_mov_b32 v165, 0
  v_mov_b32 v172, 0
  v_mov_b32 v173, 0
  v_mov_b32 v170, 0x3f803f80
  v_mov_b32 v171, 0x3f803f80
  v_mov_b32 v174, 0x3f803f80
  v_mov_b32 v175, 0x3f803f80
  v_mov_b32 v168, 0x3f80
  v_mov_b32 v169, 0x3f80
  v_mov_b32 v2, 0x80000000
  s_cmp_eq_u32 s49, 3
  s_cselect_b64 vcc, -1, 0
  v_cndmask_b32 v240, v2, v5, vcc
  s_cmp_eq_u32 s49, 2
  s_cselect_b64 vcc, -1, 0
  v_cndmask_b32 v5, v5, v2, vcc
  s_barrier
  s_mov_b32 s46, 0
  s_add_u32 m0, s68, 0
  s_nop 0
  buffer_load_dwordx4 v11, s[84:87], s46 offen nt lds
  s_mov_b32 s46, 16384
  s_add_u32 m0, s68, 1024
  s_nop 0
  buffer_load_dwordx4 v11, s[84:87], s46 offen nt lds
  s_mov_b32 s46, 32768
  s_add_u32 m0, s68, 2048
  s_nop 0
  buffer_load_dwordx4 v11, s[84:87], s46 offen nt lds
  s_mov_b32 s46, 49152
  s_add_u32 m0, s68, 3072
  s_nop 0
  buffer_load_dwordx4 v11, s[84:87], s46 offen nt lds
  s_mov_b32 s46, 65536
  s_add_u32 m0, s68, 4096
  s_nop 0
  buffer_load_dwordx4 v11, s[84:87], s46 offen nt lds
  s_mov_b32 s46, 81920
  s_add_u32 m0, s68, 5120
  s_nop 0
  buffer_load_dwordx4 v11, s[84:87], s46 offen nt lds
  s_mov_b32 s46, 98304
  s_add_u32 m0, s68, 6144
  s_nop 0
  buffer_load_dwordx4 v11, s[84:87], s46 offen nt lds
  s_mov_b32 s46, 114688
  s_add_u32 m0, s68, 7168
  s_nop 0
  buffer_load_dwordx4 v11, s[84:87], s46 offen nt lds
  s_mov_b32 s46, 131072
  s_add_u32 m0, s68, 8192
  s_nop 0
  buffer_load_dwordx4 v11, s[84:87], s46 offen nt lds
  s_mov_b32 s46, 147456
  s_add_u32 m0, s68, 9216
  s_nop 0
  buffer_load_dwordx4 v11, s[84:87], s46 offen nt lds
  s_mov_b32 s46, 163840
  s_add_u32 m0, s68, 10240
  s_nop 0
  buffer_load_dwordx4 v11, s[84:87], s46 offen nt lds
  s_mov_b32 s46, 180224
  s_add_u32 m0, s68, 11264
  s_nop 0
  buffer_load_dwordx4 v11, s[84:87], s46 offen nt lds
  s_mov_b32 s46, 196608
  s_add_u32 m0, s68, 12288
  s_nop 0
  buffer_load_dwordx4 v11, s[84:87], s46 offen nt lds
  s_mov_b32 s46, 212992
  s_add_u32 m0, s68, 13312
  s_nop 0
  buffer_load_dwordx4 v11, s[84:87], s46 offen nt lds
  s_mov_b32 s46, 229376
  s_add_u32 m0, s68, 14336
  s_nop 0
  buffer_load_dwordx4 v11, s[84:87], s46 offen nt lds
  s_mov_b32 s46, 245760
  s_add_u32 m0, s68, 15360
  s_nop 0
  buffer_load_dwordx4 v11, s[84:87], s46 offen nt lds
  s_waitcnt lgkmcnt(0)
  s_and_b32 s29, s29, 0xffff
  s_mov_b32 s30, 4194304
  s_mov_b32 s31, 0x20000
  s_mov_b32 s45, 2621440
  s_buffer_load_dword s70, s[28:31], s45
  s_mov_b32 s45, 73924608
  s_buffer_load_dword s70, s[24:27], s45
  s_mov_b32 s45, 54788096
  s_buffer_load_dword s70, s[24:27], s45
  s_lshl_b32 s45, s49, 23
  s_add_u32 s45, s45, 86507520
  s_buffer_load_dword s70, s[24:27], s45
  s_lshl_b32 s45, s49, 23
  s_add_u32 s45, s45, 90701824
  s_buffer_load_dword s70, s[24:27], s45
  s_lshl_b32 s45, s49, 11
  s_lshl_b32 s46, s22, 14
  s_add_u32 s45, s45, s46
  s_lshl_b32 s46, s21, 7
  s_add_u32 s45, s45, s46
  v_and_b32 v2, 2, v1
  v_lshlrev_b32 v11, 9, v2
  v_and_b32 v2, 32, v1
  v_lshl_add_u32 v11, v2, 1, v11
  v_and_b32 v2, 12, v1
  v_lshl_add_u32 v11, v2, 2, v11
  v_and_b32 v2, 1, v1
  v_lshl_add_u32 v11, v2, 3, v11
  v_and_b32 v2, 16, v1
  v_lshrrev_b32 v2, 2, v2
  v_lshl_add_u32 v11, v2, 0, v11
  v_add_u32 v11, s45, v11
  s_mov_b32 s40, 0
  s_mov_b32 s43, 400000
  s_mov_b32 s41, 0
  v_mov_b32 v18, 0
  v_mov_b32 v2, 24608
  v_mov_b32 v3, 1048576
  s_barrier
  buffer_load_dwordx4 v[44:47], v5, s[24:27], s48 offen
  buffer_load_dwordx4 v[48:51], v240, s[24:27], s48 offen offset:1024
  s_add_u32 s48, s48, 262144
  ds_read_b32 v18, v18
  ds_write_b32 v13, v14
  ds_write_b32 v2, v3
  s_waitcnt lgkmcnt(0)
  v_readfirstlane_b32 s23, v18
  s_nop 0
  s_and_b32 s44, s23, 8192
  s_and_b32 s23, s23, 1
  s_add_u32 s60, s60, s44
  v_add_u32 v11, s60, v11
  s_waitcnt vmcnt(2)
  ds_read_b64_tr_b16 v[176:177], v10 offset:0
  ds_read_b64_tr_b16 v[178:179], v10 offset:512
  ds_read_b64_tr_b16 v[180:181], v10 offset:4096
  ds_read_b64_tr_b16 v[182:183], v10 offset:4608
  ds_read_b64_tr_b16 v[184:185], v10 offset:8192
  ds_read_b64_tr_b16 v[186:187], v10 offset:8704
  ds_read_b64_tr_b16 v[188:189], v10 offset:12288
  ds_read_b64_tr_b16 v[190:191], v10 offset:12800
  s_waitcnt lgkmcnt(0)
  ds_read_b64_tr_b16 v[192:193], v10 offset:32
  ds_read_b64_tr_b16 v[194:195], v10 offset:544
  ds_read_b64_tr_b16 v[196:197], v10 offset:4128
  ds_read_b64_tr_b16 v[198:199], v10 offset:4640
  ds_read_b64_tr_b16 v[200:201], v10 offset:8224
  ds_read_b64_tr_b16 v[202:203], v10 offset:8736
  ds_read_b64_tr_b16 v[204:205], v10 offset:12320
  ds_read_b64_tr_b16 v[206:207], v10 offset:12832
  s_waitcnt lgkmcnt(0)
  ds_read_b64_tr_b16 v[208:209], v10 offset:64
  ds_read_b64_tr_b16 v[210:211], v10 offset:576
  ds_read_b64_tr_b16 v[212:213], v10 offset:4160
  ds_read_b64_tr_b16 v[214:215], v10 offset:4672
  ds_read_b64_tr_b16 v[216:217], v10 offset:8256
  ds_read_b64_tr_b16 v[218:219], v10 offset:8768
  ds_read_b64_tr_b16 v[220:221], v10 offset:12352
  ds_read_b64_tr_b16 v[222:223], v10 offset:12864
  s_waitcnt lgkmcnt(0)
  ds_read_b64_tr_b16 v[224:225], v10 offset:96
  ds_read_b64_tr_b16 v[226:227], v10 offset:608
  ds_read_b64_tr_b16 v[228:229], v10 offset:4192
  ds_read_b64_tr_b16 v[230:231], v10 offset:4704
  ds_read_b64_tr_b16 v[232:233], v10 offset:8288
  ds_read_b64_tr_b16 v[234:235], v10 offset:8800
  ds_read_b64_tr_b16 v[236:237], v10 offset:12384
  ds_read_b64_tr_b16 v[238:239], v10 offset:12896
  s_waitcnt lgkmcnt(0)
  s_lshl_b32 s45, s49, 9
  s_add_u32 s45, s45, 16384
  v_add_u32 v10, s45, v0
  s_barrier
  ds_read_b128 v[68:71], v6 offset:0
  ds_read_b128 v[84:87], v6 offset:1024
  ds_read_b128 v[72:75], v6 offset:2048
  ds_read_b128 v[88:91], v6 offset:3072
  ds_read_b128 v[76:79], v6 offset:4096
  ds_read_b128 v[92:95], v6 offset:5120
  ds_read_b128 v[80:83], v6 offset:6144
  ds_read_b128 v[96:99], v6 offset:7168
  s_waitcnt lgkmcnt(0)
  s_add_u32 s56, s54, s41
  s_add_u32 s57, s56, 4096
  s_mov_b32 s50, 0
  v_xor_b32 v6, 32768, v6
  v_add_u32 v14, 1, v14
  v_mfma_f32_16x16x32_bf16 v[100:103], v[68:71], v[176:179], 0
  v_mfma_f32_16x16x32_bf16 v[104:107], v[84:87], v[176:179], 0
  v_mfma_f32_16x16x32_bf16 v[100:103], v[72:75], v[180:183], v[100:103]
  v_mfma_f32_16x16x32_bf16 v[104:107], v[88:91], v[180:183], v[104:107]
  v_mfma_f32_16x16x32_bf16 v[100:103], v[76:79], v[184:187], v[100:103]
  v_mfma_f32_16x16x32_bf16 v[104:107], v[92:95], v[184:187], v[104:107]
  v_mfma_f32_16x16x32_bf16 v[100:103], v[80:83], v[188:191], v[100:103]
  v_mfma_f32_16x16x32_bf16 v[104:107], v[96:99], v[188:191], v[104:107]
  v_mfma_f32_16x16x32_bf16 v[108:111], v[68:71], v[192:195], 0
  v_mfma_f32_16x16x32_bf16 v[112:115], v[84:87], v[192:195], 0
  v_mfma_f32_16x16x32_bf16 v[108:111], v[72:75], v[196:199], v[108:111]
  s_nop 3
  v_cvt_pk_bf16_f32 v138, v100, v101
  v_cvt_pk_bf16_f32 v139, v102, v103
  v_mfma_f32_16x16x32_bf16 v[112:115], v[88:91], v[196:199], v[112:115]
  v_cvt_pk_bf16_f32 v142, v104, v105
  v_cvt_pk_bf16_f32 v143, v106, v107
  v_mfma_f32_16x16x32_bf16 v[108:111], v[76:79], v[200:203], v[108:111]
  v_mov_b32 v100, 0
  v_mov_b32 v101, 0
  v_mfma_f32_16x16x32_bf16 v[112:115], v[92:95], v[200:203], v[112:115]
  v_mov_b32 v102, 0
  v_mov_b32 v103, 0
  v_mfma_f32_16x16x32_bf16 v[108:111], v[80:83], v[204:207], v[108:111]
  v_mov_b32 v104, 0
  v_mov_b32 v105, 0
  v_mfma_f32_16x16x32_bf16 v[112:115], v[96:99], v[204:207], v[112:115]
  v_mov_b32 v106, 0
  v_mov_b32 v107, 0
  v_mfma_f32_16x16x32_bf16 v[116:119], v[68:71], v[208:211], 0
  v_mfma_f32_16x16x32_bf16 v[120:123], v[84:87], v[208:211], 0
  v_mfma_f32_16x16x32_bf16 v[116:119], v[72:75], v[212:215], v[116:119]
  v_cvt_pk_bf16_f32 v146, v108, v109
  v_cvt_pk_bf16_f32 v147, v110, v111
  v_mfma_f32_16x16x32_bf16 v[120:123], v[88:91], v[212:215], v[120:123]
  v_cvt_pk_bf16_f32 v150, v112, v113
  v_cvt_pk_bf16_f32 v151, v114, v115
  v_mfma_f32_16x16x32_bf16 v[116:119], v[76:79], v[216:219], v[116:119]
  v_mov_b32 v108, 0
  v_mov_b32 v109, 0
  v_mfma_f32_16x16x32_bf16 v[120:123], v[92:95], v[216:219], v[120:123]
  v_mov_b32 v110, 0
  v_mov_b32 v111, 0
  v_mfma_f32_16x16x32_bf16 v[116:119], v[80:83], v[220:223], v[116:119]
  v_mov_b32 v112, 0
  v_mov_b32 v113, 0
  v_mfma_f32_16x16x32_bf16 v[120:123], v[96:99], v[220:223], v[120:123]
  v_mov_b32 v114, 0
  v_mov_b32 v115, 0
  v_mfma_f32_16x16x32_bf16 v[124:127], v[68:71], v[224:227], 0
  v_mfma_f32_16x16x32_bf16 v[128:131], v[84:87], v[224:227], 0
  v_mfma_f32_16x16x32_bf16 v[124:127], v[72:75], v[228:231], v[124:127]
  v_cvt_pk_bf16_f32 v154, v116, v117
  v_cvt_pk_bf16_f32 v155, v118, v119
  v_mfma_f32_16x16x32_bf16 v[128:131], v[88:91], v[228:231], v[128:131]
  v_cvt_pk_bf16_f32 v158, v120, v121
  v_cvt_pk_bf16_f32 v159, v122, v123
  v_mfma_f32_16x16x32_bf16 v[124:127], v[76:79], v[232:235], v[124:127]
  v_mov_b32 v116, 0
  v_mov_b32 v117, 0
  v_mfma_f32_16x16x32_bf16 v[128:131], v[92:95], v[232:235], v[128:131]
  v_mov_b32 v118, 0
  v_mov_b32 v119, 0
  v_mfma_f32_16x16x32_bf16 v[124:127], v[80:83], v[236:239], v[124:127]
  v_mov_b32 v120, 0
  v_mov_b32 v121, 0
  v_mfma_f32_16x16x32_bf16 v[128:131], v[96:99], v[236:239], v[128:131]
  v_mov_b32 v122, 0
  v_mov_b32 v123, 0
  v_mov_b32 v132, 0
  v_mov_b32 v133, 0
  v_mov_b32 v134, 0
  v_mov_b32 v135, 0
  v_cvt_pk_bf16_f32 v162, v124, v125
  v_cvt_pk_bf16_f32 v163, v126, v127
  v_cvt_pk_bf16_f32 v166, v128, v129
  v_cvt_pk_bf16_f32 v167, v130, v131
  v_mov_b32 v124, 0
  v_mov_b32 v125, 0
  v_mov_b32 v126, 0
  v_mov_b32 v127, 0
  v_mov_b32 v128, 0
  v_mov_b32 v129, 0
  v_mov_b32 v130, 0
  v_mov_b32 v131, 0
  s_cmp_eq_u32 s23, 0
  s_cbranch_scc1 c_ent0_51
  s_branch c_ent1_52
c_top_54:
  s_waitcnt vmcnt(1)
  buffer_load_dwordx4 v[44:47], v5, s[24:27], s48 offen
  buffer_load_dwordx4 v[48:51], v240, s[24:27], s48 offen offset:1024
  s_add_u32 s48, s48, 262144
  ds_read_b128 v[68:71], v6 offset:0
  ds_read_b128 v[84:87], v6 offset:1024
  ds_read_b128 v[72:75], v6 offset:2048
  ds_read_b128 v[88:91], v6 offset:3072
  ds_read_b128 v[76:79], v6 offset:4096
  ds_read_b128 v[92:95], v6 offset:5120
  ds_read_b128 v[80:83], v6 offset:6144
  ds_read_b128 v[96:99], v6 offset:7168
  s_cmp_le_u32 s40, 4
  s_cbranch_scc1 c_top_54p
c_xr_63:
  v_mfma_f32_16x16x32_bf16 v[60:63], v[32:35], v[52:55], 0
  v_mfma_f32_16x16x32_bf16 v[60:63], v[36:39], v[56:59], v[60:63]
  s_nop 7
  v_fma_f32 v60, v60, s59, -v22
  v_fma_f32 v61, v61, s59, -v22
  v_fma_f32 v62, v62, s59, -v23
  v_fma_f32 v63, v63, s59, -v23
  v_max3_f32 v2, v60, v61, v62
  v_max_f32 v2, v2, v63
  v_cmp_nge_f32 vcc, 0x42800000, v2
  s_cbranch_vccnz c_xb_64
c_xg_65:
  v_exp_f32 v60, v60
  v_exp_f32 v61, v61
  v_exp_f32 v62, v62
  v_exp_f32 v63, v63
  v_cvt_pk_bf16_f32 v22, v60, v60
  v_cvt_pk_bf16_f32 v23, v61, v61
  v_cvt_pk_bf16_f32 v26, v62, v62
  v_cvt_pk_bf16_f32 v27, v63, v63
  s_nop 1
  v_mfma_f32_16x16x32_bf16 v[64:67], v[168:171], v[26:29], 0
  v_mfma_f32_16x16x32_bf16 v[132:135], v[168:171], v[22:25], 0
  v_mfma_f32_16x16x32_bf16 v[64:67], v[172:175], v[28:31], v[64:67]
  v_mfma_f32_16x16x32_bf16 v[104:107], v[136:139], v[26:29], 0
  v_mfma_f32_16x16x32_bf16 v[100:103], v[136:139], v[22:25], 0
  s_nop 4
  v_rcp_f32 v18, v132
  v_rcp_f32 v19, v64
  s_nop 1
  ds_write_b64 v16, v[18:19]
  v_mfma_f32_16x16x32_bf16 v[104:107], v[140:143], v[28:31], v[104:107]
  v_mfma_f32_16x16x32_bf16 v[112:115], v[144:147], v[26:29], 0
  v_mfma_f32_16x16x32_bf16 v[108:111], v[144:147], v[22:25], 0
  v_cvt_pk_bf16_f32 v52, v100, v101
  v_cvt_pk_bf16_f32 v53, v102, v103
  s_nop 3
  v_cvt_pk_bf16_f32 v54, v104, v105
  v_mfma_f32_16x16x32_bf16 v[112:115], v[148:151], v[28:31], v[112:115]
  v_cvt_pk_bf16_f32 v55, v106, v107
  ds_write_b128 v15, v[52:55] offset:0
  v_mfma_f32_16x16x32_bf16 v[120:123], v[152:155], v[26:29], 0
  v_mfma_f32_16x16x32_bf16 v[116:119], v[152:155], v[22:25], 0
  v_cvt_pk_bf16_f32 v56, v108, v109
  v_cvt_pk_bf16_f32 v57, v110, v111
  s_nop 1
  v_cvt_pk_bf16_f32 v58, v112, v113
  v_mfma_f32_16x16x32_bf16 v[120:123], v[156:159], v[28:31], v[120:123]
  v_cvt_pk_bf16_f32 v59, v114, v115
  ds_write_b128 v15, v[56:59] offset:1024
  v_mfma_f32_16x16x32_bf16 v[128:131], v[160:163], v[26:29], 0
  v_mfma_f32_16x16x32_bf16 v[124:127], v[160:163], v[22:25], 0
  v_cvt_pk_bf16_f32 v52, v116, v117
  v_cvt_pk_bf16_f32 v53, v118, v119
  s_nop 1
  v_cvt_pk_bf16_f32 v54, v120, v121
  v_mfma_f32_16x16x32_bf16 v[128:131], v[164:167], v[28:31], v[128:131]
  v_cvt_pk_bf16_f32 v55, v122, v123
  ds_write_b128 v15, v[52:55] offset:2048
  s_waitcnt lgkmcnt(4)
  s_add_u32 s56, s54, s41
  s_add_u32 s57, s56, 4096
  s_mov_b32 s50, 0
  v_xor_b32 v6, 32768, v6
  v_add_u32 v14, 1, v14
  v_mfma_f32_16x16x32_bf16 v[100:103], v[68:71], v[176:179], 0
  v_mfma_f32_16x16x32_bf16 v[104:107], v[84:87], v[176:179], 0
  v_cvt_pk_bf16_f32 v56, v124, v125
  v_cvt_pk_bf16_f32 v57, v126, v127
  v_mfma_f32_16x16x32_bf16 v[100:103], v[72:75], v[180:183], v[100:103]
  v_cvt_pk_bf16_f32 v58, v128, v129
  v_cvt_pk_bf16_f32 v59, v130, v131
  v_mfma_f32_16x16x32_bf16 v[104:107], v[88:91], v[180:183], v[104:107]
  ds_write_b128 v15, v[56:59] offset:3072
  v_mfma_f32_16x16x32_bf16 v[100:103], v[76:79], v[184:187], v[100:103]
  v_mfma_f32_16x16x32_bf16 v[104:107], v[92:95], v[184:187], v[104:107]
  v_mfma_f32_16x16x32_bf16 v[100:103], v[80:83], v[188:191], v[100:103]
  v_mfma_f32_16x16x32_bf16 v[104:107], v[96:99], v[188:191], v[104:107]
  v_mfma_f32_16x16x32_bf16 v[108:111], v[68:71], v[192:195], 0
  v_mfma_f32_16x16x32_bf16 v[112:115], v[84:87], v[192:195], 0
  v_mfma_f32_16x16x32_bf16 v[108:111], v[72:75], v[196:199], v[108:111]
  s_nop 3
  v_cvt_pk_bf16_f32 v138, v100, v101
  v_cvt_pk_bf16_f32 v139, v102, v103
  v_mfma_f32_16x16x32_bf16 v[112:115], v[88:91], v[196:199], v[112:115]
  v_cvt_pk_bf16_f32 v142, v104, v105
  v_cvt_pk_bf16_f32 v143, v106, v107
  v_mfma_f32_16x16x32_bf16 v[108:111], v[76:79], v[200:203], v[108:111]
  v_mov_b32 v100, 0
  v_mov_b32 v101, 0
  v_mfma_f32_16x16x32_bf16 v[112:115], v[92:95], v[200:203], v[112:115]
  v_mov_b32 v102, 0
  v_mov_b32 v103, 0
  v_mfma_f32_16x16x32_bf16 v[108:111], v[80:83], v[204:207], v[108:111]
  v_mov_b32 v104, 0
  v_mov_b32 v105, 0
  v_mfma_f32_16x16x32_bf16 v[112:115], v[96:99], v[204:207], v[112:115]
  v_mov_b32 v106, 0
  v_mov_b32 v107, 0
  v_mfma_f32_16x16x32_bf16 v[116:119], v[68:71], v[208:211], 0
  v_mfma_f32_16x16x32_bf16 v[120:123], v[84:87], v[208:211], 0
  v_mfma_f32_16x16x32_bf16 v[116:119], v[72:75], v[212:215], v[116:119]
  v_cvt_pk_bf16_f32 v146, v108, v109
  v_cvt_pk_bf16_f32 v147, v110, v111
  v_mfma_f32_16x16x32_bf16 v[120:123], v[88:91], v[212:215], v[120:123]
  v_cvt_pk_bf16_f32 v150, v112, v113
  v_cvt_pk_bf16_f32 v151, v114, v115
  v_mfma_f32_16x16x32_bf16 v[116:119], v[76:79], v[216:219], v[116:119]
  v_mov_b32 v108, 0
  v_mov_b32 v109, 0
  v_mfma_f32_16x16x32_bf16 v[120:123], v[92:95], v[216:219], v[120:123]
  v_mov_b32 v110, 0
  v_mov_b32 v111, 0
  v_mfma_f32_16x16x32_bf16 v[116:119], v[80:83], v[220:223], v[116:119]
  v_mov_b32 v112, 0
  v_mov_b32 v113, 0
  v_mfma_f32_16x16x32_bf16 v[120:123], v[96:99], v[220:223], v[120:123]
  v_mov_b32 v114, 0
  v_mov_b32 v115, 0
  v_mfma_f32_16x16x32_bf16 v[124:127], v[68:71], v[224:227], 0
  v_mfma_f32_16x16x32_bf16 v[128:131], v[84:87], v[224:227], 0
  v_mfma_f32_16x16x32_bf16 v[124:127], v[72:75], v[228:231], v[124:127]
  v_cvt_pk_bf16_f32 v154, v116, v117
  v_cvt_pk_bf16_f32 v155, v118, v119
  v_mfma_f32_16x16x32_bf16 v[128:131], v[88:91], v[228:231], v[128:131]
  v_cvt_pk_bf16_f32 v158, v120, v121
  v_cvt_pk_bf16_f32 v159, v122, v123
  v_mfma_f32_16x16x32_bf16 v[124:127], v[76:79], v[232:235], v[124:127]
  v_mov_b32 v116, 0
  v_mov_b32 v117, 0
  v_mfma_f32_16x16x32_bf16 v[128:131], v[92:95], v[232:235], v[128:131]
  v_mov_b32 v118, 0
  v_mov_b32 v119, 0
  v_mfma_f32_16x16x32_bf16 v[124:127], v[80:83], v[236:239], v[124:127]
  v_mov_b32 v120, 0
  v_mov_b32 v121, 0
  v_mfma_f32_16x16x32_bf16 v[128:131], v[96:99], v[236:239], v[128:131]
  v_mov_b32 v122, 0
  v_mov_b32 v123, 0
  v_mov_b32 v132, 0
  v_mov_b32 v133, 0
  v_mov_b32 v134, 0
  v_mov_b32 v135, 0
  v_cvt_pk_bf16_f32 v162, v124, v125
  v_cvt_pk_bf16_f32 v163, v126, v127
  v_cvt_pk_bf16_f32 v166, v128, v129
  v_cvt_pk_bf16_f32 v167, v130, v131
  v_mov_b32 v124, 0
  v_mov_b32 v125, 0
  v_mov_b32 v126, 0
  v_mov_b32 v127, 0
  v_mov_b32 v128, 0
  v_mov_b32 v129, 0
  v_mov_b32 v130, 0
  v_mov_b32 v131, 0
  v_xor_b32 v15, 16384, v15
  v_xor_b32 v16, 2048, v16
c_ent0_51:
  s_waitcnt vmcnt(0) lgkmcnt(0)
  s_setprio 2
  s_cmp_ge_u32 s49, 2
  s_cbranch_scc1 c_r2_60
  s_barrier
  ds_read_b64_tr_b16 v[68:69], v7 offset:0
  ds_read_b64_tr_b16 v[70:71], v7 offset:160
  ds_read_b64_tr_b16 v[72:73], v7 offset:1280
  ds_read_b64_tr_b16 v[74:75], v7 offset:1440
  s_waitcnt lgkmcnt(2)
  v_mfma_f32_16x16x32_bf16 v[84:87], v[44:47], v[68:71], 0
  s_waitcnt lgkmcnt(0)
  v_mfma_f32_16x16x32_bf16 v[84:87], v[44:47], v[72:75], v[84:87]
  s_nop 7
  v_add_f32_dpp v84, v84, v84 quad_perm:[2,3,0,1] row_mask:0xf bank_mask:0xf
  v_add_f32_dpp v85, v85, v85 quad_perm:[2,3,0,1] row_mask:0xf bank_mask:0xf
  v_add_f32_dpp v86, v86, v86 quad_perm:[2,3,0,1] row_mask:0xf bank_mask:0xf
  v_add_f32_dpp v87, v87, v87 quad_perm:[2,3,0,1] row_mask:0xf bank_mask:0xf
  v_cvt_pk_bf16_f32 v84, v84, v85
  v_cvt_pk_bf16_f32 v85, v86, v87
  buffer_store_dwordx2 v[84:85], v8, s[24:27], s41 offen
  s_branch c_j_62
c_r2_60:
  s_cmp_eq_u32 s49, 3
  s_cbranch_scc1 c_r3_61
  s_barrier
  ds_read_b64_tr_b16 v[68:69], v7 offset:0
  ds_read_b64_tr_b16 v[70:71], v7 offset:160
  ds_read_b64_tr_b16 v[76:77], v7 offset:2560
  ds_read_b64_tr_b16 v[78:79], v7 offset:2720
  ds_read_b64_tr_b16 v[72:73], v7 offset:1280
  ds_read_b64_tr_b16 v[74:75], v7 offset:1440
  ds_read_b64_tr_b16 v[80:81], v7 offset:3840
  ds_read_b64_tr_b16 v[82:83], v7 offset:4000
  s_waitcnt lgkmcnt(4)
  v_mfma_f32_16x16x32_bf16 v[84:87], v[76:79], v[68:71], 0
  s_waitcnt lgkmcnt(2)
  v_mfma_f32_16x16x32_bf16 v[84:87], v[76:79], v[72:75], v[84:87]
  s_waitcnt lgkmcnt(0)
  v_mfma_f32_16x16x32_bf16 v[84:87], v[80:83], v[68:71], v[84:87]
  v_mfma_f32_16x16x32_bf16 v[84:87], v[80:83], v[72:75], v[84:87]
  s_nop 7
  v_pk_add_f32 v[84:85], v[84:85], v[86:87]
  v_cndmask_b32 v86, v85, v84, s[52:53]
  v_cndmask_b32 v87, v84, v85, s[52:53]
  s_nop 1
  v_add_f32_dpp v84, v86, v87 quad_perm:[2,3,0,1] row_mask:0xf bank_mask:0xf
  v_mul_f32 v84, s59, v84
  v_cvt_pk_bf16_f32 v84, v84, v84
  buffer_store_short v84, v8, s[24:27], s41 offen
  s_branch c_j_62
c_r3_61:
  s_barrier
  ds_read_b64_tr_b16 v[76:77], v7 offset:2560
  ds_read_b64_tr_b16 v[78:79], v7 offset:2720
  ds_read_b64_tr_b16 v[80:81], v7 offset:3840
  ds_read_b64_tr_b16 v[82:83], v7 offset:4000
  s_waitcnt lgkmcnt(2)
  v_mfma_f32_16x16x32_bf16 v[84:87], v[76:79], v[44:47], 0
  v_mfma_f32_16x16x32_bf16 v[88:91], v[76:79], v[48:51], 0
  s_waitcnt lgkmcnt(0)
  v_mfma_f32_16x16x32_bf16 v[84:87], v[80:83], v[44:47], v[84:87]
  v_mfma_f32_16x16x32_bf16 v[88:91], v[80:83], v[48:51], v[88:91]
  s_nop 6
  v_add_f32 v84, v84, v86
  v_add_f32 v85, v85, v87
  v_cvt_pk_bf16_f32 v84, v84, v85
  v_add_f32 v88, v88, v90
  v_add_f32 v89, v89, v91
  v_cvt_pk_bf16_f32 v85, v88, v89
  buffer_store_dwordx2 v[84:85], v8, s[24:27], s41 offen
c_j_62:
  s_sleep 2
c_p_55:
  buffer_load_dwordx4 v[92:95], v4, s[24:27], s56 offen offset:0 sc1
  buffer_load_dwordx4 v[96:99], v4, s[24:27], s56 offen offset:1024 sc1
  s_sleep 2
  buffer_load_dwordx4 v[68:71], v4, s[24:27], s56 offen offset:2048 sc1
  buffer_load_dwordx4 v[72:75], v4, s[24:27], s56 offen offset:3072 sc1
  buffer_load_dwordx2 v[76:77], v0, s[24:27], s57 offen offset:2048 sc1
c_q_66w:
  s_sub_u32 s43, s43, 1
  s_cbranch_scc1 fused_kernel_fin
  s_waitcnt vmcnt(4)
  v_smfmac_f32_16x16x64_bf16 v[100:103], v[92:95], v[176:183], v12 abid:1
  s_waitcnt vmcnt(3)
  v_smfmac_f32_16x16x64_bf16 v[100:103], v[96:99], v[184:191], v12 abid:1
  v_smfmac_f32_16x16x64_bf16 v[104:107], v[92:95], v[192:199], v12 abid:1
  v_smfmac_f32_16x16x64_bf16 v[104:107], v[96:99], v[200:207], v12 abid:1
  v_smfmac_f32_16x16x64_bf16 v[108:111], v[92:95], v[208:215], v12 abid:1
  v_smfmac_f32_16x16x64_bf16 v[108:111], v[96:99], v[216:223], v12 abid:1
  v_smfmac_f32_16x16x64_bf16 v[112:115], v[92:95], v[224:231], v12 abid:1
  v_smfmac_f32_16x16x64_bf16 v[112:115], v[96:99], v[232:239], v12 abid:1
  s_nop 1
  v_cmp_u_f32 s[44:45], v100, v101
  v_cmp_u_f32 vcc, v102, v103
  v_cvt_pk_bf16_f32 v136, v100, v101
  v_cvt_pk_bf16_f32 v137, v102, v103
  s_or_b64 vcc, vcc, s[44:45]
  s_cbranch_scc1 c_pz_56
  v_cvt_pk_bf16_f32 v144, v104, v105
  v_cvt_pk_bf16_f32 v145, v106, v107
c_q_66l:
  s_waitcnt vmcnt(2)
  v_mfma_f32_16x16x32_bf16 v[60:63], v[32:35], v[68:71], 0
  s_waitcnt vmcnt(1)
  v_mfma_f32_16x16x32_bf16 v[60:63], v[36:39], v[72:75], v[60:63]
  s_waitcnt vmcnt(0)
  v_mfma_f32_16x16x16_bf16 v[64:67], v[20:21], v[76:77], 0
  v_cvt_pk_bf16_f32 v152, v108, v109
  v_cvt_pk_bf16_f32 v153, v110, v111
  v_cvt_pk_bf16_f32 v160, v112, v113
  v_cvt_pk_bf16_f32 v161, v114, v115
  s_nop 1
  v_exp_f32 v80, v60
  v_exp_f32 v81, v61
  v_cmp_u_f32 vcc, v60, v64
  v_exp_f32 v84, v64
  s_cbranch_vccnz c_q_66r
  ds_write_b32 v13, v14
  buffer_load_dwordx4 v[52:55], v4, s[24:27], s57 offen offset:0 sc1
  buffer_load_dwordx4 v[56:59], v4, s[24:27], s57 offen offset:1024 sc1
  buffer_load_dwordx4 v[22:25], v4, s[24:27], s58 offen
  buffer_load_dwordx4 v[28:31], v4, s[24:27], s58 offen offset:1024
  s_add_u32 s58, s58, 262144
  v_exp_f32 v82, v62
  v_exp_f32 v83, v63
  v_cvt_pk_bf16_f32 v40, v84, v84
  v_cvt_pk_bf16_f32 v42, v84, v84
  v_cvt_pk_bf16_f32 v41, v80, v81
  v_cvt_pk_bf16_f32 v43, v82, v83
  v_permlane32_swap_b32 v40, v42
  s_nop 1
  v_smfmac_f32_16x16x64_bf16 v[132:135], v[40:43], v[168:175], v12
  v_smfmac_f32_16x16x64_bf16 v[116:119], v[40:43], v[136:143], v12
  v_smfmac_f32_16x16x64_bf16 v[120:123], v[40:43], v[144:151], v12
c_sm_57:
  v_smfmac_f32_16x16x64_bf16 v[124:127], v[40:43], v[152:159], v12
  s_nop 4
  v_pk_add_f32 v[132:133], v[132:133], v[134:135]
  v_smfmac_f32_16x16x64_bf16 v[128:131], v[40:43], v[160:167], v12
  v_rcp_f32 v18, v132
  v_rcp_f32 v19, v133
  v_pk_add_f32 v[116:117], v[116:117], v[118:119]
  v_pk_mul_f32 v[116:117], v[116:117], v[18:19]
  ds_write2st64_b32 v9, v116, v117 offset0:0 offset1:1
  v_pk_add_f32 v[120:121], v[120:121], v[122:123]
  v_pk_mul_f32 v[120:121], v[120:121], v[18:19]
  ds_write2st64_b32 v9, v120, v121 offset0:2 offset1:3
  v_pk_add_f32 v[124:125], v[124:125], v[126:127]
  v_pk_mul_f32 v[124:125], v[124:125], v[18:19]
  ds_write2st64_b32 v9, v124, v125 offset0:4 offset1:5
  v_pk_add_f32 v[128:129], v[128:129], v[130:131]
  v_pk_mul_f32 v[128:129], v[128:129], v[18:19]
  ds_write2st64_b32 v9, v128, v129 offset0:6 offset1:7
  v_subrev_u32 v132, 0x1f800000, v132
  v_subrev_u32 v133, 0x1f800000, v133
  v_max_u32 v2, v132, v133
  v_cmp_lt_u32 vcc, 0x40000000, v2
  s_add_u32 s40, s40, 1
  s_cbranch_vccnz c_fb_58
c_z_59:
  s_waitcnt lgkmcnt(0)
  s_barrier
  ds_read_b64 v[84:85], v10 offset:0
  ds_read_b64 v[86:87], v10 offset:2048
  ds_read_b64 v[88:89], v10 offset:4096
  ds_read_b64 v[90:91], v10 offset:6144
  s_cmp_eq_u32 s40, 64
  s_waitcnt lgkmcnt(2)
  v_pk_add_f32 v[84:85], v[84:85], v[86:87]
  s_waitcnt lgkmcnt(1)
  v_pk_add_f32 v[84:85], v[84:85], v[88:89]
  s_waitcnt lgkmcnt(0)
  v_pk_add_f32 v[84:85], v[84:85], v[90:91]
  v_cvt_pk_bf16_f32 v18, v84, v85
  buffer_store_dword v18, v11, s[24:27], s41 offen sc1
  s_setprio 0
  s_cbranch_scc1 c_fin_53
  s_add_u32 s41, s41, 262144
  s_and_b32 s41, s41, 786432
  s_branch c_top_54
c_top_54p:
  s_sub_u32 s44, s58, 262144
  s_cmp_eq_u32 s40, 4
  s_cselect_b32 s45, 65536, 0
  s_sub_u32 s58, s58, s45
  v_cmp_u_f32 vcc, v22, v28
  s_cbranch_vccz c_xr_63
c_top_54q:
  buffer_load_dwordx4 v[22:25], v4, s[24:27], s44 offen sc1
  buffer_load_dwordx4 v[28:31], v4, s[24:27], s44 offen offset:1024 sc1
  s_sub_u32 s43, s43, 1
  s_cbranch_scc1 fused_kernel_fin
  s_waitcnt vmcnt(0)
  v_cmp_u_f32 vcc, v22, v28
  s_cbranch_vccnz c_top_54q
  s_branch c_xr_63
c_pz_56:
  buffer_load_dwordx4 v[92:95], v4, s[24:27], s56 offen offset:0 sc1
  buffer_load_dwordx4 v[96:99], v4, s[24:27], s56 offen offset:1024 sc1
  s_nop 7
  v_mov_b32 v100, 0
  v_mov_b32 v101, 0
  v_mov_b32 v102, 0
  v_mov_b32 v103, 0
  v_mov_b32 v104, 0
  v_mov_b32 v105, 0
  v_mov_b32 v106, 0
  v_mov_b32 v107, 0
  v_mov_b32 v108, 0
  v_mov_b32 v109, 0
  v_mov_b32 v110, 0
  v_mov_b32 v111, 0
  v_mov_b32 v112, 0
  v_mov_b32 v113, 0
  v_mov_b32 v114, 0
  v_mov_b32 v115, 0
  s_waitcnt vmcnt(2)
  buffer_load_dwordx4 v[68:71], v4, s[24:27], s56 offen offset:2048 sc1
  buffer_load_dwordx4 v[72:75], v4, s[24:27], s56 offen offset:3072 sc1
  buffer_load_dwordx2 v[76:77], v0, s[24:27], s57 offen offset:2048 sc1
  s_branch c_q_66w
c_q_66r:
  buffer_load_dwordx4 v[68:71], v4, s[24:27], s56 offen offset:2048 sc1
  buffer_load_dwordx4 v[72:75], v4, s[24:27], s56 offen offset:3072 sc1
  buffer_load_dwordx2 v[76:77], v0, s[24:27], s57 offen offset:2048 sc1
  s_sub_u32 s43, s43, 1
  s_cbranch_scc1 fused_kernel_fin
  s_branch c_q_66l
c_xb_64:
  v_cmp_u_f32 vcc, v2, v2
  s_cbranch_vccz c_big_67
  buffer_load_dwordx4 v[52:55], v4, s[24:27], s57 offen offset:0 sc1
  buffer_load_dwordx4 v[56:59], v4, s[24:27], s57 offen offset:1024 sc1
  s_sub_u32 s43, s43, 1
  s_cbranch_scc1 fused_kernel_fin
  s_waitcnt vmcnt(0)
  s_branch c_xr_63
c_big_67:
  v_max3_f32 v2, v60, v61, 0
  v_mov_b32 v3, v2
  s_nop 1
  v_permlane16_swap_b32 v2, v3
  v_max_f32 v2, v2, v3
  v_mov_b32 v3, v2
  s_nop 1
  v_permlane32_swap_b32 v2, v3
  v_max_f32 v2, v2, v3
  v_sub_f32 v60, v60, v2
  v_sub_f32 v61, v61, v2
  v_exp_f32 v2, -v2
  v_lshlrev_b32 v3, 16, v24
  v_and_b32 v24, 0xffff0000, v24
  v_mul_f32 v3, v3, v2
  v_mul_f32 v24, v24, v2
  v_cvt_pk_bf16_f32 v24, v3, v24
  v_lshlrev_b32 v3, 16, v25
  v_and_b32 v25, 0xffff0000, v25
  v_mul_f32 v3, v3, v2
  v_mul_f32 v25, v25, v2
  v_cvt_pk_bf16_f32 v25, v3, v25
  v_max3_f32 v2, v62, v63, 0
  v_mov_b32 v3, v2
  s_nop 1
  v_permlane16_swap_b32 v2, v3
  v_max_f32 v2, v2, v3
  v_mov_b32 v3, v2
  s_nop 1
  v_permlane32_swap_b32 v2, v3
  v_max_f32 v2, v2, v3
  v_sub_f32 v62, v62, v2
  v_sub_f32 v63, v63, v2
  v_exp_f32 v2, -v2
  v_lshlrev_b32 v3, 16, v28
  v_and_b32 v28, 0xffff0000, v28
  v_mul_f32 v3, v3, v2
  v_mul_f32 v28, v28, v2
  v_cvt_pk_bf16_f32 v28, v3, v28
  v_lshlrev_b32 v3, 16, v29
  v_and_b32 v29, 0xffff0000, v29
  v_mul_f32 v3, v3, v2
  v_mul_f32 v29, v29, v2
  v_cvt_pk_bf16_f32 v29, v3, v29
  v_lshlrev_b32 v3, 16, v30
  v_and_b32 v30, 0xffff0000, v30
  v_mul_f32 v3, v3, v2
  v_mul_f32 v30, v30, v2
  v_cvt_pk_bf16_f32 v30, v3, v30
  v_lshlrev_b32 v3, 16, v31
  v_and_b32 v31, 0xffff0000, v31
  v_mul_f32 v3, v3, v2
  v_mul_f32 v31, v31, v2
  v_cvt_pk_bf16_f32 v31, v3, v31
  s_branch c_xg_65
c_fb_58:
  s_cmp_lg_u32 s50, 0
  s_cbranch_scc1 c_z_59
  s_mov_b32 s50, 1
  s_sub_u32 s40, s40, 1
  v_max3_f32 v2, v60, v61, v62
  v_max3_f32 v2, v2, v63, v64
  s_nop 1
  v_max_f32_dpp v2, v2, v2 quad_perm:[2,3,0,1] row_mask:0xf bank_mask:0xf
  v_mov_b32 v3, v2
  s_nop 1
  v_permlane16_swap_b32 v2, v3
  v_max_f32 v2, v2, v3
  v_mov_b32 v3, v2
  s_nop 1
  v_permlane32_swap_b32 v2, v3
  v_max_f32 v2, v2, v3
  v_sub_f32 v60, v60, v2
  v_sub_f32 v61, v61, v2
  v_sub_f32 v62, v62, v2
  v_sub_f32 v63, v63, v2
  v_sub_f32 v64, v64, v2
  v_exp_f32 v80, v60
  v_exp_f32 v81, v61
  v_exp_f32 v84, v64
  v_exp_f32 v82, v62
  v_exp_f32 v83, v63
  v_cvt_pk_bf16_f32 v40, v84, v84
  v_cvt_pk_bf16_f32 v42, v84, v84
  v_cvt_pk_bf16_f32 v41, v80, v81
  v_cvt_pk_bf16_f32 v43, v82, v83
  v_permlane32_swap_b32 v40, v42
  v_mov_b32 v116, 0
  v_mov_b32 v117, 0
  v_mov_b32 v118, 0
  v_mov_b32 v119, 0
  v_mov_b32 v120, 0
  v_mov_b32 v121, 0
  v_mov_b32 v122, 0
  v_mov_b32 v123, 0
  v_mov_b32 v124, 0
  v_mov_b32 v125, 0
  v_mov_b32 v126, 0
  v_mov_b32 v127, 0
  v_mov_b32 v128, 0
  v_mov_b32 v129, 0
  v_mov_b32 v130, 0
  v_mov_b32 v131, 0
  v_mov_b32 v132, 0
  v_mov_b32 v133, 0
  v_mov_b32 v134, 0
  v_mov_b32 v135, 0
  s_nop 1
  v_smfmac_f32_16x16x64_bf16 v[132:135], v[40:43], v[168:175], v12
  v_smfmac_f32_16x16x64_bf16 v[116:119], v[40:43], v[136:143], v12
  v_smfmac_f32_16x16x64_bf16 v[120:123], v[40:43], v[144:151], v12
  s_nop 7
  s_branch c_sm_57
c_top_68:
  s_waitcnt vmcnt(1)
  buffer_load_dwordx4 v[44:47], v5, s[24:27], s48 offen
  buffer_load_dwordx4 v[48:51], v240, s[24:27], s48 offen offset:1024
  s_add_u32 s48, s48, 262144
  ds_read_b128 v[68:71], v6 offset:0
  ds_read_b128 v[84:87], v6 offset:1024
  ds_read_b128 v[72:75], v6 offset:2048
  ds_read_b128 v[88:91], v6 offset:3072
  ds_read_b128 v[76:79], v6 offset:4096
  ds_read_b128 v[92:95], v6 offset:5120
  ds_read_b128 v[80:83], v6 offset:6144
  ds_read_b128 v[96:99], v6 offset:7168
  s_cmp_le_u32 s40, 4
  s_cbranch_scc1 c_top_68p
c_xr_77:
  v_mfma_f32_16x16x32_bf16 v[60:63], v[32:35], v[52:55], 0
  v_mfma_f32_16x16x32_bf16 v[60:63], v[36:39], v[56:59], v[60:63]
  s_nop 7
  v_fma_f32 v60, v60, s59, -v22
  v_fma_f32 v61, v61, s59, -v22
  v_fma_f32 v62, v62, s59, -v23
  v_fma_f32 v63, v63, s59, -v23
  v_max3_f32 v2, v60, v61, v62
  v_max_f32 v2, v2, v63
  v_cmp_nge_f32 vcc, 0x42800000, v2
  s_cbranch_vccnz c_xb_78
c_xg_79:
  v_exp_f32 v60, v60
  v_exp_f32 v61, v61
  v_exp_f32 v62, v62
  v_exp_f32 v63, v63
  v_cvt_pk_bf16_f32 v22, v60, v60
  v_cvt_pk_bf16_f32 v23, v61, v61
  v_cvt_pk_bf16_f32 v26, v62, v62
  v_cvt_pk_bf16_f32 v27, v63, v63
  s_nop 1
  v_mfma_f32_16x16x32_bf16 v[64:67], v[168:171], v[26:29], 0
  v_mfma_f32_16x16x32_bf16 v[132:135], v[168:171], v[22:25], 0
  v_mfma_f32_16x16x32_bf16 v[64:67], v[172:175], v[28:31], v[64:67]
  v_mfma_f32_16x16x32_bf16 v[104:107], v[136:139], v[26:29], 0
  v_mfma_f32_16x16x32_bf16 v[100:103], v[136:139], v[22:25], 0
  s_nop 4
  v_rcp_f32 v18, v132
  v_rcp_f32 v19, v64
  s_nop 1
  ds_write_b64 v16, v[18:19]
  v_mfma_f32_16x16x32_bf16 v[104:107], v[140:143], v[28:31], v[104:107]
  v_mfma_f32_16x16x32_bf16 v[112:115], v[144:147], v[26:29], 0
  v_mfma_f32_16x16x32_bf16 v[108:111], v[144:147], v[22:25], 0
  v_cvt_pk_bf16_f32 v52, v100, v101
  v_cvt_pk_bf16_f32 v53, v102, v103
  s_nop 3
  v_cvt_pk_bf16_f32 v54, v104, v105
  v_mfma_f32_16x16x32_bf16 v[112:115], v[148:151], v[28:31], v[112:115]
  v_cvt_pk_bf16_f32 v55, v106, v107
  ds_write_b128 v15, v[52:55] offset:0
  v_mfma_f32_16x16x32_bf16 v[120:123], v[152:155], v[26:29], 0
  v_mfma_f32_16x16x32_bf16 v[116:119], v[152:155], v[22:25], 0
  v_cvt_pk_bf16_f32 v56, v108, v109
  v_cvt_pk_bf16_f32 v57, v110, v111
  s_nop 1
  v_cvt_pk_bf16_f32 v58, v112, v113
  v_mfma_f32_16x16x32_bf16 v[120:123], v[156:159], v[28:31], v[120:123]
  v_cvt_pk_bf16_f32 v59, v114, v115
  ds_write_b128 v15, v[56:59] offset:1024
  v_mfma_f32_16x16x32_bf16 v[128:131], v[160:163], v[26:29], 0
  v_mfma_f32_16x16x32_bf16 v[124:127], v[160:163], v[22:25], 0
  v_cvt_pk_bf16_f32 v52, v116, v117
  v_cvt_pk_bf16_f32 v53, v118, v119
  s_nop 1
  v_cvt_pk_bf16_f32 v54, v120, v121
  v_mfma_f32_16x16x32_bf16 v[128:131], v[164:167], v[28:31], v[128:131]
  v_cvt_pk_bf16_f32 v55, v122, v123
  ds_write_b128 v15, v[52:55] offset:2048
  s_waitcnt lgkmcnt(4)
  s_add_u32 s56, s54, s41
  s_add_u32 s57, s56, 4096
  s_mov_b32 s50, 0
  v_xor_b32 v6, 32768, v6
  v_add_u32 v14, 1, v14
  v_mfma_f32_16x16x32_bf16 v[100:103], v[68:71], v[176:179], 0
  v_mfma_f32_16x16x32_bf16 v[104:107], v[84:87], v[176:179], 0
  v_cvt_pk_bf16_f32 v56, v124, v125
  v_cvt_pk_bf16_f32 v57, v126, v127
  v_mfma_f32_16x16x32_bf16 v[100:103], v[72:75], v[180:183], v[100:103]
  v_cvt_pk_bf16_f32 v58, v128, v129
  v_cvt_pk_bf16_f32 v59, v130, v131
  v_mfma_f32_16x16x32_bf16 v[104:107], v[88:91], v[180:183], v[104:107]
  ds_write_b128 v15, v[56:59] offset:3072
  v_mfma_f32_16x16x32_bf16 v[100:103], v[76:79], v[184:187], v[100:103]
  v_mfma_f32_16x16x32_bf16 v[104:107], v[92:95], v[184:187], v[104:107]
  v_mfma_f32_16x16x32_bf16 v[100:103], v[80:83], v[188:191], v[100:103]
  v_mfma_f32_16x16x32_bf16 v[104:107], v[96:99], v[188:191], v[104:107]
  v_mfma_f32_16x16x32_bf16 v[108:111], v[68:71], v[192:195], 0
  v_mfma_f32_16x16x32_bf16 v[112:115], v[84:87], v[192:195], 0
  v_mfma_f32_16x16x32_bf16 v[108:111], v[72:75], v[196:199], v[108:111]
  s_nop 3
  v_cvt_pk_bf16_f32 v138, v100, v101
  v_cvt_pk_bf16_f32 v139, v102, v103
  v_mfma_f32_16x16x32_bf16 v[112:115], v[88:91], v[196:199], v[112:115]
  v_cvt_pk_bf16_f32 v142, v104, v105
  v_cvt_pk_bf16_f32 v143, v106, v107
  v_mfma_f32_16x16x32_bf16 v[108:111], v[76:79], v[200:203], v[108:111]
  v_mov_b32 v100, 0
  v_mov_b32 v101, 0
  v_mfma_f32_16x16x32_bf16 v[112:115], v[92:95], v[200:203], v[112:115]
  v_mov_b32 v102, 0
  v_mov_b32 v103, 0
  v_mfma_f32_16x16x32_bf16 v[108:111], v[80:83], v[204:207], v[108:111]
  v_mov_b32 v104, 0
  v_mov_b32 v105, 0
  v_mfma_f32_16x16x32_bf16 v[112:115], v[96:99], v[204:207], v[112:115]
  v_mov_b32 v106, 0
  v_mov_b32 v107, 0
  v_mfma_f32_16x16x32_bf16 v[116:119], v[68:71], v[208:211], 0
  v_mfma_f32_16x16x32_bf16 v[120:123], v[84:87], v[208:211], 0
  v_mfma_f32_16x16x32_bf16 v[116:119], v[72:75], v[212:215], v[116:119]
  v_cvt_pk_bf16_f32 v146, v108, v109
  v_cvt_pk_bf16_f32 v147, v110, v111
  v_mfma_f32_16x16x32_bf16 v[120:123], v[88:91], v[212:215], v[120:123]
  v_cvt_pk_bf16_f32 v150, v112, v113
  v_cvt_pk_bf16_f32 v151, v114, v115
  v_mfma_f32_16x16x32_bf16 v[116:119], v[76:79], v[216:219], v[116:119]
  v_mov_b32 v108, 0
  v_mov_b32 v109, 0
  v_mfma_f32_16x16x32_bf16 v[120:123], v[92:95], v[216:219], v[120:123]
  v_mov_b32 v110, 0
  v_mov_b32 v111, 0
  v_mfma_f32_16x16x32_bf16 v[116:119], v[80:83], v[220:223], v[116:119]
  v_mov_b32 v112, 0
  v_mov_b32 v113, 0
  v_mfma_f32_16x16x32_bf16 v[120:123], v[96:99], v[220:223], v[120:123]
  v_mov_b32 v114, 0
  v_mov_b32 v115, 0
  v_mfma_f32_16x16x32_bf16 v[124:127], v[68:71], v[224:227], 0
  v_mfma_f32_16x16x32_bf16 v[128:131], v[84:87], v[224:227], 0
  v_mfma_f32_16x16x32_bf16 v[124:127], v[72:75], v[228:231], v[124:127]
  v_cvt_pk_bf16_f32 v154, v116, v117
  v_cvt_pk_bf16_f32 v155, v118, v119
  v_mfma_f32_16x16x32_bf16 v[128:131], v[88:91], v[228:231], v[128:131]
  v_cvt_pk_bf16_f32 v158, v120, v121
  v_cvt_pk_bf16_f32 v159, v122, v123
  v_mfma_f32_16x16x32_bf16 v[124:127], v[76:79], v[232:235], v[124:127]
  v_mov_b32 v116, 0
  v_mov_b32 v117, 0
  v_mfma_f32_16x16x32_bf16 v[128:131], v[92:95], v[232:235], v[128:131]
  v_mov_b32 v118, 0
  v_mov_b32 v119, 0
  v_mfma_f32_16x16x32_bf16 v[124:127], v[80:83], v[236:239], v[124:127]
  v_mov_b32 v120, 0
  v_mov_b32 v121, 0
  v_mfma_f32_16x16x32_bf16 v[128:131], v[96:99], v[236:239], v[128:131]
  v_mov_b32 v122, 0
  v_mov_b32 v123, 0
  v_mov_b32 v132, 0
  v_mov_b32 v133, 0
  v_mov_b32 v134, 0
  v_mov_b32 v135, 0
  v_cvt_pk_bf16_f32 v162, v124, v125
  v_cvt_pk_bf16_f32 v163, v126, v127
  v_cvt_pk_bf16_f32 v166, v128, v129
  v_cvt_pk_bf16_f32 v167, v130, v131
  v_mov_b32 v124, 0
  v_mov_b32 v125, 0
  v_mov_b32 v126, 0
  v_mov_b32 v127, 0
  v_mov_b32 v128, 0
  v_mov_b32 v129, 0
  v_mov_b32 v130, 0
  v_mov_b32 v131, 0
  v_xor_b32 v15, 16384, v15
  v_xor_b32 v16, 2048, v16
c_ent1_52:
  s_waitcnt vmcnt(0) lgkmcnt(0)
  s_setprio 2
  s_cmp_ge_u32 s49, 2
  s_cbranch_scc1 c_r2_74
  s_barrier
  ds_read_b64_tr_b16 v[68:69], v7 offset:0
  ds_read_b64_tr_b16 v[70:71], v7 offset:160
  ds_read_b64_tr_b16 v[72:73], v7 offset:1280
  ds_read_b64_tr_b16 v[74:75], v7 offset:1440
  s_waitcnt lgkmcnt(2)
  v_mfma_f32_16x16x32_bf16 v[84:87], v[44:47], v[68:71], 0
  s_waitcnt lgkmcnt(0)
  v_mfma_f32_16x16x32_bf16 v[84:87], v[44:47], v[72:75], v[84:87]
  s_nop 7
  v_add_f32_dpp v84, v84, v84 quad_perm:[2,3,0,1] row_mask:0xf bank_mask:0xf
  v_add_f32_dpp v85, v85, v85 quad_perm:[2,3,0,1] row_mask:0xf bank_mask:0xf
  v_add_f32_dpp v86, v86, v86 quad_perm:[2,3,0,1] row_mask:0xf bank_mask:0xf
  v_add_f32_dpp v87, v87, v87 quad_perm:[2,3,0,1] row_mask:0xf bank_mask:0xf
  v_cvt_pk_bf16_f32 v84, v84, v85
  v_cvt_pk_bf16_f32 v85, v86, v87
  buffer_store_dwordx2 v[84:85], v8, s[24:27], s41 offen sc1
  s_branch c_j_76
c_r2_74:
  s_cmp_eq_u32 s49, 3
  s_cbranch_scc1 c_r3_75
  s_barrier
  ds_read_b64_tr_b16 v[68:69], v7 offset:0
  ds_read_b64_tr_b16 v[70:71], v7 offset:160
  ds_read_b64_tr_b16 v[76:77], v7 offset:2560
  ds_read_b64_tr_b16 v[78:79], v7 offset:2720
  ds_read_b64_tr_b16 v[72:73], v7 offset:1280
  ds_read_b64_tr_b16 v[74:75], v7 offset:1440
  ds_read_b64_tr_b16 v[80:81], v7 offset:3840
  ds_read_b64_tr_b16 v[82:83], v7 offset:4000
  s_waitcnt lgkmcnt(4)
  v_mfma_f32_16x16x32_bf16 v[84:87], v[76:79], v[68:71], 0
  s_waitcnt lgkmcnt(2)
  v_mfma_f32_16x16x32_bf16 v[84:87], v[76:79], v[72:75], v[84:87]
  s_waitcnt lgkmcnt(0)
  v_mfma_f32_16x16x32_bf16 v[84:87], v[80:83], v[68:71], v[84:87]
  v_mfma_f32_16x16x32_bf16 v[84:87], v[80:83], v[72:75], v[84:87]
  s_nop 7
  v_pk_add_f32 v[84:85], v[84:85], v[86:87]
  v_cndmask_b32 v86, v85, v84, s[52:53]
  v_cndmask_b32 v87, v84, v85, s[52:53]
  s_nop 1
  v_add_f32_dpp v84, v86, v87 quad_perm:[2,3,0,1] row_mask:0xf bank_mask:0xf
  v_mul_f32 v84, s59, v84
  v_cvt_pk_bf16_f32 v84, v84, v84
  buffer_store_short v84, v8, s[24:27], s41 offen sc1
  s_branch c_j_76
c_r3_75:
  s_barrier
  ds_read_b64_tr_b16 v[76:77], v7 offset:2560
  ds_read_b64_tr_b16 v[78:79], v7 offset:2720
  ds_read_b64_tr_b16 v[80:81], v7 offset:3840
  ds_read_b64_tr_b16 v[82:83], v7 offset:4000
  s_waitcnt lgkmcnt(2)
  v_mfma_f32_16x16x32_bf16 v[84:87], v[76:79], v[44:47], 0
  v_mfma_f32_16x16x32_bf16 v[88:91], v[76:79], v[48:51], 0
  s_waitcnt lgkmcnt(0)
  v_mfma_f32_16x16x32_bf16 v[84:87], v[80:83], v[44:47], v[84:87]
  v_mfma_f32_16x16x32_bf16 v[88:91], v[80:83], v[48:51], v[88:91]
  s_nop 6
  v_add_f32 v84, v84, v86
  v_add_f32 v85, v85, v87
  v_cvt_pk_bf16_f32 v84, v84, v85
  v_add_f32 v88, v88, v90
  v_add_f32 v89, v89, v91
  v_cvt_pk_bf16_f32 v85, v88, v89
  buffer_store_dwordx2 v[84:85], v8, s[24:27], s41 offen sc1
c_j_76:
  s_sleep 2
c_p_69:
  buffer_load_dwordx4 v[92:95], v4, s[24:27], s56 offen offset:0 sc1
  buffer_load_dwordx4 v[96:99], v4, s[24:27], s56 offen offset:1024 sc1
  s_sleep 2
  buffer_load_dwordx4 v[68:71], v4, s[24:27], s56 offen offset:2048 sc1
  buffer_load_dwordx4 v[72:75], v4, s[24:27], s56 offen offset:3072 sc1
  buffer_load_dwordx2 v[76:77], v0, s[24:27], s57 offen offset:2048 sc1
c_q_80w:
  s_sub_u32 s43, s43, 1
  s_cbranch_scc1 fused_kernel_fin
  s_waitcnt vmcnt(4)
  v_smfmac_f32_16x16x64_bf16 v[100:103], v[92:95], v[176:183], v12 abid:1
  s_waitcnt vmcnt(3)
  v_smfmac_f32_16x16x64_bf16 v[100:103], v[96:99], v[184:191], v12 abid:1
  v_smfmac_f32_16x16x64_bf16 v[104:107], v[92:95], v[192:199], v12 abid:1
  v_smfmac_f32_16x16x64_bf16 v[104:107], v[96:99], v[200:207], v12 abid:1
  v_smfmac_f32_16x16x64_bf16 v[108:111], v[92:95], v[208:215], v12 abid:1
  v_smfmac_f32_16x16x64_bf16 v[108:111], v[96:99], v[216:223], v12 abid:1
  v_smfmac_f32_16x16x64_bf16 v[112:115], v[92:95], v[224:231], v12 abid:1
  v_smfmac_f32_16x16x64_bf16 v[112:115], v[96:99], v[232:239], v12 abid:1
  s_nop 1
  v_cmp_u_f32 s[44:45], v100, v101
  v_cmp_u_f32 vcc, v102, v103
  v_cvt_pk_bf16_f32 v136, v100, v101
  v_cvt_pk_bf16_f32 v137, v102, v103
  s_or_b64 vcc, vcc, s[44:45]
  s_cbranch_scc1 c_pz_70
  v_cvt_pk_bf16_f32 v144, v104, v105
  v_cvt_pk_bf16_f32 v145, v106, v107
c_q_80l:
  s_waitcnt vmcnt(2)
  v_mfma_f32_16x16x32_bf16 v[60:63], v[32:35], v[68:71], 0
  s_waitcnt vmcnt(1)
  v_mfma_f32_16x16x32_bf16 v[60:63], v[36:39], v[72:75], v[60:63]
  s_waitcnt vmcnt(0)
  v_mfma_f32_16x16x16_bf16 v[64:67], v[20:21], v[76:77], 0
  v_cvt_pk_bf16_f32 v152, v108, v109
  v_cvt_pk_bf16_f32 v153, v110, v111
  v_cvt_pk_bf16_f32 v160, v112, v113
  v_cvt_pk_bf16_f32 v161, v114, v115
  s_nop 1
  v_exp_f32 v80, v60
  v_exp_f32 v81, v61
  v_cmp_u_f32 vcc, v60, v64
  v_exp_f32 v84, v64
  s_cbranch_vccnz c_q_80r
  ds_write_b32 v13, v14
  buffer_load_dwordx4 v[52:55], v4, s[24:27], s57 offen offset:0 sc1
  buffer_load_dwordx4 v[56:59], v4, s[24:27], s57 offen offset:1024 sc1
  buffer_load_dwordx4 v[22:25], v4, s[24:27], s58 offen
  buffer_load_dwordx4 v[28:31], v4, s[24:27], s58 offen offset:1024
  s_add_u32 s58, s58, 262144
  v_exp_f32 v82, v62
  v_exp_f32 v83, v63
  v_cvt_pk_bf16_f32 v40, v84, v84
  v_cvt_pk_bf16_f32 v42, v84, v84
  v_cvt_pk_bf16_f32 v41, v80, v81
  v_cvt_pk_bf16_f32 v43, v82, v83
  v_permlane32_swap_b32 v40, v42
  s_nop 1
  v_smfmac_f32_16x16x64_bf16 v[132:135], v[40:43], v[168:175], v12
  v_smfmac_f32_16x16x64_bf16 v[116:119], v[40:43], v[136:143], v12
  v_smfmac_f32_16x16x64_bf16 v[120:123], v[40:43], v[144:151], v12
c_sm_71:
  v_smfmac_f32_16x16x64_bf16 v[124:127], v[40:43], v[152:159], v12
  s_nop 4
  v_pk_add_f32 v[132:133], v[132:133], v[134:135]
  v_smfmac_f32_16x16x64_bf16 v[128:131], v[40:43], v[160:167], v12
  v_rcp_f32 v18, v132
  v_rcp_f32 v19, v133
  v_pk_add_f32 v[116:117], v[116:117], v[118:119]
  v_pk_mul_f32 v[116:117], v[116:117], v[18:19]
  ds_write2st64_b32 v9, v116, v117 offset0:0 offset1:1
  v_pk_add_f32 v[120:121], v[120:121], v[122:123]
  v_pk_mul_f32 v[120:121], v[120:121], v[18:19]
  ds_write2st64_b32 v9, v120, v121 offset0:2 offset1:3
  v_pk_add_f32 v[124:125], v[124:125], v[126:127]
  v_pk_mul_f32 v[124:125], v[124:125], v[18:19]
  ds_write2st64_b32 v9, v124, v125 offset0:4 offset1:5
  v_pk_add_f32 v[128:129], v[128:129], v[130:131]
  v_pk_mul_f32 v[128:129], v[128:129], v[18:19]
  ds_write2st64_b32 v9, v128, v129 offset0:6 offset1:7
  v_subrev_u32 v132, 0x1f800000, v132
  v_subrev_u32 v133, 0x1f800000, v133
  v_max_u32 v2, v132, v133
  v_cmp_lt_u32 vcc, 0x40000000, v2
  s_add_u32 s40, s40, 1
  s_cbranch_vccnz c_fb_72
c_z_73:
  s_waitcnt lgkmcnt(0)
  s_barrier
  ds_read_b64 v[84:85], v10 offset:0
  ds_read_b64 v[86:87], v10 offset:2048
  ds_read_b64 v[88:89], v10 offset:4096
  ds_read_b64 v[90:91], v10 offset:6144
  s_cmp_eq_u32 s40, 64
  s_waitcnt lgkmcnt(2)
  v_pk_add_f32 v[84:85], v[84:85], v[86:87]
  s_waitcnt lgkmcnt(1)
  v_pk_add_f32 v[84:85], v[84:85], v[88:89]
  s_waitcnt lgkmcnt(0)
  v_pk_add_f32 v[84:85], v[84:85], v[90:91]
  v_cvt_pk_bf16_f32 v18, v84, v85
  buffer_store_dword v18, v11, s[24:27], s41 offen sc1
  s_setprio 0
  s_cbranch_scc1 c_fin_53
  s_add_u32 s41, s41, 262144
  s_and_b32 s41, s41, 786432
  s_branch c_top_68
c_top_68p:
  s_sub_u32 s44, s58, 262144
  s_cmp_eq_u32 s40, 4
  s_cselect_b32 s45, 65536, 0
  s_sub_u32 s58, s58, s45
  v_cmp_u_f32 vcc, v22, v28
  s_cbranch_vccz c_xr_77
c_top_68q:
  buffer_load_dwordx4 v[22:25], v4, s[24:27], s44 offen sc1
  buffer_load_dwordx4 v[28:31], v4, s[24:27], s44 offen offset:1024 sc1
  s_sub_u32 s43, s43, 1
  s_cbranch_scc1 fused_kernel_fin
  s_waitcnt vmcnt(0)
  v_cmp_u_f32 vcc, v22, v28
  s_cbranch_vccnz c_top_68q
  s_branch c_xr_77
c_pz_70:
  buffer_load_dwordx4 v[92:95], v4, s[24:27], s56 offen offset:0 sc1
  buffer_load_dwordx4 v[96:99], v4, s[24:27], s56 offen offset:1024 sc1
  s_nop 7
  v_mov_b32 v100, 0
  v_mov_b32 v101, 0
  v_mov_b32 v102, 0
  v_mov_b32 v103, 0
  v_mov_b32 v104, 0
  v_mov_b32 v105, 0
  v_mov_b32 v106, 0
  v_mov_b32 v107, 0
  v_mov_b32 v108, 0
  v_mov_b32 v109, 0
  v_mov_b32 v110, 0
  v_mov_b32 v111, 0
  v_mov_b32 v112, 0
  v_mov_b32 v113, 0
  v_mov_b32 v114, 0
  v_mov_b32 v115, 0
  s_waitcnt vmcnt(2)
  buffer_load_dwordx4 v[68:71], v4, s[24:27], s56 offen offset:2048 sc1
  buffer_load_dwordx4 v[72:75], v4, s[24:27], s56 offen offset:3072 sc1
  buffer_load_dwordx2 v[76:77], v0, s[24:27], s57 offen offset:2048 sc1
  s_branch c_q_80w
c_q_80r:
  buffer_load_dwordx4 v[68:71], v4, s[24:27], s56 offen offset:2048 sc1
  buffer_load_dwordx4 v[72:75], v4, s[24:27], s56 offen offset:3072 sc1
  buffer_load_dwordx2 v[76:77], v0, s[24:27], s57 offen offset:2048 sc1
  s_sub_u32 s43, s43, 1
  s_cbranch_scc1 fused_kernel_fin
  s_branch c_q_80l
c_xb_78:
  v_cmp_u_f32 vcc, v2, v2
  s_cbranch_vccz c_big_81
  buffer_load_dwordx4 v[52:55], v4, s[24:27], s57 offen offset:0 sc1
  buffer_load_dwordx4 v[56:59], v4, s[24:27], s57 offen offset:1024 sc1
  s_sub_u32 s43, s43, 1
  s_cbranch_scc1 fused_kernel_fin
  s_waitcnt vmcnt(0)
  s_branch c_xr_77
c_big_81:
  v_max3_f32 v2, v60, v61, 0
  v_mov_b32 v3, v2
  s_nop 1
  v_permlane16_swap_b32 v2, v3
  v_max_f32 v2, v2, v3
  v_mov_b32 v3, v2
  s_nop 1
  v_permlane32_swap_b32 v2, v3
  v_max_f32 v2, v2, v3
  v_sub_f32 v60, v60, v2
  v_sub_f32 v61, v61, v2
  v_exp_f32 v2, -v2
  v_lshlrev_b32 v3, 16, v24
  v_and_b32 v24, 0xffff0000, v24
  v_mul_f32 v3, v3, v2
  v_mul_f32 v24, v24, v2
  v_cvt_pk_bf16_f32 v24, v3, v24
  v_lshlrev_b32 v3, 16, v25
  v_and_b32 v25, 0xffff0000, v25
  v_mul_f32 v3, v3, v2
  v_mul_f32 v25, v25, v2
  v_cvt_pk_bf16_f32 v25, v3, v25
  v_max3_f32 v2, v62, v63, 0
  v_mov_b32 v3, v2
  s_nop 1
  v_permlane16_swap_b32 v2, v3
  v_max_f32 v2, v2, v3
  v_mov_b32 v3, v2
  s_nop 1
  v_permlane32_swap_b32 v2, v3
  v_max_f32 v2, v2, v3
  v_sub_f32 v62, v62, v2
  v_sub_f32 v63, v63, v2
  v_exp_f32 v2, -v2
  v_lshlrev_b32 v3, 16, v28
  v_and_b32 v28, 0xffff0000, v28
  v_mul_f32 v3, v3, v2
  v_mul_f32 v28, v28, v2
  v_cvt_pk_bf16_f32 v28, v3, v28
  v_lshlrev_b32 v3, 16, v29
  v_and_b32 v29, 0xffff0000, v29
  v_mul_f32 v3, v3, v2
  v_mul_f32 v29, v29, v2
  v_cvt_pk_bf16_f32 v29, v3, v29
  v_lshlrev_b32 v3, 16, v30
  v_and_b32 v30, 0xffff0000, v30
  v_mul_f32 v3, v3, v2
  v_mul_f32 v30, v30, v2
  v_cvt_pk_bf16_f32 v30, v3, v30
  v_lshlrev_b32 v3, 16, v31
  v_and_b32 v31, 0xffff0000, v31
  v_mul_f32 v3, v3, v2
  v_mul_f32 v31, v31, v2
  v_cvt_pk_bf16_f32 v31, v3, v31
  s_branch c_xg_79
c_fb_72:
  s_cmp_lg_u32 s50, 0
  s_cbranch_scc1 c_z_73
  s_mov_b32 s50, 1
  s_sub_u32 s40, s40, 1
  v_max3_f32 v2, v60, v61, v62
  v_max3_f32 v2, v2, v63, v64
  s_nop 1
  v_max_f32_dpp v2, v2, v2 quad_perm:[2,3,0,1] row_mask:0xf bank_mask:0xf
  v_mov_b32 v3, v2
  s_nop 1
  v_permlane16_swap_b32 v2, v3
  v_max_f32 v2, v2, v3
  v_mov_b32 v3, v2
  s_nop 1
  v_permlane32_swap_b32 v2, v3
  v_max_f32 v2, v2, v3
  v_sub_f32 v60, v60, v2
  v_sub_f32 v61, v61, v2
  v_sub_f32 v62, v62, v2
  v_sub_f32 v63, v63, v2
  v_sub_f32 v64, v64, v2
  v_exp_f32 v80, v60
  v_exp_f32 v81, v61
  v_exp_f32 v84, v64
  v_exp_f32 v82, v62
  v_exp_f32 v83, v63
  v_cvt_pk_bf16_f32 v40, v84, v84
  v_cvt_pk_bf16_f32 v42, v84, v84
  v_cvt_pk_bf16_f32 v41, v80, v81
  v_cvt_pk_bf16_f32 v43, v82, v83
  v_permlane32_swap_b32 v40, v42
  v_mov_b32 v116, 0
  v_mov_b32 v117, 0
  v_mov_b32 v118, 0
  v_mov_b32 v119, 0
  v_mov_b32 v120, 0
  v_mov_b32 v121, 0
  v_mov_b32 v122, 0
  v_mov_b32 v123, 0
  v_mov_b32 v124, 0
  v_mov_b32 v125, 0
  v_mov_b32 v126, 0
  v_mov_b32 v127, 0
  v_mov_b32 v128, 0
  v_mov_b32 v129, 0
  v_mov_b32 v130, 0
  v_mov_b32 v131, 0
  v_mov_b32 v132, 0
  v_mov_b32 v133, 0
  v_mov_b32 v134, 0
  v_mov_b32 v135, 0
  s_nop 1
  v_smfmac_f32_16x16x64_bf16 v[132:135], v[40:43], v[168:175], v12
  v_smfmac_f32_16x16x64_bf16 v[116:119], v[40:43], v[136:143], v12
  v_smfmac_f32_16x16x64_bf16 v[120:123], v[40:43], v[144:151], v12
  s_nop 7
  s_branch c_sm_71
c_fin_53:
  s_waitcnt vmcnt(1)
c_xr_82:
  v_mfma_f32_16x16x32_bf16 v[60:63], v[32:35], v[52:55], 0
  v_mfma_f32_16x16x32_bf16 v[60:63], v[36:39], v[56:59], v[60:63]
  s_nop 7
  v_fma_f32 v60, v60, s59, -v22
  v_fma_f32 v61, v61, s59, -v22
  v_fma_f32 v62, v62, s59, -v23
  v_fma_f32 v63, v63, s59, -v23
  v_max3_f32 v2, v60, v61, v62
  v_max_f32 v2, v2, v63
  v_cmp_nge_f32 vcc, 0x42800000, v2
  s_cbranch_vccnz c_xb_83
c_xg_84:
  v_exp_f32 v60, v60
  v_exp_f32 v61, v61
  v_exp_f32 v62, v62
  v_exp_f32 v63, v63
  v_cvt_pk_bf16_f32 v22, v60, v60
  v_cvt_pk_bf16_f32 v23, v61, v61
  v_cvt_pk_bf16_f32 v26, v62, v62
  v_cvt_pk_bf16_f32 v27, v63, v63
  s_nop 1
  v_mfma_f32_16x16x32_bf16 v[64:67], v[168:171], v[26:29], 0
  v_mfma_f32_16x16x32_bf16 v[132:135], v[168:171], v[22:25], 0
  v_mfma_f32_16x16x32_bf16 v[64:67], v[172:175], v[28:31], v[64:67]
  v_mfma_f32_16x16x32_bf16 v[104:107], v[136:139], v[26:29], 0
  v_mfma_f32_16x16x32_bf16 v[100:103], v[136:139], v[22:25], 0
  s_nop 4
  v_rcp_f32 v18, v132
  v_rcp_f32 v19, v64
  s_nop 1
  ds_write_b64 v16, v[18:19]
  v_mfma_f32_16x16x32_bf16 v[104:107], v[140:143], v[28:31], v[104:107]
  v_mfma_f32_16x16x32_bf16 v[112:115], v[144:147], v[26:29], 0
  v_mfma_f32_16x16x32_bf16 v[108:111], v[144:147], v[22:25], 0
  v_cvt_pk_bf16_f32 v52, v100, v101
  v_cvt_pk_bf16_f32 v53, v102, v103
  s_nop 3
  v_cvt_pk_bf16_f32 v54, v104, v105
  v_mfma_f32_16x16x32_bf16 v[112:115], v[148:151], v[28:31], v[112:115]
  v_cvt_pk_bf16_f32 v55, v106, v107
  ds_write_b128 v15, v[52:55] offset:0
  v_mfma_f32_16x16x32_bf16 v[120:123], v[152:155], v[26:29], 0
  v_mfma_f32_16x16x32_bf16 v[116:119], v[152:155], v[22:25], 0
  v_cvt_pk_bf16_f32 v56, v108, v109
  v_cvt_pk_bf16_f32 v57, v110, v111
  s_nop 1
  v_cvt_pk_bf16_f32 v58, v112, v113
  v_mfma_f32_16x16x32_bf16 v[120:123], v[156:159], v[28:31], v[120:123]
  v_cvt_pk_bf16_f32 v59, v114, v115
  ds_write_b128 v15, v[56:59] offset:1024
  v_mfma_f32_16x16x32_bf16 v[128:131], v[160:163], v[26:29], 0
  v_mfma_f32_16x16x32_bf16 v[124:127], v[160:163], v[22:25], 0
  v_cvt_pk_bf16_f32 v52, v116, v117
  v_cvt_pk_bf16_f32 v53, v118, v119
  s_nop 1
  v_cvt_pk_bf16_f32 v54, v120, v121
  v_mfma_f32_16x16x32_bf16 v[128:131], v[164:167], v[28:31], v[128:131]
  v_cvt_pk_bf16_f32 v55, v122, v123
  ds_write_b128 v15, v[52:55] offset:2048
  v_cvt_pk_bf16_f32 v56, v124, v125
  v_cvt_pk_bf16_f32 v57, v126, v127
  s_nop 3
  v_cvt_pk_bf16_f32 v58, v128, v129
  v_cvt_pk_bf16_f32 v59, v130, v131
  ds_write_b128 v15, v[56:59] offset:3072
  s_waitcnt lgkmcnt(0)
  s_barrier
  s_branch fused_kernel_done
c_xb_83:
  v_cmp_u_f32 vcc, v2, v2
  s_cbranch_vccz c_big_85
  buffer_load_dwordx4 v[52:55], v4, s[24:27], s57 offen offset:0 sc1
  buffer_load_dwordx4 v[56:59], v4, s[24:27], s57 offen offset:1024 sc1
  s_sub_u32 s43, s43, 1
  s_cbranch_scc1 fused_kernel_fin
  s_waitcnt vmcnt(0)
  s_branch c_xr_82
c_big_85:
  v_max3_f32 v2, v60, v61, 0
  v_mov_b32 v3, v2
  s_nop 1
  v_permlane16_swap_b32 v2, v3
  v_max_f32 v2, v2, v3
  v_mov_b32 v3, v2
  s_nop 1
  v_permlane32_swap_b32 v2, v3
  v_max_f32 v2, v2, v3
  v_sub_f32 v60, v60, v2
  v_sub_f32 v61, v61, v2
  v_exp_f32 v2, -v2
  v_lshlrev_b32 v3, 16, v24
  v_and_b32 v24, 0xffff0000, v24
  v_mul_f32 v3, v3, v2
  v_mul_f32 v24, v24, v2
  v_cvt_pk_bf16_f32 v24, v3, v24
  v_lshlrev_b32 v3, 16, v25
  v_and_b32 v25, 0xffff0000, v25
  v_mul_f32 v3, v3, v2
  v_mul_f32 v25, v25, v2
  v_cvt_pk_bf16_f32 v25, v3, v25
  v_max3_f32 v2, v62, v63, 0
  v_mov_b32 v3, v2
  s_nop 1
  v_permlane16_swap_b32 v2, v3
  v_max_f32 v2, v2, v3
  v_mov_b32 v3, v2
  s_nop 1
  v_permlane32_swap_b32 v2, v3
  v_max_f32 v2, v2, v3
  v_sub_f32 v62, v62, v2
  v_sub_f32 v63, v63, v2
  v_exp_f32 v2, -v2
  v_lshlrev_b32 v3, 16, v28
  v_and_b32 v28, 0xffff0000, v28
  v_mul_f32 v3, v3, v2
  v_mul_f32 v28, v28, v2
  v_cvt_pk_bf16_f32 v28, v3, v28
  v_lshlrev_b32 v3, 16, v29
  v_and_b32 v29, 0xffff0000, v29
  v_mul_f32 v3, v3, v2
  v_mul_f32 v29, v29, v2
  v_cvt_pk_bf16_f32 v29, v3, v29
  v_lshlrev_b32 v3, 16, v30
  v_and_b32 v30, 0xffff0000, v30
  v_mul_f32 v3, v3, v2
  v_mul_f32 v30, v30, v2
  v_cvt_pk_bf16_f32 v30, v3, v30
  v_lshlrev_b32 v3, 16, v31
  v_and_b32 v31, 0xffff0000, v31
  v_mul_f32 v3, v3, v2
  v_mul_f32 v31, v31, v2
  v_cvt_pk_bf16_f32 v31, v3, v31
  s_branch c_xg_84
fused_kernel_fin:
fused_kernel_end:
  s_endpgm
fused_kernel_done:
  s_endpgm
  v_mbcnt_lo_u32_b32 v0, -1, 0
  v_mbcnt_hi_u32_b32 v0, -1, v0
  s_lshl_b32 s44, s20, 6
  v_add_u32 v0, s44, v0
  s_mov_b32 s7, -1
fused_kernel_worker:
  s_lshl_b32 s28, s6, 2
  s_add_u32 s28, s28, 128
  s_lshl_b32 s16, s20, 10
  s_mov_b32 s13, 512
  s_mov_b32 s30, 0
  s_mov_b32 s38, 1
  v_mov_b32 v252, 0
  s_cmp_eq_u32 s20, 0
  s_cselect_b32 s41, 0, 0
  s_cmp_lg_u32 s7, -1
  s_cbranch_scc1 w_first_890
  s_cmp_lg_u32 s20, 0
  s_cbranch_scc1 w_pop_91
  s_mov_b64 exec, 1
  v_mov_b32 v255, 1
  buffer_atomic_add v255, off, s[8:11], s28 sc0 sc1
  s_mov_b64 exec, -1
w_pop_91:
w_next_87:
  s_waitcnt vmcnt(0)
  v_mov_b32 v1, s16
  s_cmp_lg_u32 s20, 0
  s_cbranch_scc1 w_sig_88
  s_cmp_eq_u32 s38, 0
  s_cbranch_scc1 w_nc_90
  s_mov_b32 s38, 0
  v_mbcnt_lo_u32_b32 v6, -1, 0
  v_lshl_add_u32 v6, v6, 3, 32
  s_mov_b32 s31, 400000
  s_mov_b64 exec, 15
gp_92:
  buffer_load_dwordx2 v[4:5], v6, s[8:11], 0 offen sc1
  s_sub_u32 s31, s31, 1
  s_cbranch_scc1 fused_kernel_end
  s_waitcnt vmcnt(0)
  v_and_b32 v7, 32, v4
  v_cmp_eq_u32 vcc, 0, v7
  s_cbranch_vccz gp_92x
  s_sleep 4
  s_branch gp_92
gp_92x:
  s_mov_b64 exec, -1
w_nc_90:
  v_readfirstlane_b32 s33, v255
  s_cmp_eq_u32 s28, 144
  s_cselect_b32 s32, 0, 32
  s_add_u32 s32, s32, s33
  v_mov_b32 v2, s32
  v_and_b32 v3, 7, v0
  v_lshl_add_u32 v3, v3, 10, v1
  ds_write_b32 v3, v2
  s_waitcnt lgkmcnt(0)
w_sig_88:
  s_barrier
  ds_read_b32 v2, v1
  s_xor_b32 s16, s16, 4
  s_cmp_lg_u32 s20, 0
  s_cbranch_scc1 w_np_94
  s_cmp_eq_u32 s30, 0
  s_cbranch_scc1 w_ns_93
  v_lshlrev_b32 v4, 7, v0
  v_mov_b32 v3, s39
  s_mov_b32 exec_lo, s30
  s_mov_b32 exec_hi, 0
  buffer_atomic_add v3, v4, s[24:27], s29 offen sc1
  s_mov_b64 exec, -1
w_ns_93:
w_np_94:
  s_waitcnt lgkmcnt(0)
  v_readfirstlane_b32 s7, v2
  s_mov_b32 s30, 0
  s_sub_u32 s13, s13, 1
  s_cbranch_scc1 fused_kernel_end
  s_mov_b32 s32, 236
  s_cmp_eq_u32 s28, 144
  s_cselect_b32 s32, 144, s32
  s_cmp_ge_u32 s7, s32
  s_cbranch_scc1 w_sw_96
w_first_89:
  s_cmp_eq_u32 s28, 144
  s_cbranch_scc1 w_red_95
  s_mov_b32 s32, 0
  s_cmp_ge_u32 s7, 24
  s_cselect_b32 s32, 131060, s32
  s_cmp_ge_u32 s7, 32
  s_cselect_b32 s32, 16, s32
  s_cmp_ge_u32 s7, 40
  s_cselect_b32 s32, 131056, s32
  s_cmp_ge_u32 s7, 52
  s_cselect_b32 s32, 262092, s32
  s_cmp_ge_u32 s7, 56
  s_cselect_b32 s32, 131052, s32
  s_cmp_ge_u32 s7, 64
  s_cselect_b32 s32, 196568, s32
  s_cmp_ge_u32 s7, 76
  s_cselect_b32 s32, 36, s32
  s_cmp_ge_u32 s7, 84
  s_cselect_b32 s32, 196560, s32
  s_cmp_ge_u32 s7, 96
  s_cselect_b32 s32, 327584, s32
  s_cmp_ge_u32 s7, 98
  s_cselect_b32 s32, 393118, s32
  s_cmp_ge_u32 s7, 100
  s_cselect_b32 s32, 458652, s32
  s_cmp_ge_u32 s7, 108
  s_cselect_b32 s32, 196548, s32
  s_cmp_ge_u32 s7, 156
  s_cselect_b32 s32, 524132, s32
  s_cmp_ge_u32 s7, 172
  s_cselect_b32 s32, 655220, s32
  s_cmp_ge_u32 s7, 204
  s_cselect_b32 s32, 589620, s32
  s_sext_i32_i16 s33, s32
  s_add_u32 s7, s7, s33
  s_lshr_b32 s32, s32, 16
  s_mov_b32 s39, 1
  s_cmp_eq_u32 s32, 0
  s_cbranch_scc1 w_t_105
  s_cmp_eq_u32 s32, 2
  s_cbranch_scc1 w_big_98
  s_cmp_eq_u32 s32, 3
  s_cbranch_scc1 w_p0_106
  s_cmp_eq_u32 s32, 4
  s_cbranch_scc1 w_kva_100
  s_cmp_eq_u32 s32, 5
  s_cbranch_scc1 w_gate_101
  s_cmp_eq_u32 s32, 6
  s_cbranch_scc1 w_qa_102
  s_cmp_eq_u32 s32, 7
  s_cbranch_scc1 w_att_103
  s_cmp_eq_u32 s32, 8
  s_cbranch_scc1 w_fin_104
  s_cmp_eq_u32 s32, 9
  s_cbranch_scc1 w_att_103h
  s_mul_i32 s85, s7, 43691
  s_lshr_b32 s85, s85, 19
  s_mul_i32 s33, s85, 12
  s_sub_u32 s86, s7, s33
  s_load_dwordx2 s[44:45], s[0:1], 0
  s_mov_b32 s30, 1
  s_mov_b32 s39, 2
  s_lshl_b32 s34, s6, 3
  s_cmp_ge_u32 s86, 8
  s_cbranch_scc1 w_v_108
  s_load_dwordx2 s[48:49], s[0:1], 56
  s_load_dwordx2 s[52:53], s[0:1], 64
  s_add_u32 s34, s34, s86
  s_lshl_b32 s32, s34, 8
  s_mov_b32 s33, s32
  s_bitcmp1_b32 s20, 1
  s_mov_b32 s56, 0
  s_cselect_b32 s56, 16769024, s56
  s_cselect_b32 s65, 0x3e0293ee, 1.0
  s_branch w_j_109
w_v_108:
  s_load_dwordx2 s[48:49], s[0:1], 72
  s_load_dwordx2 s[52:53], s[0:1], 72
  s_lshl_b32 s32, s86, 1
  s_add_u32 s34, s34, s32
  s_sub_u32 s34, s34, 16
  s_lshl_b32 s32, s34, 8
  s_add_u32 s33, s32, 256
  s_mov_b32 s56, 33554432
  s_mov_b32 s65, 1.0
w_j_109:
  s_lshl_b32 s87, s85, 7
  s_lshl_b32 s35, s20, 5
  s_add_u32 s87, s87, s35
  s_lshl_b32 s35, s34, 0
  s_add_u32 s87, s87, s35
  s_lshl_b32 s35, s85, 7
  s_lshr_b32 s29, s34, 2
  s_lshl_b32 s29, s29, 11
  s_add_u32 s29, s29, s35
  s_add_u32 s29, s29, 124813312
  s_lshl_b32 s34, s34, 13
  s_lshl_b32 s35, s85, 20
  s_add_u32 s34, s34, s35
  s_add_u32 s56, s56, s34
  s_mov_b32 s67, 1
  s_mov_b32 s58, 8192
  s_mov_b32 s35, 8388608
  s_mov_b32 s59, 2048
  v_and_b32 v12, 63, v0
  s_lshl_b32 s63, s20, 10
  s_lshl_b32 s62, s58, 5
  v_lshrrev_b32 v13, 4, v0
  v_and_b32 v14, 3, v13
  v_lshlrev_b32 v14, 1, v14
  v_and_b32 v15, 8, v13
  v_or_b32 v14, v14, v15
  v_and_b32 v15, 15, v12
  v_xor_b32 v14, v14, v15
  v_lshlrev_b32 v14, 4, v14
  v_mul_lo_u32 v13, v13, s58
  v_add_u32 v7, v13, v14
  v_lshrrev_b32 v13, 3, v0
  v_lshrrev_b32 v14, 4, v0
  v_xor_b32 v14, v14, v12
  v_and_b32 v14, 7, v14
  v_lshlrev_b32 v14, 4, v14
  v_lshl_add_u32 v8, v13, 11, v14
  v_add_u32 v9, 131072, v8
  s_lshl_b32 s34, s85, 18
  s_waitcnt lgkmcnt(0)
  s_add_u32 s44, s44, s34
  s_addc_u32 s45, s45, 0
  s_and_b32 s45, s45, 0xffff
  s_mov_b32 s46, 262144
  s_mov_b32 s47, 0x20000
  s_sub_u32 s34, s35, s32
  s_add_u32 s48, s48, s32
  s_addc_u32 s49, s49, 0
  s_and_b32 s49, s49, 0xffff
  s_mov_b32 s50, s34
  s_mov_b32 s51, 0x20000
  s_sub_u32 s34, s35, s33
  s_add_u32 s52, s52, s33
  s_addc_u32 s53, s53, 0
  s_and_b32 s53, s53, 0xffff
  s_mov_b32 s54, s34
  s_mov_b32 s55, 0x20000
  s_bfe_u32 s32, s85, 131072
  s_mul_i32 s76, s58, 13248
  s_mul_i32 s82, s58, 272
  s_mov_b32 s60, 0
  s_mov_b32 s61, 0
  s_mov_b32 s83, 0
  s_mov_b32 s77, 0
  s_bitcmp1_b32 s16, 2
  s_cselect_b32 s57, 1920, 0
  s_mul_i32 s84, s57, s58
  s_lshr_b32 s84, s84, 1
  s_mov_b32 s83, s57
  s_mov_b32 s77, s84
  s_add_u32 m0, s63, 98304
  s_nop 0
  buffer_load_dwordx4 v8, s[44:47], s83 offen lds
  s_add_u32 m0, s63, 106496
  s_nop 0
  buffer_load_dwordx4 v9, s[44:47], s83 offen lds
  s_add_u32 s60, s60, 544
  s_and_b32 s83, s60, 0x780
  s_xor_b32 s83, s83, s57
  s_bitcmp1_b32 s60, 13
  s_cselect_b32 s83, 1073741824, s83
  s_add_u32 m0, s63, 0
  s_nop 0
  buffer_load_dwordx4 v7, s[48:51], s77 offen lds
  s_add_u32 m0, s63, 8192
  s_nop 0
  buffer_load_dwordx4 v7, s[52:55], s77 offen lds
  s_add_u32 s77, s77, s62
  s_add_u32 m0, s63, 16384
  s_nop 0
  buffer_load_dwordx4 v7, s[48:51], s77 offen lds
  s_add_u32 m0, s63, 24576
  s_nop 0
  buffer_load_dwordx4 v7, s[52:55], s77 offen lds
  s_add_u32 s61, s61, s82
  s_and_b32 s77, s61, s76
  s_xor_b32 s77, s77, s84
  s_add_u32 m0, s63, 114688
  s_nop 0
  buffer_load_dwordx4 v8, s[44:47], s83 offen lds
  s_add_u32 m0, s63, 122880
  s_nop 0
  buffer_load_dwordx4 v9, s[44:47], s83 offen lds
  s_add_u32 s60, s60, 544
  s_and_b32 s83, s60, 0x780
  s_xor_b32 s83, s83, s57
  s_bitcmp1_b32 s60, 13
  s_cselect_b32 s83, 1073741824, s83
  s_add_u32 m0, s63, 32768
  s_nop 0
  buffer_load_dwordx4 v7, s[48:51], s77 offen lds
  s_add_u32 m0, s63, 40960
  s_nop 0
  buffer_load_dwordx4 v7, s[52:55], s77 offen lds
  s_add_u32 s77, s77, s62
  s_add_u32 m0, s63, 49152
  s_nop 0
  buffer_load_dwordx4 v7, s[48:51], s77 offen lds
  s_add_u32 m0, s63, 57344
  s_nop 0
  buffer_load_dwordx4 v7, s[52:55], s77 offen lds
  s_add_u32 s61, s61, s82
  s_and_b32 s77, s61, s76
  s_xor_b32 s77, s77, s84
  s_add_u32 m0, s63, 131072
  s_nop 0
  buffer_load_dwordx4 v8, s[44:47], s83 offen lds
  s_add_u32 m0, s63, 139264
  s_nop 0
  buffer_load_dwordx4 v9, s[44:47], s83 offen lds
  s_add_u32 s60, s60, 544
  s_and_b32 s83, s60, 0x780
  s_xor_b32 s83, s83, s57
  s_bitcmp1_b32 s60, 13
  s_cselect_b32 s83, 1073741824, s83
  s_add_u32 m0, s63, 65536
  s_nop 0
  buffer_load_dwordx4 v7, s[48:51], s77 offen lds
  s_add_u32 m0, s63, 73728
  s_nop 0
  buffer_load_dwordx4 v7, s[52:55], s77 offen lds
  s_add_u32 s77, s77, s62
  s_add_u32 m0, s63, 81920
  s_nop 0
  buffer_load_dwordx4 v7, s[48:51], s77 offen lds
  s_add_u32 m0, s63, 90112
  s_nop 0
  buffer_load_dwordx4 v7, s[52:55], s77 offen lds
  s_add_u32 s61, s61, s82
  s_and_b32 s77, s61, s76
  s_xor_b32 s77, s77, s84
  v_lshrrev_b32 v13, 2, v12
  v_and_b32 v15, 7, v13
  v_and_b32 v13, 3, v13
  v_lshrrev_b32 v14, 4, v12
  v_lshl_add_u32 v14, v14, 3, v13
  v_lshlrev_b32 v14, 8, v14
  s_and_b32 s66, s20, 1
  s_mul_i32 s66, s66, 4
  v_xor_b32 v15, s66, v15
  v_lshl_add_u32 v14, v15, 5, v14
  s_and_b32 s66, s20, 2
  s_lshl_b32 s66, s66, 12
  v_add_u32 v14, s66, v14
  v_and_b32 v13, 3, v12
  v_lshl_add_u32 v1, v13, 3, v14
  v_xor_b32 v2, 32, v1
  v_xor_b32 v3, 64, v1
  v_xor_b32 v4, 96, v1
  s_lshr_b32 s66, s20, 2
  s_mul_i32 s66, s66, 64
  v_and_b32 v13, 15, v12
  v_add_u32 v15, s66, v13
  v_lshrrev_b32 v13, 1, v13
  v_lshrrev_b32 v14, 4, v12
  v_xor_b32 v13, v13, v14
  v_lshlrev_b32 v13, 4, v13
  v_lshl_add_u32 v13, v15, 7, v13
  v_add_u32 v5, 98304, v13
  v_xor_b32 v6, 64, v5
  s_and_b32 s66, s20, 3
  s_lshr_b32 s71, s20, 2
  v_and_b32 v13, 15, v12
  s_cmp_lg_u32 s67, 0
  s_cbranch_scc1 go_f_111
  s_mul_i32 s71, s71, 64
  v_add_u32 v15, s71, v13
  v_mul_lo_u32 v15, v15, s59
  v_and_b32 v13, 16, v12
  v_lshl_add_u32 v15, v13, 1, v15
  v_lshrrev_b32 v13, 5, v12
  v_lshl_add_u32 v15, v13, 4, v15
  s_mul_i32 s66, s66, 128
  v_add_u32 v10, s66, v15
  s_lshl_b32 s68, s59, 4
  s_lshl_b32 s69, s59, 5
  s_mov_b32 s70, 64
  s_branch go_d_113
go_f_111:
  v_lshlrev_b32 v15, 4, v13
  s_mov_b32 s68, 1024
  s_cmp_eq_u32 s67, 1
  s_cbranch_scc1 go_k_112
  v_and_b32 v15, 3, v12
  v_lshlrev_b32 v15, 4, v15
  v_and_b32 v13, 8, v12
  v_lshl_add_u32 v15, v13, 3, v15
  v_and_b32 v13, 4, v12
  v_lshl_add_u32 v15, v13, 8, v15
  s_mov_b32 s68, 128
go_k_112:
  v_and_b32 v13, 16, v12
  v_lshl_add_u32 v15, v13, 5, v15
  v_and_b32 v13, 32, v12
  v_lshl_add_u32 v15, v13, 3, v15
  s_mul_i32 s66, s66, 4096
  s_mul_i32 s71, s71, 524288
  s_add_u32 s66, s66, s71
  v_add_u32 v10, s66, v15
  s_mov_b32 s69, 262144
  s_mov_b32 s70, 2048
go_d_113:
  v_and_b32 v13, 15, v12
  v_lshlrev_b32 v15, 4, v13
  v_and_b32 v13, 16, v12
  v_lshl_add_u32 v15, v13, 5, v15
  v_and_b32 v13, 32, v12
  v_lshl_add_u32 v15, v13, 3, v15
  s_lshr_b32 s66, s20, 2
  s_mul_i32 s66, s66, 32768
  s_and_b32 s71, s20, 3
  s_lshl_b32 s71, s71, 12
  s_add_u32 s66, s66, s71
  s_add_u32 s66, s66, 32768
  v_add_u32 v11, s66, v15
  v_mov_b32 v80, 0
  v_mov_b32 v81, 0
  v_mov_b32 v82, 0
  v_mov_b32 v83, 0
  v_mov_b32 v84, 0
  v_mov_b32 v85, 0
  v_mov_b32 v86, 0
  v_mov_b32 v87, 0
  v_mov_b32 v88, 0
  v_mov_b32 v89, 0
  v_mov_b32 v90, 0
  v_mov_b32 v91, 0
  v_mov_b32 v92, 0
  v_mov_b32 v93, 0
  v_mov_b32 v94, 0
  v_mov_b32 v95, 0
  v_mov_b32 v96, 0
  v_mov_b32 v97, 0
  v_mov_b32 v98, 0
  v_mov_b32 v99, 0
  v_mov_b32 v100, 0
  v_mov_b32 v101, 0
  v_mov_b32 v102, 0
  v_mov_b32 v103, 0
  v_mov_b32 v104, 0
  v_mov_b32 v105, 0
  v_mov_b32 v106, 0
  v_mov_b32 v107, 0
  v_mov_b32 v108, 0
  v_mov_b32 v109, 0
  v_mov_b32 v110, 0
  v_mov_b32 v111, 0
  v_mov_b32 v112, 0
  v_mov_b32 v113, 0
  v_mov_b32 v114, 0
  v_mov_b32 v115, 0
  v_mov_b32 v116, 0
  v_mov_b32 v117, 0
  v_mov_b32 v118, 0
  v_mov_b32 v119, 0
  v_mov_b32 v120, 0
  v_mov_b32 v121, 0
  v_mov_b32 v122, 0
  v_mov_b32 v123, 0
  v_mov_b32 v124, 0
  v_mov_b32 v125, 0
  v_mov_b32 v126, 0
  v_mov_b32 v127, 0
  v_mov_b32 v128, 0
  v_mov_b32 v129, 0
  v_mov_b32 v130, 0
  v_mov_b32 v131, 0
  v_mov_b32 v132, 0
  v_mov_b32 v133, 0
  v_mov_b32 v134, 0
  v_mov_b32 v135, 0
  v_mov_b32 v136, 0
  v_mov_b32 v137, 0
  v_mov_b32 v138, 0
  v_mov_b32 v139, 0
  v_mov_b32 v140, 0
  v_mov_b32 v141, 0
  v_mov_b32 v142, 0
  v_mov_b32 v143, 0
  s_mov_b32 s72, s63
  s_mov_b32 s73, 16384
  s_mov_b32 s75, 16384
  s_add_u32 s74, s63, 81920
  s_add_u32 s80, s63, 147456
  s_mov_b32 s78, s80
  s_mov_b32 s79, -49152
  s_mov_b32 s81, 16384
  s_mov_b32 s64, 16
  s_waitcnt vmcnt(12)
  s_barrier
  ds_read_b64_tr_b16 v[16:17], v1
  ds_read_b64_tr_b16 v[18:19], v1 offset:1024
  ds_read_b128 v[48:51], v5 offset:0
  ds_read_b128 v[52:55], v5 offset:2048
  ds_read_b128 v[56:59], v5 offset:4096
  ds_read_b128 v[60:63], v5 offset:6144
  ds_read_b64_tr_b16 v[20:21], v2
  ds_read_b64_tr_b16 v[22:23], v2 offset:1024
  ds_read_b64_tr_b16 v[24:25], v3
  ds_read_b64_tr_b16 v[26:27], v3 offset:1024
  ds_read_b64_tr_b16 v[28:29], v4
  ds_read_b64_tr_b16 v[30:31], v4 offset:1024
  v_add_u32 v1, s73, v1
  v_add_u32 v2, s73, v2
  v_add_u32 v3, s73, v3
  v_add_u32 v4, s73, v4
gk_116:
  s_waitcnt lgkmcnt(0)
  s_add_u32 m0, s78, 0
  v_mfma_f32_16x16x32_bf16 v[80:83], v[16:19], v[48:51], v[80:83]
  buffer_load_dwordx4 v8, s[44:47], s83 offen lds
  ds_read_b64_tr_b16 v[32:33], v1
  v_mfma_f32_16x16x32_bf16 v[96:99], v[16:19], v[52:55], v[96:99]
  ds_read_b64_tr_b16 v[34:35], v1 offset:1024
  v_mfma_f32_16x16x32_bf16 v[112:115], v[16:19], v[56:59], v[112:115]
  ds_read_b128 v[64:67], v6 offset:0
  v_mfma_f32_16x16x32_bf16 v[128:131], v[16:19], v[60:63], v[128:131]
  ds_read_b128 v[68:71], v6 offset:2048
  s_add_u32 m0, s78, 8192
  v_mfma_f32_16x16x32_bf16 v[84:87], v[20:23], v[48:51], v[84:87]
  buffer_load_dwordx4 v9, s[44:47], s83 offen lds
  s_add_u32 s60, s60, 544
  s_and_b32 s83, s60, 0x780
  s_xor_b32 s83, s83, s57
  s_bitcmp1_b32 s60, 13
  s_cselect_b32 s83, 1073741824, s83
  ds_read_b128 v[72:75], v6 offset:4096
  v_mfma_f32_16x16x32_bf16 v[100:103], v[20:23], v[52:55], v[100:103]
  ds_read_b128 v[76:79], v6 offset:6144
  v_mfma_f32_16x16x32_bf16 v[116:119], v[20:23], v[56:59], v[116:119]
  ds_read_b64_tr_b16 v[36:37], v2
  v_mfma_f32_16x16x32_bf16 v[132:135], v[20:23], v[60:63], v[132:135]
  ds_read_b64_tr_b16 v[38:39], v2 offset:1024
  v_mfma_f32_16x16x32_bf16 v[88:91], v[24:27], v[48:51], v[88:91]
  ds_read_b64_tr_b16 v[40:41], v3
  v_mfma_f32_16x16x32_bf16 v[104:107], v[24:27], v[52:55], v[104:107]
  ds_read_b64_tr_b16 v[42:43], v3 offset:1024
  v_mfma_f32_16x16x32_bf16 v[120:123], v[24:27], v[56:59], v[120:123]
  ds_read_b64_tr_b16 v[44:45], v4
  v_mfma_f32_16x16x32_bf16 v[136:139], v[24:27], v[60:63], v[136:139]
  ds_read_b64_tr_b16 v[46:47], v4 offset:1024
  v_mfma_f32_16x16x32_bf16 v[92:95], v[28:31], v[48:51], v[92:95]
  s_add_u32 s72, s72, s73
  s_cmp_eq_u32 s72, s74
  s_cselect_b32 s73, -81920, s75
  v_mfma_f32_16x16x32_bf16 v[108:111], v[28:31], v[52:55], v[108:111]
  v_add_u32 v1, s73, v1
  v_add_u32 v2, s73, v2
  v_mfma_f32_16x16x32_bf16 v[124:127], v[28:31], v[56:59], v[124:127]
  v_add_u32 v3, s73, v3
  v_add_u32 v4, s73, v4
  v_mfma_f32_16x16x32_bf16 v[140:143], v[28:31], v[60:63], v[140:143]
  s_add_u32 s78, s78, s79
  s_cmp_eq_u32 s78, s80
  s_cselect_b32 s79, -49152, s81
  v_add_u32 v5, s79, v5
  s_waitcnt vmcnt(8) lgkmcnt(0)
  s_barrier
  s_add_u32 m0, s72, -16384
  v_mfma_f32_16x16x32_bf16 v[80:83], v[32:35], v[64:67], v[80:83]
  buffer_load_dwordx4 v7, s[48:51], s77 offen lds
  ds_read_b64_tr_b16 v[16:17], v1
  v_mfma_f32_16x16x32_bf16 v[96:99], v[32:35], v[68:71], v[96:99]
  ds_read_b64_tr_b16 v[18:19], v1 offset:1024
  v_mfma_f32_16x16x32_bf16 v[112:115], v[32:35], v[72:75], v[112:115]
  ds_read_b128 v[48:51], v5 offset:0
  v_mfma_f32_16x16x32_bf16 v[128:131], v[32:35], v[76:79], v[128:131]
  ds_read_b128 v[52:55], v5 offset:2048
  s_add_u32 m0, s72, -8192
  v_mfma_f32_16x16x32_bf16 v[84:87], v[36:39], v[64:67], v[84:87]
  buffer_load_dwordx4 v7, s[52:55], s77 offen lds
  s_add_u32 s77, s77, s62
  ds_read_b128 v[56:59], v5 offset:4096
  v_mfma_f32_16x16x32_bf16 v[100:103], v[36:39], v[68:71], v[100:103]
  ds_read_b128 v[60:63], v5 offset:6144
  v_mfma_f32_16x16x32_bf16 v[116:119], v[36:39], v[72:75], v[116:119]
  ds_read_b64_tr_b16 v[20:21], v2
  v_mfma_f32_16x16x32_bf16 v[132:135], v[36:39], v[76:79], v[132:135]
  ds_read_b64_tr_b16 v[22:23], v2 offset:1024
  s_add_u32 m0, s72, 0
  v_mfma_f32_16x16x32_bf16 v[88:91], v[40:43], v[64:67], v[88:91]
  buffer_load_dwordx4 v7, s[48:51], s77 offen lds
  ds_read_b64_tr_b16 v[24:25], v3
  v_mfma_f32_16x16x32_bf16 v[104:107], v[40:43], v[68:71], v[104:107]
  ds_read_b64_tr_b16 v[26:27], v3 offset:1024
  v_mfma_f32_16x16x32_bf16 v[120:123], v[40:43], v[72:75], v[120:123]
  ds_read_b64_tr_b16 v[28:29], v4
  v_mfma_f32_16x16x32_bf16 v[136:139], v[40:43], v[76:79], v[136:139]
  ds_read_b64_tr_b16 v[30:31], v4 offset:1024
  s_add_u32 m0, s72, 8192
  v_mfma_f32_16x16x32_bf16 v[92:95], v[44:47], v[64:67], v[92:95]
  buffer_load_dwordx4 v7, s[52:55], s77 offen lds
  s_add_u32 s61, s61, s82
  s_and_b32 s77, s61, s76
  s_xor_b32 s77, s77, s84
  s_add_u32 s72, s72, s73
  s_cmp_eq_u32 s72, s74
  s_cselect_b32 s73, -81920, s75
  v_mfma_f32_16x16x32_bf16 v[108:111], v[44:47], v[68:71], v[108:111]
  v_add_u32 v1, s73, v1
  v_add_u32 v2, s73, v2
  v_mfma_f32_16x16x32_bf16 v[124:127], v[44:47], v[72:75], v[124:127]
  v_add_u32 v3, s73, v3
  v_add_u32 v4, s73, v4
  v_mfma_f32_16x16x32_bf16 v[140:143], v[44:47], v[76:79], v[140:143]
  v_xor_b32 v6, 64, v5
  s_sub_u32 s64, s64, 1
  s_cmp_lg_u32 s64, 0
  s_cbranch_scc1 gk_116
ge_114:
  s_waitcnt vmcnt(0) lgkmcnt(0)
  s_barrier
  s_cmp_lg_u32 s20, 0
  s_cbranch_scc1 w_pop_117
  s_mov_b64 exec, 1
  v_mov_b32 v255, 1
  buffer_atomic_add v255, off, s[8:11], s28 sc0 sc1
  s_mov_b64 exec, -1
w_pop_117:
  s_cmp_lg_u32 s85, 1
  s_cbranch_scc1 w_mp_118
  s_cmp_ge_u32 s20, 5
  s_cbranch_scc1 w_mp_118
  s_cmp_ge_u32 s86, 8
  s_cbranch_scc1 w_mp_118
  s_load_dwordx2 s[44:45], s[0:1], 0
  v_and_b32 v253, 63, v0
  v_lshlrev_b32 v253, 7, v253
  s_lshl_b32 s32, s6, 13
  s_lshl_b32 s33, s86, 15
  s_add_u32 s32, s32, s33
  s_lshl_b32 s33, s20, 18
  s_add_u32 s32, s32, s33
  s_add_u32 s32, s32, 786432
  s_waitcnt lgkmcnt(0)
  s_and_b32 s45, s45, 0xffff
  s_mov_b32 s46, 4194304
  s_mov_b32 s47, 0x20000
  buffer_load_dword v253, v253, s[44:47], s32 offen
w_mp_118:
  s_cmp_lt_u32 s86, 8
  s_cselect_b64 vcc, -1, 0
  s_mov_b32 s66, s56
  v_mul_f32 v80, s65, v80
  v_mul_f32 v81, s65, v81
  v_mul_f32 v82, s65, v82
  v_mul_f32 v83, s65, v83
  v_mul_f32 v84, s65, v84
  v_mul_f32 v85, s65, v85
  v_mul_f32 v86, s65, v86
  v_mul_f32 v87, s65, v87
  v_cvt_pk_bf16_f32 v80, v80, v81
  v_cvt_pk_bf16_f32 v81, v82, v83
  v_cvt_pk_bf16_f32 v82, v84, v85
  v_cvt_pk_bf16_f32 v83, v86, v87
  v_mul_f32 v88, s65, v88
  v_mul_f32 v89, s65, v89
  v_mul_f32 v90, s65, v90
  v_mul_f32 v91, s65, v91
  v_mul_f32 v92, s65, v92
  v_mul_f32 v93, s65, v93
  v_mul_f32 v94, s65, v94
  v_mul_f32 v95, s65, v95
  v_cvt_pk_bf16_f32 v88, v88, v89
  v_cvt_pk_bf16_f32 v89, v90, v91
  v_cvt_pk_bf16_f32 v90, v92, v93
  v_cvt_pk_bf16_f32 v91, v94, v95
  v_permlane16_swap_b32 v80, v82
  v_permlane16_swap_b32 v81, v83
  v_permlane16_swap_b32 v88, v90
  v_permlane16_swap_b32 v89, v91
  s_mov_b32 s71, s66
  s_cbranch_vccz ex_119
  ds_write_b128 v11, v[80:83] offset:0
  ds_write_b128 v11, v[88:91] offset:2048
ex_119:
  buffer_store_dwordx4 v[80:83], v10, s[24:27], s71 offen sc1
  s_add_u32 s71, s71, s70
  buffer_store_dwordx4 v[88:91], v10, s[24:27], s71 offen sc1
  v_mul_f32 v96, s65, v96
  v_mul_f32 v97, s65, v97
  v_mul_f32 v98, s65, v98
  v_mul_f32 v99, s65, v99
  v_mul_f32 v100, s65, v100
  v_mul_f32 v101, s65, v101
  v_mul_f32 v102, s65, v102
  v_mul_f32 v103, s65, v103
  v_cvt_pk_bf16_f32 v96, v96, v97
  v_cvt_pk_bf16_f32 v97, v98, v99
  v_cvt_pk_bf16_f32 v98, v100, v101
  v_cvt_pk_bf16_f32 v99, v102, v103
  v_mul_f32 v104, s65, v104
  v_mul_f32 v105, s65, v105
  v_mul_f32 v106, s65, v106
  v_mul_f32 v107, s65, v107
  v_mul_f32 v108, s65, v108
  v_mul_f32 v109, s65, v109
  v_mul_f32 v110, s65, v110
  v_mul_f32 v111, s65, v111
  v_cvt_pk_bf16_f32 v104, v104, v105
  v_cvt_pk_bf16_f32 v105, v106, v107
  v_cvt_pk_bf16_f32 v106, v108, v109
  v_cvt_pk_bf16_f32 v107, v110, v111
  v_permlane16_swap_b32 v96, v98
  v_permlane16_swap_b32 v97, v99
  v_permlane16_swap_b32 v104, v106
  v_permlane16_swap_b32 v105, v107
  s_add_u32 s71, s66, s68
  s_cbranch_vccz ex_120
  ds_write_b128 v11, v[96:99] offset:1024
  ds_write_b128 v11, v[104:107] offset:3072
ex_120:
  buffer_store_dwordx4 v[96:99], v10, s[24:27], s71 offen sc1
  s_add_u32 s71, s71, s70
  buffer_store_dwordx4 v[104:107], v10, s[24:27], s71 offen sc1
  s_add_u32 s66, s66, s69
  v_mul_f32 v112, s65, v112
  v_mul_f32 v113, s65, v113
  v_mul_f32 v114, s65, v114
  v_mul_f32 v115, s65, v115
  v_mul_f32 v116, s65, v116
  v_mul_f32 v117, s65, v117
  v_mul_f32 v118, s65, v118
  v_mul_f32 v119, s65, v119
  v_cvt_pk_bf16_f32 v112, v112, v113
  v_cvt_pk_bf16_f32 v113, v114, v115
  v_cvt_pk_bf16_f32 v114, v116, v117
  v_cvt_pk_bf16_f32 v115, v118, v119
  v_mul_f32 v120, s65, v120
  v_mul_f32 v121, s65, v121
  v_mul_f32 v122, s65, v122
  v_mul_f32 v123, s65, v123
  v_mul_f32 v124, s65, v124
  v_mul_f32 v125, s65, v125
  v_mul_f32 v126, s65, v126
  v_mul_f32 v127, s65, v127
  v_cvt_pk_bf16_f32 v120, v120, v121
  v_cvt_pk_bf16_f32 v121, v122, v123
  v_cvt_pk_bf16_f32 v122, v124, v125
  v_cvt_pk_bf16_f32 v123, v126, v127
  v_permlane16_swap_b32 v112, v114
  v_permlane16_swap_b32 v113, v115
  v_permlane16_swap_b32 v120, v122
  v_permlane16_swap_b32 v121, v123
  s_mov_b32 s71, s66
  s_cbranch_vccz ex_121
  ds_write_b128 v11, v[112:115] offset:16384
  ds_write_b128 v11, v[120:123] offset:18432
ex_121:
  buffer_store_dwordx4 v[112:115], v10, s[24:27], s71 offen sc1
  s_add_u32 s71, s71, s70
  buffer_store_dwordx4 v[120:123], v10, s[24:27], s71 offen sc1
  v_mul_f32 v128, s65, v128
  v_mul_f32 v129, s65, v129
  v_mul_f32 v130, s65, v130
  v_mul_f32 v131, s65, v131
  v_mul_f32 v132, s65, v132
  v_mul_f32 v133, s65, v133
  v_mul_f32 v134, s65, v134
  v_mul_f32 v135, s65, v135
  v_cvt_pk_bf16_f32 v128, v128, v129
  v_cvt_pk_bf16_f32 v129, v130, v131
  v_cvt_pk_bf16_f32 v130, v132, v133
  v_cvt_pk_bf16_f32 v131, v134, v135
  v_mul_f32 v136, s65, v136
  v_mul_f32 v137, s65, v137
  v_mul_f32 v138, s65, v138
  v_mul_f32 v139, s65, v139
  v_mul_f32 v140, s65, v140
  v_mul_f32 v141, s65, v141
  v_mul_f32 v142, s65, v142
  v_mul_f32 v143, s65, v143
  v_cvt_pk_bf16_f32 v136, v136, v137
  v_cvt_pk_bf16_f32 v137, v138, v139
  v_cvt_pk_bf16_f32 v138, v140, v141
  v_cvt_pk_bf16_f32 v139, v142, v143
  v_permlane16_swap_b32 v128, v130
  v_permlane16_swap_b32 v129, v131
  v_permlane16_swap_b32 v136, v138
  v_permlane16_swap_b32 v137, v139
  s_add_u32 s71, s66, s68
  s_cbranch_vccz ex_122
  ds_write_b128 v11, v[128:131] offset:17408
  ds_write_b128 v11, v[136:139] offset:19456
ex_122:
  buffer_store_dwordx4 v[128:131], v10, s[24:27], s71 offen sc1
  s_add_u32 s71, s71, s70
  buffer_store_dwordx4 v[136:139], v10, s[24:27], s71 offen sc1
  s_add_u32 s66, s66, s69
  s_cmp_ge_u32 s86, 8
  s_cbranch_scc1 w_next_87
  s_waitcnt lgkmcnt(0)
  s_barrier
  s_cmp_ge_u32 s20, 4
  s_cbranch_scc1 w_next_87
  s_branch w_px_107
w_big_98:
  s_mov_b32 s32, s7
  s_mul_i32 s85, s32, 43691
  s_lshr_b32 s85, s85, 19
  s_mul_i32 s33, s85, 12
  s_sub_u32 s86, s32, s33
  s_lshl_b32 s85, s85, 1
w_big_982:
  s_load_dwordx2 s[44:45], s[0:1], 0
  s_mov_b32 s30, 3
  s_mov_b32 s39, 2
  s_lshl_b32 s34, s6, 3
  s_cmp_ge_u32 s86, 8
  s_cbranch_scc1 w_v_123
  s_load_dwordx2 s[48:49], s[0:1], 56
  s_load_dwordx2 s[52:53], s[0:1], 64
  s_add_u32 s34, s34, s86
  s_lshl_b32 s32, s34, 8
  s_mov_b32 s33, s32
  s_bitcmp1_b32 s20, 1
  s_mov_b32 s56, 0
  s_cselect_b32 s56, 16769024, s56
  s_cselect_b32 s65, 0x3e0293ee, 1.0
  s_branch w_j_124
w_v_123:
  s_load_dwordx2 s[48:49], s[0:1], 72
  s_load_dwordx2 s[52:53], s[0:1], 72
  s_lshl_b32 s32, s86, 1
  s_add_u32 s34, s34, s32
  s_sub_u32 s34, s34, 16
  s_lshl_b32 s32, s34, 8
  s_add_u32 s33, s32, 256
  s_mov_b32 s56, 33554432
  s_mov_b32 s65, 1.0
w_j_124:
  s_lshl_b32 s87, s85, 7
  s_lshl_b32 s35, s20, 5
  s_add_u32 s87, s87, s35
  s_lshl_b32 s35, s34, 0
  s_add_u32 s87, s87, s35
  s_lshl_b32 s35, s85, 7
  s_lshr_b32 s29, s34, 2
  s_lshl_b32 s29, s29, 11
  s_add_u32 s29, s29, s35
  s_add_u32 s29, s29, 124813312
  s_lshl_b32 s34, s34, 13
  s_lshl_b32 s35, s85, 20
  s_add_u32 s34, s34, s35
  s_add_u32 s56, s56, s34
  s_mov_b32 s67, 1
  s_mov_b32 s58, 8192
  s_mov_b32 s35, 8388608
w_big_983:
  s_mov_b32 s59, 2048
  v_and_b32 v14, 63, v0
  s_lshl_b32 s63, s20, 10
  s_lshl_b32 s62, s58, 5
  v_lshrrev_b32 v15, 4, v0
  v_and_b32 v16, 3, v15
  v_lshlrev_b32 v16, 1, v16
  v_and_b32 v17, 8, v15
  v_or_b32 v16, v16, v17
  v_and_b32 v17, 15, v14
  v_xor_b32 v16, v16, v17
  v_lshlrev_b32 v16, 4, v16
  v_mul_lo_u32 v15, v15, s58
  v_add_u32 v7, v15, v16
  v_lshrrev_b32 v15, 3, v0
  v_lshrrev_b32 v16, 4, v0
  v_xor_b32 v16, v16, v14
  v_and_b32 v16, 7, v16
  v_lshlrev_b32 v16, 4, v16
  v_lshl_add_u32 v8, v15, 11, v16
  v_add_u32 v9, 131072, v8
  v_add_u32 v10, 262144, v8
  v_add_u32 v11, 393216, v8
  s_lshl_b32 s34, s85, 18
  s_waitcnt lgkmcnt(0)
  s_add_u32 s44, s44, s34
  s_addc_u32 s45, s45, 0
  s_and_b32 s45, s45, 0xffff
  s_mov_b32 s46, 524288
  s_mov_b32 s47, 0x20000
  s_sub_u32 s34, s35, s32
  s_add_u32 s48, s48, s32
  s_addc_u32 s49, s49, 0
  s_and_b32 s49, s49, 0xffff
  s_mov_b32 s50, s34
  s_mov_b32 s51, 0x20000
  s_sub_u32 s34, s35, s33
  s_add_u32 s52, s52, s33
  s_addc_u32 s53, s53, 0
  s_and_b32 s53, s53, 0xffff
  s_mov_b32 s54, s34
  s_mov_b32 s55, 0x20000
  s_bfe_u32 s32, s85, 131073
  s_lshl_b32 s82, s32, 7
  s_mul_i32 s76, s82, s58
  s_lshr_b32 s76, s76, 1
  s_mov_b32 s60, 0
  s_mov_b32 s61, 0
  s_mov_b32 s83, s82
  s_mov_b32 s77, s76
  s_add_u32 m0, s63, 65536
  s_nop 0
  buffer_load_dwordx4 v8, s[44:47], s83 offen lds
  s_add_u32 m0, s63, 73728
  s_nop 0
  buffer_load_dwordx4 v9, s[44:47], s83 offen lds
  s_add_u32 m0, s63, 81920
  s_nop 0
  buffer_load_dwordx4 v10, s[44:47], s83 offen lds
  s_add_u32 m0, s63, 90112
  s_nop 0
  buffer_load_dwordx4 v11, s[44:47], s83 offen lds
  s_add_u32 s60, s60, 128
  s_bitcmp1_b32 s60, 11
  s_cselect_b32 s60, 1073743872, s60
  s_xor_b32 s83, s60, s82
  s_add_u32 m0, s63, 0
  s_nop 0
  buffer_load_dwordx4 v7, s[48:51], s77 offen lds
  s_add_u32 m0, s63, 8192
  s_nop 0
  buffer_load_dwordx4 v7, s[52:55], s77 offen lds
  s_add_u32 s61, s61, s62
  s_xor_b32 s77, s61, s76
  s_add_u32 m0, s63, 16384
  s_nop 0
  buffer_load_dwordx4 v7, s[48:51], s77 offen lds
  s_add_u32 m0, s63, 24576
  s_nop 0
  buffer_load_dwordx4 v7, s[52:55], s77 offen lds
  s_add_u32 s61, s61, s62
  s_xor_b32 s77, s61, s76
  s_add_u32 m0, s63, 98304
  s_nop 0
  buffer_load_dwordx4 v8, s[44:47], s83 offen lds
  s_add_u32 m0, s63, 106496
  s_nop 0
  buffer_load_dwordx4 v9, s[44:47], s83 offen lds
  s_add_u32 m0, s63, 114688
  s_nop 0
  buffer_load_dwordx4 v10, s[44:47], s83 offen lds
  s_add_u32 m0, s63, 122880
  s_nop 0
  buffer_load_dwordx4 v11, s[44:47], s83 offen lds
  s_add_u32 s60, s60, 128
  s_bitcmp1_b32 s60, 11
  s_cselect_b32 s60, 1073743872, s60
  s_xor_b32 s83, s60, s82
  s_add_u32 m0, s63, 32768
  s_nop 0
  buffer_load_dwordx4 v7, s[48:51], s77 offen lds
  s_add_u32 m0, s63, 40960
  s_nop 0
  buffer_load_dwordx4 v7, s[52:55], s77 offen lds
  s_add_u32 s61, s61, s62
  s_xor_b32 s77, s61, s76
  s_add_u32 m0, s63, 49152
  s_nop 0
  buffer_load_dwordx4 v7, s[48:51], s77 offen lds
  s_add_u32 m0, s63, 57344
  s_nop 0
  buffer_load_dwordx4 v7, s[52:55], s77 offen lds
  s_add_u32 s61, s61, s62
  s_xor_b32 s77, s61, s76
  v_lshrrev_b32 v15, 2, v14
  v_and_b32 v17, 7, v15
  v_and_b32 v15, 3, v15
  v_lshrrev_b32 v16, 4, v14
  v_lshl_add_u32 v16, v16, 3, v15
  v_lshlrev_b32 v16, 8, v16
  s_and_b32 s66, s20, 1
  s_mul_i32 s66, s66, 4
  v_xor_b32 v17, s66, v17
  v_lshl_add_u32 v16, v17, 5, v16
  s_and_b32 s66, s20, 2
  s_lshl_b32 s66, s66, 12
  v_add_u32 v16, s66, v16
  v_and_b32 v15, 3, v14
  v_lshl_add_u32 v1, v15, 3, v16
  v_xor_b32 v2, 32, v1
  v_xor_b32 v3, 64, v1
  v_xor_b32 v4, 96, v1
  s_lshr_b32 s66, s20, 2
  s_mul_i32 s66, s66, 128
  v_and_b32 v15, 15, v14
  v_add_u32 v17, s66, v15
  v_lshrrev_b32 v15, 1, v15
  v_lshrrev_b32 v16, 4, v14
  v_xor_b32 v15, v15, v16
  v_lshlrev_b32 v15, 4, v15
  v_lshl_add_u32 v15, v17, 7, v15
  v_add_u32 v5, 65536, v15
  v_xor_b32 v6, 64, v5
  s_and_b32 s66, s20, 3
  s_lshr_b32 s71, s20, 2
  v_and_b32 v15, 15, v14
  s_cmp_lg_u32 s67, 0
  s_cbranch_scc1 go_f_126
  s_mul_i32 s71, s71, 128
  v_add_u32 v17, s71, v15
  v_mul_lo_u32 v17, v17, s59
  v_and_b32 v15, 16, v14
  v_lshl_add_u32 v17, v15, 1, v17
  v_lshrrev_b32 v15, 5, v14
  v_lshl_add_u32 v17, v15, 4, v17
  s_mul_i32 s66, s66, 128
  v_add_u32 v12, s66, v17
  s_lshl_b32 s68, s59, 4
  s_lshl_b32 s69, s59, 5
  s_mov_b32 s70, 64
  s_branch go_d_128
go_f_126:
  v_lshlrev_b32 v17, 4, v15
  s_mov_b32 s68, 1024
  s_cmp_eq_u32 s67, 1
  s_cbranch_scc1 go_k_127
  v_and_b32 v17, 3, v14
  v_lshlrev_b32 v17, 4, v17
  v_and_b32 v15, 8, v14
  v_lshl_add_u32 v17, v15, 3, v17
  v_and_b32 v15, 4, v14
  v_lshl_add_u32 v17, v15, 8, v17
  s_mov_b32 s68, 128
go_k_127:
  v_and_b32 v15, 16, v14
  v_lshl_add_u32 v17, v15, 5, v17
  v_and_b32 v15, 32, v14
  v_lshl_add_u32 v17, v15, 3, v17
  s_mul_i32 s66, s66, 4096
  s_mul_i32 s71, s71, 1048576
  s_add_u32 s66, s66, s71
  v_add_u32 v12, s66, v17
  s_mov_b32 s69, 262144
  s_mov_b32 s70, 2048
go_d_128:
  v_and_b32 v15, 15, v14
  v_lshlrev_b32 v17, 4, v15
  v_and_b32 v15, 16, v14
  v_lshl_add_u32 v17, v15, 5, v17
  v_and_b32 v15, 32, v14
  v_lshl_add_u32 v17, v15, 3, v17
  s_lshr_b32 s66, s20, 2
  s_mul_i32 s66, s66, 65536
  s_and_b32 s71, s20, 3
  s_lshl_b32 s71, s71, 12
  s_add_u32 s66, s66, s71
  s_add_u32 s66, s66, 32768
  v_add_u32 v13, s66, v17
  v_mov_b32 v116, 0
  v_mov_b32 v117, 0
  v_mov_b32 v118, 0
  v_mov_b32 v119, 0
  v_mov_b32 v120, 0
  v_mov_b32 v121, 0
  v_mov_b32 v122, 0
  v_mov_b32 v123, 0
  v_mov_b32 v124, 0
  v_mov_b32 v125, 0
  v_mov_b32 v126, 0
  v_mov_b32 v127, 0
  v_mov_b32 v128, 0
  v_mov_b32 v129, 0
  v_mov_b32 v130, 0
  v_mov_b32 v131, 0
  v_mov_b32 v132, 0
  v_mov_b32 v133, 0
  v_mov_b32 v134, 0
  v_mov_b32 v135, 0
  v_mov_b32 v136, 0
  v_mov_b32 v137, 0
  v_mov_b32 v138, 0
  v_mov_b32 v139, 0
  v_mov_b32 v140, 0
  v_mov_b32 v141, 0
  v_mov_b32 v142, 0
  v_mov_b32 v143, 0
  v_mov_b32 v144, 0
  v_mov_b32 v145, 0
  v_mov_b32 v146, 0
  v_mov_b32 v147, 0
  v_mov_b32 v148, 0
  v_mov_b32 v149, 0
  v_mov_b32 v150, 0
  v_mov_b32 v151, 0
  v_mov_b32 v152, 0
  v_mov_b32 v153, 0
  v_mov_b32 v154, 0
  v_mov_b32 v155, 0
  v_mov_b32 v156, 0
  v_mov_b32 v157, 0
  v_mov_b32 v158, 0
  v_mov_b32 v159, 0
  v_mov_b32 v160, 0
  v_mov_b32 v161, 0
  v_mov_b32 v162, 0
  v_mov_b32 v163, 0
  v_mov_b32 v164, 0
  v_mov_b32 v165, 0
  v_mov_b32 v166, 0
  v_mov_b32 v167, 0
  v_mov_b32 v168, 0
  v_mov_b32 v169, 0
  v_mov_b32 v170, 0
  v_mov_b32 v171, 0
  v_mov_b32 v172, 0
  v_mov_b32 v173, 0
  v_mov_b32 v174, 0
  v_mov_b32 v175, 0
  v_mov_b32 v176, 0
  v_mov_b32 v177, 0
  v_mov_b32 v178, 0
  v_mov_b32 v179, 0
  v_mov_b32 v180, 0
  v_mov_b32 v181, 0
  v_mov_b32 v182, 0
  v_mov_b32 v183, 0
  v_mov_b32 v184, 0
  v_mov_b32 v185, 0
  v_mov_b32 v186, 0
  v_mov_b32 v187, 0
  v_mov_b32 v188, 0
  v_mov_b32 v189, 0
  v_mov_b32 v190, 0
  v_mov_b32 v191, 0
  v_mov_b32 v192, 0
  v_mov_b32 v193, 0
  v_mov_b32 v194, 0
  v_mov_b32 v195, 0
  v_mov_b32 v196, 0
  v_mov_b32 v197, 0
  v_mov_b32 v198, 0
  v_mov_b32 v199, 0
  v_mov_b32 v200, 0
  v_mov_b32 v201, 0
  v_mov_b32 v202, 0
  v_mov_b32 v203, 0
  v_mov_b32 v204, 0
  v_mov_b32 v205, 0
  v_mov_b32 v206, 0
  v_mov_b32 v207, 0
  v_mov_b32 v208, 0
  v_mov_b32 v209, 0
  v_mov_b32 v210, 0
  v_mov_b32 v211, 0
  v_mov_b32 v212, 0
  v_mov_b32 v213, 0
  v_mov_b32 v214, 0
  v_mov_b32 v215, 0
  v_mov_b32 v216, 0
  v_mov_b32 v217, 0
  v_mov_b32 v218, 0
  v_mov_b32 v219, 0
  v_mov_b32 v220, 0
  v_mov_b32 v221, 0
  v_mov_b32 v222, 0
  v_mov_b32 v223, 0
  v_mov_b32 v224, 0
  v_mov_b32 v225, 0
  v_mov_b32 v226, 0
  v_mov_b32 v227, 0
  v_mov_b32 v228, 0
  v_mov_b32 v229, 0
  v_mov_b32 v230, 0
  v_mov_b32 v231, 0
  v_mov_b32 v232, 0
  v_mov_b32 v233, 0
  v_mov_b32 v234, 0
  v_mov_b32 v235, 0
  v_mov_b32 v236, 0
  v_mov_b32 v237, 0
  v_mov_b32 v238, 0
  v_mov_b32 v239, 0
  v_mov_b32 v240, 0
  v_mov_b32 v241, 0
  v_mov_b32 v242, 0
  v_mov_b32 v243, 0
  s_mov_b32 s72, s63
  s_mov_b32 s73, 16384
  s_mov_b32 s75, 16384
  s_add_u32 s74, s63, 49152
  s_add_u32 s80, s63, 131072
  s_mov_b32 s78, s80
  s_mov_b32 s79, -65536
  s_mov_b32 s81, 32768
  s_mov_b32 s64, 16
  s_waitcnt vmcnt(8)
  s_barrier
  ds_read_b64_tr_b16 v[20:21], v1
  ds_read_b64_tr_b16 v[22:23], v1 offset:1024
  ds_read_b128 v[52:55], v5 offset:0
  ds_read_b128 v[56:59], v5 offset:2048
  ds_read_b128 v[60:63], v5 offset:4096
  ds_read_b128 v[64:67], v5 offset:6144
  ds_read_b128 v[68:71], v5 offset:8192
  ds_read_b128 v[72:75], v5 offset:10240
  ds_read_b128 v[76:79], v5 offset:12288
  ds_read_b128 v[80:83], v5 offset:14336
  ds_read_b64_tr_b16 v[24:25], v2
  ds_read_b64_tr_b16 v[26:27], v2 offset:1024
  ds_read_b64_tr_b16 v[28:29], v3
  ds_read_b64_tr_b16 v[30:31], v3 offset:1024
  ds_read_b64_tr_b16 v[32:33], v4
  ds_read_b64_tr_b16 v[34:35], v4 offset:1024
  v_add_u32 v1, s73, v1
  v_add_u32 v2, s73, v2
  v_add_u32 v3, s73, v3
  v_add_u32 v4, s73, v4
gk_131:
  s_waitcnt lgkmcnt(0)
  s_add_u32 m0, s78, 0
  v_mfma_f32_16x16x32_bf16 v[116:119], v[20:23], v[52:55], v[116:119]
  buffer_load_dwordx4 v8, s[44:47], s83 offen lds
  ds_read_b64_tr_b16 v[36:37], v1
  v_mfma_f32_16x16x32_bf16 v[132:135], v[20:23], v[56:59], v[132:135]
  ds_read_b64_tr_b16 v[38:39], v1 offset:1024
  v_mfma_f32_16x16x32_bf16 v[148:151], v[20:23], v[60:63], v[148:151]
  ds_read_b128 v[84:87], v6 offset:0
  v_mfma_f32_16x16x32_bf16 v[164:167], v[20:23], v[64:67], v[164:167]
  ds_read_b128 v[88:91], v6 offset:2048
  s_add_u32 m0, s78, 8192
  v_mfma_f32_16x16x32_bf16 v[180:183], v[20:23], v[68:71], v[180:183]
  buffer_load_dwordx4 v9, s[44:47], s83 offen lds
  ds_read_b128 v[92:95], v6 offset:4096
  v_mfma_f32_16x16x32_bf16 v[196:199], v[20:23], v[72:75], v[196:199]
  ds_read_b128 v[96:99], v6 offset:6144
  v_mfma_f32_16x16x32_bf16 v[212:215], v[20:23], v[76:79], v[212:215]
  ds_read_b128 v[100:103], v6 offset:8192
  v_mfma_f32_16x16x32_bf16 v[228:231], v[20:23], v[80:83], v[228:231]
  ds_read_b128 v[104:107], v6 offset:10240
  s_add_u32 m0, s78, 16384
  v_mfma_f32_16x16x32_bf16 v[120:123], v[24:27], v[52:55], v[120:123]
  buffer_load_dwordx4 v10, s[44:47], s83 offen lds
  ds_read_b128 v[108:111], v6 offset:12288
  v_mfma_f32_16x16x32_bf16 v[136:139], v[24:27], v[56:59], v[136:139]
  ds_read_b128 v[112:115], v6 offset:14336
  v_mfma_f32_16x16x32_bf16 v[152:155], v[24:27], v[60:63], v[152:155]
  ds_read_b64_tr_b16 v[40:41], v2
  v_mfma_f32_16x16x32_bf16 v[168:171], v[24:27], v[64:67], v[168:171]
  ds_read_b64_tr_b16 v[42:43], v2 offset:1024
  s_add_u32 m0, s78, 24576
  v_mfma_f32_16x16x32_bf16 v[184:187], v[24:27], v[68:71], v[184:187]
  buffer_load_dwordx4 v11, s[44:47], s83 offen lds
  s_add_u32 s60, s60, 128
  s_bitcmp1_b32 s60, 11
  s_cselect_b32 s60, 1073743872, s60
  s_xor_b32 s83, s60, s82
  ds_read_b64_tr_b16 v[44:45], v3
  v_mfma_f32_16x16x32_bf16 v[200:203], v[24:27], v[72:75], v[200:203]
  ds_read_b64_tr_b16 v[46:47], v3 offset:1024
  v_mfma_f32_16x16x32_bf16 v[216:219], v[24:27], v[76:79], v[216:219]
  ds_read_b64_tr_b16 v[48:49], v4
  v_mfma_f32_16x16x32_bf16 v[232:235], v[24:27], v[80:83], v[232:235]
  ds_read_b64_tr_b16 v[50:51], v4 offset:1024
  v_mfma_f32_16x16x32_bf16 v[124:127], v[28:31], v[52:55], v[124:127]
  s_add_u32 s72, s72, s73
  s_cmp_eq_u32 s72, s74
  s_cselect_b32 s73, -49152, s75
  v_mfma_f32_16x16x32_bf16 v[140:143], v[28:31], v[56:59], v[140:143]
  v_add_u32 v1, s73, v1
  v_add_u32 v2, s73, v2
  v_mfma_f32_16x16x32_bf16 v[156:159], v[28:31], v[60:63], v[156:159]
  v_add_u32 v3, s73, v3
  v_add_u32 v4, s73, v4
  v_mfma_f32_16x16x32_bf16 v[172:175], v[28:31], v[64:67], v[172:175]
  s_add_u32 s78, s78, s79
  s_cmp_eq_u32 s78, s80
  s_cselect_b32 s79, -65536, s81
  v_mfma_f32_16x16x32_bf16 v[188:191], v[28:31], v[68:71], v[188:191]
  v_add_u32 v5, s79, v5
  v_mfma_f32_16x16x32_bf16 v[204:207], v[28:31], v[72:75], v[204:207]
  v_mfma_f32_16x16x32_bf16 v[220:223], v[28:31], v[76:79], v[220:223]
  v_mfma_f32_16x16x32_bf16 v[236:239], v[28:31], v[80:83], v[236:239]
  v_mfma_f32_16x16x32_bf16 v[128:131], v[32:35], v[52:55], v[128:131]
  v_mfma_f32_16x16x32_bf16 v[144:147], v[32:35], v[56:59], v[144:147]
  v_mfma_f32_16x16x32_bf16 v[160:163], v[32:35], v[60:63], v[160:163]
  v_mfma_f32_16x16x32_bf16 v[176:179], v[32:35], v[64:67], v[176:179]
  v_mfma_f32_16x16x32_bf16 v[192:195], v[32:35], v[68:71], v[192:195]
  v_mfma_f32_16x16x32_bf16 v[208:211], v[32:35], v[72:75], v[208:211]
  v_mfma_f32_16x16x32_bf16 v[224:227], v[32:35], v[76:79], v[224:227]
  v_mfma_f32_16x16x32_bf16 v[240:243], v[32:35], v[80:83], v[240:243]
  s_waitcnt vmcnt(4) lgkmcnt(0)
  s_barrier
  s_add_u32 m0, s72, -16384
  v_mfma_f32_16x16x32_bf16 v[116:119], v[36:39], v[84:87], v[116:119]
  buffer_load_dwordx4 v7, s[48:51], s77 offen lds
  ds_read_b64_tr_b16 v[20:21], v1
  v_mfma_f32_16x16x32_bf16 v[132:135], v[36:39], v[88:91], v[132:135]
  ds_read_b64_tr_b16 v[22:23], v1 offset:1024
  v_mfma_f32_16x16x32_bf16 v[148:151], v[36:39], v[92:95], v[148:151]
  ds_read_b128 v[52:55], v5 offset:0
  v_mfma_f32_16x16x32_bf16 v[164:167], v[36:39], v[96:99], v[164:167]
  ds_read_b128 v[56:59], v5 offset:2048
  s_add_u32 m0, s72, -8192
  v_mfma_f32_16x16x32_bf16 v[180:183], v[36:39], v[100:103], v[180:183]
  buffer_load_dwordx4 v7, s[52:55], s77 offen lds
  s_add_u32 s61, s61, s62
  s_xor_b32 s77, s61, s76
  ds_read_b128 v[60:63], v5 offset:4096
  v_mfma_f32_16x16x32_bf16 v[196:199], v[36:39], v[104:107], v[196:199]
  ds_read_b128 v[64:67], v5 offset:6144
  v_mfma_f32_16x16x32_bf16 v[212:215], v[36:39], v[108:111], v[212:215]
  ds_read_b128 v[68:71], v5 offset:8192
  v_mfma_f32_16x16x32_bf16 v[228:231], v[36:39], v[112:115], v[228:231]
  ds_read_b128 v[72:75], v5 offset:10240
  s_add_u32 m0, s72, 0
  v_mfma_f32_16x16x32_bf16 v[120:123], v[40:43], v[84:87], v[120:123]
  buffer_load_dwordx4 v7, s[48:51], s77 offen lds
  ds_read_b128 v[76:79], v5 offset:12288
  v_mfma_f32_16x16x32_bf16 v[136:139], v[40:43], v[88:91], v[136:139]
  ds_read_b128 v[80:83], v5 offset:14336
  v_mfma_f32_16x16x32_bf16 v[152:155], v[40:43], v[92:95], v[152:155]
  ds_read_b64_tr_b16 v[24:25], v2
  v_mfma_f32_16x16x32_bf16 v[168:171], v[40:43], v[96:99], v[168:171]
  ds_read_b64_tr_b16 v[26:27], v2 offset:1024
  s_add_u32 m0, s72, 8192
  v_mfma_f32_16x16x32_bf16 v[184:187], v[40:43], v[100:103], v[184:187]
  buffer_load_dwordx4 v7, s[52:55], s77 offen lds
  s_add_u32 s61, s61, s62
  s_xor_b32 s77, s61, s76
  ds_read_b64_tr_b16 v[28:29], v3
  v_mfma_f32_16x16x32_bf16 v[200:203], v[40:43], v[104:107], v[200:203]
  ds_read_b64_tr_b16 v[30:31], v3 offset:1024
  v_mfma_f32_16x16x32_bf16 v[216:219], v[40:43], v[108:111], v[216:219]
  ds_read_b64_tr_b16 v[32:33], v4
  v_mfma_f32_16x16x32_bf16 v[232:235], v[40:43], v[112:115], v[232:235]
  ds_read_b64_tr_b16 v[34:35], v4 offset:1024
  v_mfma_f32_16x16x32_bf16 v[124:127], v[44:47], v[84:87], v[124:127]
  s_add_u32 s72, s72, s73
  s_cmp_eq_u32 s72, s74
  s_cselect_b32 s73, -49152, s75
  v_mfma_f32_16x16x32_bf16 v[140:143], v[44:47], v[88:91], v[140:143]
  v_add_u32 v1, s73, v1
  v_add_u32 v2, s73, v2
  v_mfma_f32_16x16x32_bf16 v[156:159], v[44:47], v[92:95], v[156:159]
  v_add_u32 v3, s73, v3
  v_add_u32 v4, s73, v4
  v_mfma_f32_16x16x32_bf16 v[172:175], v[44:47], v[96:99], v[172:175]
  v_xor_b32 v6, 64, v5
  s_sub_u32 s64, s64, 1
  v_mfma_f32_16x16x32_bf16 v[188:191], v[44:47], v[100:103], v[188:191]
  v_mfma_f32_16x16x32_bf16 v[204:207], v[44:47], v[104:107], v[204:207]
  v_mfma_f32_16x16x32_bf16 v[220:223], v[44:47], v[108:111], v[220:223]
  v_mfma_f32_16x16x32_bf16 v[236:239], v[44:47], v[112:115], v[236:239]
  v_mfma_f32_16x16x32_bf16 v[128:131], v[48:51], v[84:87], v[128:131]
  v_mfma_f32_16x16x32_bf16 v[144:147], v[48:51], v[88:91], v[144:147]
  v_mfma_f32_16x16x32_bf16 v[160:163], v[48:51], v[92:95], v[160:163]
  v_mfma_f32_16x16x32_bf16 v[176:179], v[48:51], v[96:99], v[176:179]
  v_mfma_f32_16x16x32_bf16 v[192:195], v[48:51], v[100:103], v[192:195]
  v_mfma_f32_16x16x32_bf16 v[208:211], v[48:51], v[104:107], v[208:211]
  v_mfma_f32_16x16x32_bf16 v[224:227], v[48:51], v[108:111], v[224:227]
  v_mfma_f32_16x16x32_bf16 v[240:243], v[48:51], v[112:115], v[240:243]
  s_cmp_lg_u32 s64, 0
  s_cbranch_scc1 gk_131
ge_129:
  s_waitcnt vmcnt(0) lgkmcnt(0)
  s_barrier
  s_cmp_lg_u32 s20, 0
  s_cbranch_scc1 w_pop_132
  s_mov_b64 exec, 1
  v_mov_b32 v255, 1
  buffer_atomic_add v255, off, s[8:11], s28 sc0 sc1
  s_mov_b64 exec, -1
w_pop_132:
  s_cmp_lt_u32 s86, 8
  s_cselect_b64 vcc, -1, 0
  s_mov_b32 s66, s56
  v_mul_f32 v116, s65, v116
  v_mul_f32 v117, s65, v117
  v_mul_f32 v118, s65, v118
  v_mul_f32 v119, s65, v119
  v_mul_f32 v120, s65, v120
  v_mul_f32 v121, s65, v121
  v_mul_f32 v122, s65, v122
  v_mul_f32 v123, s65, v123
  v_cvt_pk_bf16_f32 v116, v116, v117
  v_cvt_pk_bf16_f32 v117, v118, v119
  v_cvt_pk_bf16_f32 v118, v120, v121
  v_cvt_pk_bf16_f32 v119, v122, v123
  v_mul_f32 v124, s65, v124
  v_mul_f32 v125, s65, v125
  v_mul_f32 v126, s65, v126
  v_mul_f32 v127, s65, v127
  v_mul_f32 v128, s65, v128
  v_mul_f32 v129, s65, v129
  v_mul_f32 v130, s65, v130
  v_mul_f32 v131, s65, v131
  v_cvt_pk_bf16_f32 v124, v124, v125
  v_cvt_pk_bf16_f32 v125, v126, v127
  v_cvt_pk_bf16_f32 v126, v128, v129
  v_cvt_pk_bf16_f32 v127, v130, v131
  v_permlane16_swap_b32 v116, v118
  v_permlane16_swap_b32 v117, v119
  v_permlane16_swap_b32 v124, v126
  v_permlane16_swap_b32 v125, v127
  s_mov_b32 s71, s66
  s_cbranch_vccz ex_133
  ds_write_b128 v13, v[116:119] offset:0
  ds_write_b128 v13, v[124:127] offset:2048
ex_133:
  buffer_store_dwordx4 v[116:119], v12, s[24:27], s71 offen sc1
  s_add_u32 s71, s71, s70
  buffer_store_dwordx4 v[124:127], v12, s[24:27], s71 offen sc1
  v_mul_f32 v132, s65, v132
  v_mul_f32 v133, s65, v133
  v_mul_f32 v134, s65, v134
  v_mul_f32 v135, s65, v135
  v_mul_f32 v136, s65, v136
  v_mul_f32 v137, s65, v137
  v_mul_f32 v138, s65, v138
  v_mul_f32 v139, s65, v139
  v_cvt_pk_bf16_f32 v132, v132, v133
  v_cvt_pk_bf16_f32 v133, v134, v135
  v_cvt_pk_bf16_f32 v134, v136, v137
  v_cvt_pk_bf16_f32 v135, v138, v139
  v_mul_f32 v140, s65, v140
  v_mul_f32 v141, s65, v141
  v_mul_f32 v142, s65, v142
  v_mul_f32 v143, s65, v143
  v_mul_f32 v144, s65, v144
  v_mul_f32 v145, s65, v145
  v_mul_f32 v146, s65, v146
  v_mul_f32 v147, s65, v147
  v_cvt_pk_bf16_f32 v140, v140, v141
  v_cvt_pk_bf16_f32 v141, v142, v143
  v_cvt_pk_bf16_f32 v142, v144, v145
  v_cvt_pk_bf16_f32 v143, v146, v147
  v_permlane16_swap_b32 v132, v134
  v_permlane16_swap_b32 v133, v135
  v_permlane16_swap_b32 v140, v142
  v_permlane16_swap_b32 v141, v143
  s_add_u32 s71, s66, s68
  s_cbranch_vccz ex_134
  ds_write_b128 v13, v[132:135] offset:1024
  ds_write_b128 v13, v[140:143] offset:3072
ex_134:
  buffer_store_dwordx4 v[132:135], v12, s[24:27], s71 offen sc1
  s_add_u32 s71, s71, s70
  buffer_store_dwordx4 v[140:143], v12, s[24:27], s71 offen sc1
  s_add_u32 s66, s66, s69
  v_mul_f32 v148, s65, v148
  v_mul_f32 v149, s65, v149
  v_mul_f32 v150, s65, v150
  v_mul_f32 v151, s65, v151
  v_mul_f32 v152, s65, v152
  v_mul_f32 v153, s65, v153
  v_mul_f32 v154, s65, v154
  v_mul_f32 v155, s65, v155
  v_cvt_pk_bf16_f32 v148, v148, v149
  v_cvt_pk_bf16_f32 v149, v150, v151
  v_cvt_pk_bf16_f32 v150, v152, v153
  v_cvt_pk_bf16_f32 v151, v154, v155
  v_mul_f32 v156, s65, v156
  v_mul_f32 v157, s65, v157
  v_mul_f32 v158, s65, v158
  v_mul_f32 v159, s65, v159
  v_mul_f32 v160, s65, v160
  v_mul_f32 v161, s65, v161
  v_mul_f32 v162, s65, v162
  v_mul_f32 v163, s65, v163
  v_cvt_pk_bf16_f32 v156, v156, v157
  v_cvt_pk_bf16_f32 v157, v158, v159
  v_cvt_pk_bf16_f32 v158, v160, v161
  v_cvt_pk_bf16_f32 v159, v162, v163
  v_permlane16_swap_b32 v148, v150
  v_permlane16_swap_b32 v149, v151
  v_permlane16_swap_b32 v156, v158
  v_permlane16_swap_b32 v157, v159
  s_mov_b32 s71, s66
  s_cbranch_vccz ex_135
  ds_write_b128 v13, v[148:151] offset:16384
  ds_write_b128 v13, v[156:159] offset:18432
ex_135:
  buffer_store_dwordx4 v[148:151], v12, s[24:27], s71 offen sc1
  s_add_u32 s71, s71, s70
  buffer_store_dwordx4 v[156:159], v12, s[24:27], s71 offen sc1
  v_mul_f32 v164, s65, v164
  v_mul_f32 v165, s65, v165
  v_mul_f32 v166, s65, v166
  v_mul_f32 v167, s65, v167
  v_mul_f32 v168, s65, v168
  v_mul_f32 v169, s65, v169
  v_mul_f32 v170, s65, v170
  v_mul_f32 v171, s65, v171
  v_cvt_pk_bf16_f32 v164, v164, v165
  v_cvt_pk_bf16_f32 v165, v166, v167
  v_cvt_pk_bf16_f32 v166, v168, v169
  v_cvt_pk_bf16_f32 v167, v170, v171
  v_mul_f32 v172, s65, v172
  v_mul_f32 v173, s65, v173
  v_mul_f32 v174, s65, v174
  v_mul_f32 v175, s65, v175
  v_mul_f32 v176, s65, v176
  v_mul_f32 v177, s65, v177
  v_mul_f32 v178, s65, v178
  v_mul_f32 v179, s65, v179
  v_cvt_pk_bf16_f32 v172, v172, v173
  v_cvt_pk_bf16_f32 v173, v174, v175
  v_cvt_pk_bf16_f32 v174, v176, v177
  v_cvt_pk_bf16_f32 v175, v178, v179
  v_permlane16_swap_b32 v164, v166
  v_permlane16_swap_b32 v165, v167
  v_permlane16_swap_b32 v172, v174
  v_permlane16_swap_b32 v173, v175
  s_add_u32 s71, s66, s68
  s_cbranch_vccz ex_136
  ds_write_b128 v13, v[164:167] offset:17408
  ds_write_b128 v13, v[172:175] offset:19456
ex_136:
  buffer_store_dwordx4 v[164:167], v12, s[24:27], s71 offen sc1
  s_add_u32 s71, s71, s70
  buffer_store_dwordx4 v[172:175], v12, s[24:27], s71 offen sc1
  s_add_u32 s66, s66, s69
  v_mul_f32 v180, s65, v180
  v_mul_f32 v181, s65, v181
  v_mul_f32 v182, s65, v182
  v_mul_f32 v183, s65, v183
  v_mul_f32 v184, s65, v184
  v_mul_f32 v185, s65, v185
  v_mul_f32 v186, s65, v186
  v_mul_f32 v187, s65, v187
  v_cvt_pk_bf16_f32 v180, v180, v181
  v_cvt_pk_bf16_f32 v181, v182, v183
  v_cvt_pk_bf16_f32 v182, v184, v185
  v_cvt_pk_bf16_f32 v183, v186, v187
  v_mul_f32 v188, s65, v188
  v_mul_f32 v189, s65, v189
  v_mul_f32 v190, s65, v190
  v_mul_f32 v191, s65, v191
  v_mul_f32 v192, s65, v192
  v_mul_f32 v193, s65, v193
  v_mul_f32 v194, s65, v194
  v_mul_f32 v195, s65, v195
  v_cvt_pk_bf16_f32 v188, v188, v189
  v_cvt_pk_bf16_f32 v189, v190, v191
  v_cvt_pk_bf16_f32 v190, v192, v193
  v_cvt_pk_bf16_f32 v191, v194, v195
  v_permlane16_swap_b32 v180, v182
  v_permlane16_swap_b32 v181, v183
  v_permlane16_swap_b32 v188, v190
  v_permlane16_swap_b32 v189, v191
  s_mov_b32 s71, s66
  s_cbranch_vccz ex_137
  ds_write_b128 v13, v[180:183] offset:32768
  ds_write_b128 v13, v[188:191] offset:34816
ex_137:
  buffer_store_dwordx4 v[180:183], v12, s[24:27], s71 offen sc1
  s_add_u32 s71, s71, s70
  buffer_store_dwordx4 v[188:191], v12, s[24:27], s71 offen sc1
  v_mul_f32 v196, s65, v196
  v_mul_f32 v197, s65, v197
  v_mul_f32 v198, s65, v198
  v_mul_f32 v199, s65, v199
  v_mul_f32 v200, s65, v200
  v_mul_f32 v201, s65, v201
  v_mul_f32 v202, s65, v202
  v_mul_f32 v203, s65, v203
  v_cvt_pk_bf16_f32 v196, v196, v197
  v_cvt_pk_bf16_f32 v197, v198, v199
  v_cvt_pk_bf16_f32 v198, v200, v201
  v_cvt_pk_bf16_f32 v199, v202, v203
  v_mul_f32 v204, s65, v204
  v_mul_f32 v205, s65, v205
  v_mul_f32 v206, s65, v206
  v_mul_f32 v207, s65, v207
  v_mul_f32 v208, s65, v208
  v_mul_f32 v209, s65, v209
  v_mul_f32 v210, s65, v210
  v_mul_f32 v211, s65, v211
  v_cvt_pk_bf16_f32 v204, v204, v205
  v_cvt_pk_bf16_f32 v205, v206, v207
  v_cvt_pk_bf16_f32 v206, v208, v209
  v_cvt_pk_bf16_f32 v207, v210, v211
  v_permlane16_swap_b32 v196, v198
  v_permlane16_swap_b32 v197, v199
  v_permlane16_swap_b32 v204, v206
  v_permlane16_swap_b32 v205, v207
  s_add_u32 s71, s66, s68
  s_cbranch_vccz ex_138
  ds_write_b128 v13, v[196:199] offset:33792
  ds_write_b128 v13, v[204:207] offset:35840
ex_138:
  buffer_store_dwordx4 v[196:199], v12, s[24:27], s71 offen sc1
  s_add_u32 s71, s71, s70
  buffer_store_dwordx4 v[204:207], v12, s[24:27], s71 offen sc1
  s_add_u32 s66, s66, s69
  v_mul_f32 v212, s65, v212
  v_mul_f32 v213, s65, v213
  v_mul_f32 v214, s65, v214
  v_mul_f32 v215, s65, v215
  v_mul_f32 v216, s65, v216
  v_mul_f32 v217, s65, v217
  v_mul_f32 v218, s65, v218
  v_mul_f32 v219, s65, v219
  v_cvt_pk_bf16_f32 v212, v212, v213
  v_cvt_pk_bf16_f32 v213, v214, v215
  v_cvt_pk_bf16_f32 v214, v216, v217
  v_cvt_pk_bf16_f32 v215, v218, v219
  v_mul_f32 v220, s65, v220
  v_mul_f32 v221, s65, v221
  v_mul_f32 v222, s65, v222
  v_mul_f32 v223, s65, v223
  v_mul_f32 v224, s65, v224
  v_mul_f32 v225, s65, v225
  v_mul_f32 v226, s65, v226
  v_mul_f32 v227, s65, v227
  v_cvt_pk_bf16_f32 v220, v220, v221
  v_cvt_pk_bf16_f32 v221, v222, v223
  v_cvt_pk_bf16_f32 v222, v224, v225
  v_cvt_pk_bf16_f32 v223, v226, v227
  v_permlane16_swap_b32 v212, v214
  v_permlane16_swap_b32 v213, v215
  v_permlane16_swap_b32 v220, v222
  v_permlane16_swap_b32 v221, v223
  s_mov_b32 s71, s66
  s_cbranch_vccz ex_139
  ds_write_b128 v13, v[212:215] offset:49152
  ds_write_b128 v13, v[220:223] offset:51200
ex_139:
  buffer_store_dwordx4 v[212:215], v12, s[24:27], s71 offen sc1
  s_add_u32 s71, s71, s70
  buffer_store_dwordx4 v[220:223], v12, s[24:27], s71 offen sc1
  v_mul_f32 v228, s65, v228
  v_mul_f32 v229, s65, v229
  v_mul_f32 v230, s65, v230
  v_mul_f32 v231, s65, v231
  v_mul_f32 v232, s65, v232
  v_mul_f32 v233, s65, v233
  v_mul_f32 v234, s65, v234
  v_mul_f32 v235, s65, v235
  v_cvt_pk_bf16_f32 v228, v228, v229
  v_cvt_pk_bf16_f32 v229, v230, v231
  v_cvt_pk_bf16_f32 v230, v232, v233
  v_cvt_pk_bf16_f32 v231, v234, v235
  v_mul_f32 v236, s65, v236
  v_mul_f32 v237, s65, v237
  v_mul_f32 v238, s65, v238
  v_mul_f32 v239, s65, v239
  v_mul_f32 v240, s65, v240
  v_mul_f32 v241, s65, v241
  v_mul_f32 v242, s65, v242
  v_mul_f32 v243, s65, v243
  v_cvt_pk_bf16_f32 v236, v236, v237
  v_cvt_pk_bf16_f32 v237, v238, v239
  v_cvt_pk_bf16_f32 v238, v240, v241
  v_cvt_pk_bf16_f32 v239, v242, v243
  v_permlane16_swap_b32 v228, v230
  v_permlane16_swap_b32 v229, v231
  v_permlane16_swap_b32 v236, v238
  v_permlane16_swap_b32 v237, v239
  s_add_u32 s71, s66, s68
  s_cbranch_vccz ex_140
  ds_write_b128 v13, v[228:231] offset:50176
  ds_write_b128 v13, v[236:239] offset:52224
ex_140:
  buffer_store_dwordx4 v[228:231], v12, s[24:27], s71 offen sc1
  s_add_u32 s71, s71, s70
  buffer_store_dwordx4 v[236:239], v12, s[24:27], s71 offen sc1
  s_add_u32 s66, s66, s69
  s_cmp_ge_u32 s86, 8
  s_cbranch_scc1 w_next_87
  s_waitcnt lgkmcnt(0)
  s_barrier
w_px_107:
  v_and_b32 v2, 63, v0
  v_lshlrev_b32 v1, 4, v2
  v_lshrrev_b32 v3, 2, v2
  v_and_b32 v3, 12, v3
  v_and_b32 v2, 15, v2
  v_sub_u32 v2, v2, v3
  v_mov_b32 v3, 0xf149f2ca
  v_cmp_le_i32 vcc, 0, v2
  s_nop 1
  v_cndmask_b32 v4, v3, 0, vcc
  v_cmp_le_i32 vcc, 1, v2
  s_nop 1
  v_cndmask_b32 v5, v3, 0, vcc
  v_cmp_le_i32 vcc, 2, v2
  s_nop 1
  v_cndmask_b32 v6, v3, 0, vcc
  v_cmp_le_i32 vcc, 3, v2
  s_nop 1
  v_cndmask_b32 v7, v3, 0, vcc
  s_lshl_b32 s88, s20, 14
  s_add_u32 s88, s88, 32768
  v_add_u32 v2, s88, v1
  ds_read_b128 v[40:43], v2 offset:8192
  ds_read_b128 v[8:11], v2 offset:0
  ds_read_b128 v[56:59], v2 offset:9216
  ds_read_b128 v[24:27], v2 offset:1024
  ds_read_b128 v[44:47], v2 offset:10240
  ds_read_b128 v[12:15], v2 offset:2048
  ds_read_b128 v[60:63], v2 offset:11264
  ds_read_b128 v[28:31], v2 offset:3072
  ds_read_b128 v[48:51], v2 offset:12288
  ds_read_b128 v[16:19], v2 offset:4096
  ds_read_b128 v[64:67], v2 offset:13312
  ds_read_b128 v[32:35], v2 offset:5120
  s_waitcnt lgkmcnt(8)
  ds_read_b128 v[52:55], v2 offset:14336
  ds_read_b128 v[20:23], v2 offset:6144
  ds_read_b128 v[68:71], v2 offset:15360
  ds_read_b128 v[36:39], v2 offset:7168
  s_lshr_b32 s88, s87, 5
  s_lshl_b32 s88, s88, 18
  s_and_b32 s89, s87, 31
  s_lshl_b32 s89, s89, 11
  s_add_u32 s88, s88, s89
  s_add_u32 s88, s88, 134217728
  s_waitcnt lgkmcnt(12)
  v_mfma_f32_16x16x32_bf16 v[72:75], v[40:43], v[8:11], v[4:7]
  v_mfma_f32_16x16x32_bf16 v[76:79], v[40:43], v[24:27], 0
  v_mfma_f32_16x16x32_bf16 v[80:83], v[56:59], v[24:27], v[4:7]
  s_waitcnt lgkmcnt(8)
  v_mfma_f32_16x16x32_bf16 v[72:75], v[44:47], v[12:15], v[72:75]
  v_mfma_f32_16x16x32_bf16 v[76:79], v[44:47], v[28:31], v[76:79]
  v_mfma_f32_16x16x32_bf16 v[80:83], v[60:63], v[28:31], v[80:83]
  s_waitcnt lgkmcnt(4)
  v_mfma_f32_16x16x32_bf16 v[72:75], v[48:51], v[16:19], v[72:75]
  v_mfma_f32_16x16x32_bf16 v[76:79], v[48:51], v[32:35], v[76:79]
  v_mfma_f32_16x16x32_bf16 v[80:83], v[64:67], v[32:35], v[80:83]
  s_waitcnt lgkmcnt(0)
  v_mfma_f32_16x16x32_bf16 v[72:75], v[52:55], v[20:23], v[72:75]
  v_mfma_f32_16x16x32_bf16 v[76:79], v[52:55], v[36:39], v[76:79]
  v_mfma_f32_16x16x32_bf16 v[80:83], v[68:71], v[36:39], v[80:83]
  s_nop 5
  v_max3_f32 v84, v72, v73, v74
  v_max3_f32 v85, v76, v77, v78
  v_max_f32 v84, v84, v75
  v_max3_f32 v85, v85, v79, v80
  v_max3_f32 v85, v85, v81, v82
  v_max_f32 v85, v85, v83
  v_mov_b32 v2, v84
  v_mov_b32 v3, v85
  s_nop 0
  v_permlane16_swap_b32 v2, v84
  v_permlane16_swap_b32 v3, v85
  v_max_f32 v84, v84, v2
  v_max_f32 v85, v85, v3
  v_mov_b32 v2, v84
  v_mov_b32 v3, v85
  s_nop 0
  v_permlane32_swap_b32 v2, v84
  v_permlane32_swap_b32 v3, v85
  v_max_f32 v84, v84, v2
  v_max_f32 v85, v85, v3
  v_sub_f32 v72, v72, v84
  v_sub_f32 v73, v73, v84
  v_sub_f32 v74, v74, v84
  v_sub_f32 v75, v75, v84
  v_sub_f32 v76, v76, v85
  v_sub_f32 v77, v77, v85
  v_sub_f32 v78, v78, v85
  v_sub_f32 v79, v79, v85
  v_sub_f32 v80, v80, v85
  v_sub_f32 v81, v81, v85
  v_sub_f32 v82, v82, v85
  v_sub_f32 v83, v83, v85
  v_exp_f32 v72, v72
  v_exp_f32 v73, v73
  v_exp_f32 v74, v74
  v_exp_f32 v75, v75
  v_exp_f32 v76, v76
  v_exp_f32 v77, v77
  v_exp_f32 v78, v78
  v_exp_f32 v79, v79
  v_exp_f32 v80, v80
  v_exp_f32 v81, v81
  v_exp_f32 v82, v82
  v_exp_f32 v83, v83
  v_cvt_pk_bf16_f32 v86, v72, v73
  v_cvt_pk_bf16_f32 v87, v74, v75
  v_cvt_pk_bf16_f32 v88, v76, v77
  v_cvt_pk_bf16_f32 v89, v78, v79
  v_cvt_pk_bf16_f32 v90, v80, v81
  v_cvt_pk_bf16_f32 v91, v82, v83
  buffer_store_dwordx4 v[84:87], v1, s[24:27], s88 offen sc1
  buffer_store_dwordx4 v[88:91], v1, s[24:27], s88 offen offset:1024 sc1
  s_branch w_next_87
w_qa_102:
  s_load_dwordx2 s[44:45], s[0:1], 0
  s_load_dwordx2 s[48:49], s[0:1], 8
  s_load_dwordx2 s[52:53], s[0:1], 8
  s_mov_b32 s32, s7
  s_lshr_b32 s33, s32, 2
  s_lshl_b32 s85, s6, 2
  s_lshl_b32 s34, s33, 1
  s_add_u32 s85, s85, s34
  s_lshl_b32 s29, s85, 6
  s_add_u32 s29, s29, 124788736
  s_mov_b32 s30, 1
  s_and_b32 s32, s32, 3
  s_lshl_b32 s32, s32, 9
  s_add_u32 s33, s32, 256
  s_lshl_b32 s56, s85, 18
  s_add_u32 s56, s56, 50331648
  s_add_u32 s56, s56, s32
  s_mov_b32 s65, 0x3e8293ee
  s_mov_b32 s67, 0
  s_mov_b32 s58, 2048
  s_mov_b32 s35, 2097152
  s_mov_b32 s86, 8
  s_branch w_big_983
w_kva_100:
  s_mov_b32 s29, 124789760
  s_mov_b32 s30, 1
  s_lshl_b32 s60, s6, 1
  s_add_u32 s60, s60, s7
  s_load_dwordx2 s[44:45], s[0:1], 0
  s_load_dwordx2 s[48:49], s[0:1], 16
  s_load_dwordx2 s[52:53], s[0:1], 24
  s_load_dwordx2 s[56:57], s[0:1], 120
  v_and_b32 v1, 63, v0
  v_lshlrev_b32 v2, 4, v0
  s_waitcnt lgkmcnt(0)
  s_and_b32 s45, s45, 0xffff
  s_mov_b32 s46, 4194304
  s_mov_b32 s47, 0x20000
  s_and_b32 s49, s49, 0xffff
  s_mov_b32 s50, 65536
  s_mov_b32 s51, 0x20000
  s_and_b32 s53, s53, 0xffff
  s_mov_b32 s54, 65536
  s_mov_b32 s55, 0x20000
  s_add_u32 s56, s56, 54525952
  s_addc_u32 s57, s57, 0
  s_and_b32 s57, s57, 0xffff
  s_mov_b32 s58, 262144
  s_mov_b32 s59, 0x20000
  s_lshl_b32 s32, s20, 10
  s_add_u32 m0, s32, 0
  s_mov_b32 s33, 0
  buffer_load_dwordx4 v2, s[48:51], s33 offen lds
  s_add_u32 m0, s32, 65536
  s_nop 0
  buffer_load_dwordx4 v2, s[52:55], s33 offen lds
  s_add_u32 m0, s32, 8192
  s_mov_b32 s33, 8192
  buffer_load_dwordx4 v2, s[48:51], s33 offen lds
  s_add_u32 m0, s32, 73728
  s_nop 0
  buffer_load_dwordx4 v2, s[52:55], s33 offen lds
  s_add_u32 m0, s32, 16384
  s_mov_b32 s33, 16384
  buffer_load_dwordx4 v2, s[48:51], s33 offen lds
  s_add_u32 m0, s32, 81920
  s_nop 0
  buffer_load_dwordx4 v2, s[52:55], s33 offen lds
  s_add_u32 m0, s32, 24576
  s_mov_b32 s33, 24576
  buffer_load_dwordx4 v2, s[48:51], s33 offen lds
  s_add_u32 m0, s32, 90112
  s_nop 0
  buffer_load_dwordx4 v2, s[52:55], s33 offen lds
  s_add_u32 m0, s32, 32768
  s_mov_b32 s33, 32768
  buffer_load_dwordx4 v2, s[48:51], s33 offen lds
  s_add_u32 m0, s32, 98304
  s_nop 0
  buffer_load_dwordx4 v2, s[52:55], s33 offen lds
  s_add_u32 m0, s32, 40960
  s_mov_b32 s33, 40960
  buffer_load_dwordx4 v2, s[48:51], s33 offen lds
  s_add_u32 m0, s32, 106496
  s_nop 0
  buffer_load_dwordx4 v2, s[52:55], s33 offen lds
  s_add_u32 m0, s32, 49152
  s_mov_b32 s33, 49152
  buffer_load_dwordx4 v2, s[48:51], s33 offen lds
  s_add_u32 m0, s32, 114688
  s_nop 0
  buffer_load_dwordx4 v2, s[52:55], s33 offen lds
  s_add_u32 m0, s32, 57344
  s_mov_b32 s33, 57344
  buffer_load_dwordx4 v2, s[48:51], s33 offen lds
  s_add_u32 m0, s32, 122880
  s_nop 0
  buffer_load_dwordx4 v2, s[52:55], s33 offen lds
  s_lshl_b32 s32, s60, 3
  s_add_u32 s32, s32, s20
  v_and_b32 v2, 15, v1
  v_lshrrev_b32 v3, 4, v1
  v_lshlrev_b32 v4, 11, v2
  v_lshl_add_u32 v4, v3, 4, v4
  s_lshl_b32 s33, s32, 16
  v_add_u32 v4, s33, v4
  s_mov_b32 s33, 32768
  buffer_load_dwordx4 v[76:79], v4, s[44:47], 0 offen offset:0
  buffer_load_dwordx4 v[80:83], v4, s[44:47], s33 offen offset:0
  buffer_load_dwordx4 v[84:87], v4, s[44:47], 0 offen offset:64
  buffer_load_dwordx4 v[88:91], v4, s[44:47], s33 offen offset:64
  buffer_load_dwordx4 v[92:95], v4, s[44:47], 0 offen offset:128
  buffer_load_dwordx4 v[96:99], v4, s[44:47], s33 offen offset:128
  buffer_load_dwordx4 v[100:103], v4, s[44:47], 0 offen offset:192
  buffer_load_dwordx4 v[104:107], v4, s[44:47], s33 offen offset:192
  buffer_load_dwordx4 v[108:111], v4, s[44:47], 0 offen offset:256
  buffer_load_dwordx4 v[112:115], v4, s[44:47], s33 offen offset:256
  buffer_load_dwordx4 v[116:119], v4, s[44:47], 0 offen offset:320
  buffer_load_dwordx4 v[120:123], v4, s[44:47], s33 offen offset:320
  buffer_load_dwordx4 v[124:127], v4, s[44:47], 0 offen offset:384
  buffer_load_dwordx4 v[128:131], v4, s[44:47], s33 offen offset:384
  buffer_load_dwordx4 v[132:135], v4, s[44:47], 0 offen offset:448
  buffer_load_dwordx4 v[136:139], v4, s[44:47], s33 offen offset:448
  v_lshrrev_b32 v5, 2, v1
  v_and_b32 v5, 3, v5
  v_lshl_add_u32 v5, v3, 3, v5
  v_lshlrev_b32 v5, 6, v5
  v_and_b32 v6, 3, v1
  v_lshl_add_u32 v5, v6, 3, v5
  v_add_u32 v6, 65536, v5
  v_lshrrev_b32 v7, 5, v1
  v_lshlrev_b32 v7, 10, v7
  v_lshl_add_u32 v7, v2, 4, v7
  v_and_b32 v8, 16, v1
  v_lshl_add_u32 v7, v8, 5, v7
  s_lshl_b32 s32, s32, 12
  v_add_u32 v7, s32, v7
  v_lshlrev_b32 v8, 6, v8
  v_lshrrev_b32 v3, 5, v1
  v_lshl_add_u32 v8, v3, 9, v8
  v_and_b32 v3, 3, v1
  v_lshl_add_u32 v8, v3, 4, v8
  v_and_b32 v3, 12, v1
  v_lshl_add_u32 v8, v3, 5, v8
  v_add_u32 v8, s32, v8
  v_mov_b32 v12, 0
  v_mov_b32 v13, 0
  v_mov_b32 v14, 0
  v_mov_b32 v15, 0
  v_mov_b32 v16, 0
  v_mov_b32 v17, 0
  v_mov_b32 v18, 0
  v_mov_b32 v19, 0
  v_mov_b32 v20, 0
  v_mov_b32 v21, 0
  v_mov_b32 v22, 0
  v_mov_b32 v23, 0
  v_mov_b32 v24, 0
  v_mov_b32 v25, 0
  v_mov_b32 v26, 0
  v_mov_b32 v27, 0
  v_mov_b32 v28, 0
  v_mov_b32 v29, 0
  v_mov_b32 v30, 0
  v_mov_b32 v31, 0
  v_mov_b32 v32, 0
  v_mov_b32 v33, 0
  v_mov_b32 v34, 0
  v_mov_b32 v35, 0
  v_mov_b32 v36, 0
  v_mov_b32 v37, 0
  v_mov_b32 v38, 0
  v_mov_b32 v39, 0
  v_mov_b32 v40, 0
  v_mov_b32 v41, 0
  v_mov_b32 v42, 0
  v_mov_b32 v43, 0
  s_waitcnt vmcnt(16)
  s_barrier
  ds_read_b64_tr_b16 v[44:45], v5 offset:0
  ds_read_b64_tr_b16 v[46:47], v5 offset:256
  ds_read_b64_tr_b16 v[48:49], v5 offset:32
  ds_read_b64_tr_b16 v[50:51], v5 offset:288
  ds_read_b64_tr_b16 v[52:53], v6 offset:0
  ds_read_b64_tr_b16 v[54:55], v6 offset:256
  ds_read_b64_tr_b16 v[56:57], v6 offset:32
  ds_read_b64_tr_b16 v[58:59], v6 offset:288
  buffer_load_dwordx4 v[140:143], v4, s[44:47], 0 offen offset:512
  buffer_load_dwordx4 v[144:147], v4, s[44:47], s33 offen offset:512
  buffer_load_dwordx4 v[148:151], v4, s[44:47], 0 offen offset:576
  buffer_load_dwordx4 v[152:155], v4, s[44:47], s33 offen offset:576
  buffer_load_dwordx4 v[156:159], v4, s[44:47], 0 offen offset:640
  buffer_load_dwordx4 v[160:163], v4, s[44:47], s33 offen offset:640
  buffer_load_dwordx4 v[164:167], v4, s[44:47], 0 offen offset:704
  buffer_load_dwordx4 v[168:171], v4, s[44:47], s33 offen offset:704
  buffer_load_dwordx4 v[172:175], v4, s[44:47], 0 offen offset:768
  buffer_load_dwordx4 v[176:179], v4, s[44:47], s33 offen offset:768
  buffer_load_dwordx4 v[180:183], v4, s[44:47], 0 offen offset:832
  buffer_load_dwordx4 v[184:187], v4, s[44:47], s33 offen offset:832
  buffer_load_dwordx4 v[188:191], v4, s[44:47], 0 offen offset:896
  buffer_load_dwordx4 v[192:195], v4, s[44:47], s33 offen offset:896
  buffer_load_dwordx4 v[196:199], v4, s[44:47], 0 offen offset:960
  buffer_load_dwordx4 v[200:203], v4, s[44:47], s33 offen offset:960
  s_waitcnt vmcnt(16)
  ds_read_b64_tr_b16 v[60:61], v5 offset:2048
  ds_read_b64_tr_b16 v[62:63], v5 offset:2304
  ds_read_b64_tr_b16 v[64:65], v5 offset:2080
  ds_read_b64_tr_b16 v[66:67], v5 offset:2336
  ds_read_b64_tr_b16 v[68:69], v6 offset:2048
  ds_read_b64_tr_b16 v[70:71], v6 offset:2304
  ds_read_b64_tr_b16 v[72:73], v6 offset:2080
  ds_read_b64_tr_b16 v[74:75], v6 offset:2336
  s_waitcnt lgkmcnt(8)
  v_mfma_f32_16x16x32_bf16 v[12:15], v[44:47], v[76:79], v[12:15]
  v_mfma_f32_16x16x32_bf16 v[16:19], v[48:51], v[76:79], v[16:19]
  v_mfma_f32_16x16x32_bf16 v[28:31], v[76:79], v[52:55], v[28:31]
  v_mfma_f32_16x16x32_bf16 v[36:39], v[76:79], v[56:59], v[36:39]
  v_mfma_f32_16x16x32_bf16 v[20:23], v[44:47], v[80:83], v[20:23]
  v_mfma_f32_16x16x32_bf16 v[24:27], v[48:51], v[80:83], v[24:27]
  v_mfma_f32_16x16x32_bf16 v[32:35], v[80:83], v[52:55], v[32:35]
  v_mfma_f32_16x16x32_bf16 v[40:43], v[80:83], v[56:59], v[40:43]
  ds_read_b64_tr_b16 v[44:45], v5 offset:4096
  ds_read_b64_tr_b16 v[46:47], v5 offset:4352
  ds_read_b64_tr_b16 v[48:49], v5 offset:4128
  ds_read_b64_tr_b16 v[50:51], v5 offset:4384
  ds_read_b64_tr_b16 v[52:53], v6 offset:4096
  ds_read_b64_tr_b16 v[54:55], v6 offset:4352
  ds_read_b64_tr_b16 v[56:57], v6 offset:4128
  ds_read_b64_tr_b16 v[58:59], v6 offset:4384
  s_waitcnt lgkmcnt(8)
  v_mfma_f32_16x16x32_bf16 v[12:15], v[60:63], v[84:87], v[12:15]
  v_mfma_f32_16x16x32_bf16 v[16:19], v[64:67], v[84:87], v[16:19]
  v_mfma_f32_16x16x32_bf16 v[28:31], v[84:87], v[68:71], v[28:31]
  v_mfma_f32_16x16x32_bf16 v[36:39], v[84:87], v[72:75], v[36:39]
  v_mfma_f32_16x16x32_bf16 v[20:23], v[60:63], v[88:91], v[20:23]
  v_mfma_f32_16x16x32_bf16 v[24:27], v[64:67], v[88:91], v[24:27]
  v_mfma_f32_16x16x32_bf16 v[32:35], v[88:91], v[68:71], v[32:35]
  v_mfma_f32_16x16x32_bf16 v[40:43], v[88:91], v[72:75], v[40:43]
  ds_read_b64_tr_b16 v[60:61], v5 offset:6144
  ds_read_b64_tr_b16 v[62:63], v5 offset:6400
  ds_read_b64_tr_b16 v[64:65], v5 offset:6176
  ds_read_b64_tr_b16 v[66:67], v5 offset:6432
  ds_read_b64_tr_b16 v[68:69], v6 offset:6144
  ds_read_b64_tr_b16 v[70:71], v6 offset:6400
  ds_read_b64_tr_b16 v[72:73], v6 offset:6176
  ds_read_b64_tr_b16 v[74:75], v6 offset:6432
  s_waitcnt lgkmcnt(8)
  v_mfma_f32_16x16x32_bf16 v[12:15], v[44:47], v[92:95], v[12:15]
  v_mfma_f32_16x16x32_bf16 v[16:19], v[48:51], v[92:95], v[16:19]
  v_mfma_f32_16x16x32_bf16 v[28:31], v[92:95], v[52:55], v[28:31]
  v_mfma_f32_16x16x32_bf16 v[36:39], v[92:95], v[56:59], v[36:39]
  v_mfma_f32_16x16x32_bf16 v[20:23], v[44:47], v[96:99], v[20:23]
  v_mfma_f32_16x16x32_bf16 v[24:27], v[48:51], v[96:99], v[24:27]
  v_mfma_f32_16x16x32_bf16 v[32:35], v[96:99], v[52:55], v[32:35]
  v_mfma_f32_16x16x32_bf16 v[40:43], v[96:99], v[56:59], v[40:43]
  ds_read_b64_tr_b16 v[44:45], v5 offset:8192
  ds_read_b64_tr_b16 v[46:47], v5 offset:8448
  ds_read_b64_tr_b16 v[48:49], v5 offset:8224
  ds_read_b64_tr_b16 v[50:51], v5 offset:8480
  ds_read_b64_tr_b16 v[52:53], v6 offset:8192
  ds_read_b64_tr_b16 v[54:55], v6 offset:8448
  ds_read_b64_tr_b16 v[56:57], v6 offset:8224
  ds_read_b64_tr_b16 v[58:59], v6 offset:8480
  s_waitcnt lgkmcnt(8)
  v_mfma_f32_16x16x32_bf16 v[12:15], v[60:63], v[100:103], v[12:15]
  v_mfma_f32_16x16x32_bf16 v[16:19], v[64:67], v[100:103], v[16:19]
  v_mfma_f32_16x16x32_bf16 v[28:31], v[100:103], v[68:71], v[28:31]
  v_mfma_f32_16x16x32_bf16 v[36:39], v[100:103], v[72:75], v[36:39]
  v_mfma_f32_16x16x32_bf16 v[20:23], v[60:63], v[104:107], v[20:23]
  v_mfma_f32_16x16x32_bf16 v[24:27], v[64:67], v[104:107], v[24:27]
  v_mfma_f32_16x16x32_bf16 v[32:35], v[104:107], v[68:71], v[32:35]
  v_mfma_f32_16x16x32_bf16 v[40:43], v[104:107], v[72:75], v[40:43]
  ds_read_b64_tr_b16 v[60:61], v5 offset:10240
  ds_read_b64_tr_b16 v[62:63], v5 offset:10496
  ds_read_b64_tr_b16 v[64:65], v5 offset:10272
  ds_read_b64_tr_b16 v[66:67], v5 offset:10528
  ds_read_b64_tr_b16 v[68:69], v6 offset:10240
  ds_read_b64_tr_b16 v[70:71], v6 offset:10496
  ds_read_b64_tr_b16 v[72:73], v6 offset:10272
  ds_read_b64_tr_b16 v[74:75], v6 offset:10528
  s_waitcnt lgkmcnt(8)
  v_mfma_f32_16x16x32_bf16 v[12:15], v[44:47], v[108:111], v[12:15]
  v_mfma_f32_16x16x32_bf16 v[16:19], v[48:51], v[108:111], v[16:19]
  v_mfma_f32_16x16x32_bf16 v[28:31], v[108:111], v[52:55], v[28:31]
  v_mfma_f32_16x16x32_bf16 v[36:39], v[108:111], v[56:59], v[36:39]
  v_mfma_f32_16x16x32_bf16 v[20:23], v[44:47], v[112:115], v[20:23]
  v_mfma_f32_16x16x32_bf16 v[24:27], v[48:51], v[112:115], v[24:27]
  v_mfma_f32_16x16x32_bf16 v[32:35], v[112:115], v[52:55], v[32:35]
  v_mfma_f32_16x16x32_bf16 v[40:43], v[112:115], v[56:59], v[40:43]
  ds_read_b64_tr_b16 v[44:45], v5 offset:12288
  ds_read_b64_tr_b16 v[46:47], v5 offset:12544
  ds_read_b64_tr_b16 v[48:49], v5 offset:12320
  ds_read_b64_tr_b16 v[50:51], v5 offset:12576
  ds_read_b64_tr_b16 v[52:53], v6 offset:12288
  ds_read_b64_tr_b16 v[54:55], v6 offset:12544
  ds_read_b64_tr_b16 v[56:57], v6 offset:12320
  ds_read_b64_tr_b16 v[58:59], v6 offset:12576
  s_waitcnt lgkmcnt(8)
  v_mfma_f32_16x16x32_bf16 v[12:15], v[60:63], v[116:119], v[12:15]
  v_mfma_f32_16x16x32_bf16 v[16:19], v[64:67], v[116:119], v[16:19]
  v_mfma_f32_16x16x32_bf16 v[28:31], v[116:119], v[68:71], v[28:31]
  v_mfma_f32_16x16x32_bf16 v[36:39], v[116:119], v[72:75], v[36:39]
  v_mfma_f32_16x16x32_bf16 v[20:23], v[60:63], v[120:123], v[20:23]
  v_mfma_f32_16x16x32_bf16 v[24:27], v[64:67], v[120:123], v[24:27]
  v_mfma_f32_16x16x32_bf16 v[32:35], v[120:123], v[68:71], v[32:35]
  v_mfma_f32_16x16x32_bf16 v[40:43], v[120:123], v[72:75], v[40:43]
  ds_read_b64_tr_b16 v[60:61], v5 offset:14336
  ds_read_b64_tr_b16 v[62:63], v5 offset:14592
  ds_read_b64_tr_b16 v[64:65], v5 offset:14368
  ds_read_b64_tr_b16 v[66:67], v5 offset:14624
  ds_read_b64_tr_b16 v[68:69], v6 offset:14336
  ds_read_b64_tr_b16 v[70:71], v6 offset:14592
  ds_read_b64_tr_b16 v[72:73], v6 offset:14368
  ds_read_b64_tr_b16 v[74:75], v6 offset:14624
  s_waitcnt lgkmcnt(8)
  v_mfma_f32_16x16x32_bf16 v[12:15], v[44:47], v[124:127], v[12:15]
  v_mfma_f32_16x16x32_bf16 v[16:19], v[48:51], v[124:127], v[16:19]
  v_mfma_f32_16x16x32_bf16 v[28:31], v[124:127], v[52:55], v[28:31]
  v_mfma_f32_16x16x32_bf16 v[36:39], v[124:127], v[56:59], v[36:39]
  v_mfma_f32_16x16x32_bf16 v[20:23], v[44:47], v[128:131], v[20:23]
  v_mfma_f32_16x16x32_bf16 v[24:27], v[48:51], v[128:131], v[24:27]
  v_mfma_f32_16x16x32_bf16 v[32:35], v[128:131], v[52:55], v[32:35]
  v_mfma_f32_16x16x32_bf16 v[40:43], v[128:131], v[56:59], v[40:43]
  ds_read_b64_tr_b16 v[44:45], v5 offset:16384
  ds_read_b64_tr_b16 v[46:47], v5 offset:16640
  ds_read_b64_tr_b16 v[48:49], v5 offset:16416
  ds_read_b64_tr_b16 v[50:51], v5 offset:16672
  ds_read_b64_tr_b16 v[52:53], v6 offset:16384
  ds_read_b64_tr_b16 v[54:55], v6 offset:16640
  ds_read_b64_tr_b16 v[56:57], v6 offset:16416
  ds_read_b64_tr_b16 v[58:59], v6 offset:16672
  s_waitcnt lgkmcnt(8)
  v_mfma_f32_16x16x32_bf16 v[12:15], v[60:63], v[132:135], v[12:15]
  v_mfma_f32_16x16x32_bf16 v[16:19], v[64:67], v[132:135], v[16:19]
  v_mfma_f32_16x16x32_bf16 v[28:31], v[132:135], v[68:71], v[28:31]
  v_mfma_f32_16x16x32_bf16 v[36:39], v[132:135], v[72:75], v[36:39]
  v_mfma_f32_16x16x32_bf16 v[20:23], v[60:63], v[136:139], v[20:23]
  v_mfma_f32_16x16x32_bf16 v[24:27], v[64:67], v[136:139], v[24:27]
  v_mfma_f32_16x16x32_bf16 v[32:35], v[136:139], v[68:71], v[32:35]
  v_mfma_f32_16x16x32_bf16 v[40:43], v[136:139], v[72:75], v[40:43]
  buffer_load_dwordx4 v[76:79], v4, s[44:47], 0 offen offset:1024
  buffer_load_dwordx4 v[80:83], v4, s[44:47], s33 offen offset:1024
  buffer_load_dwordx4 v[84:87], v4, s[44:47], 0 offen offset:1088
  buffer_load_dwordx4 v[88:91], v4, s[44:47], s33 offen offset:1088
  buffer_load_dwordx4 v[92:95], v4, s[44:47], 0 offen offset:1152
  buffer_load_dwordx4 v[96:99], v4, s[44:47], s33 offen offset:1152
  buffer_load_dwordx4 v[100:103], v4, s[44:47], 0 offen offset:1216
  buffer_load_dwordx4 v[104:107], v4, s[44:47], s33 offen offset:1216
  buffer_load_dwordx4 v[108:111], v4, s[44:47], 0 offen offset:1280
  buffer_load_dwordx4 v[112:115], v4, s[44:47], s33 offen offset:1280
  buffer_load_dwordx4 v[116:119], v4, s[44:47], 0 offen offset:1344
  buffer_load_dwordx4 v[120:123], v4, s[44:47], s33 offen offset:1344
  buffer_load_dwordx4 v[124:127], v4, s[44:47], 0 offen offset:1408
  buffer_load_dwordx4 v[128:131], v4, s[44:47], s33 offen offset:1408
  buffer_load_dwordx4 v[132:135], v4, s[44:47], 0 offen offset:1472
  buffer_load_dwordx4 v[136:139], v4, s[44:47], s33 offen offset:1472
  s_waitcnt vmcnt(16)
  ds_read_b64_tr_b16 v[60:61], v5 offset:18432
  ds_read_b64_tr_b16 v[62:63], v5 offset:18688
  ds_read_b64_tr_b16 v[64:65], v5 offset:18464
  ds_read_b64_tr_b16 v[66:67], v5 offset:18720
  ds_read_b64_tr_b16 v[68:69], v6 offset:18432
  ds_read_b64_tr_b16 v[70:71], v6 offset:18688
  ds_read_b64_tr_b16 v[72:73], v6 offset:18464
  ds_read_b64_tr_b16 v[74:75], v6 offset:18720
  s_waitcnt lgkmcnt(8)
  v_mfma_f32_16x16x32_bf16 v[12:15], v[44:47], v[140:143], v[12:15]
  v_mfma_f32_16x16x32_bf16 v[16:19], v[48:51], v[140:143], v[16:19]
  v_mfma_f32_16x16x32_bf16 v[28:31], v[140:143], v[52:55], v[28:31]
  v_mfma_f32_16x16x32_bf16 v[36:39], v[140:143], v[56:59], v[36:39]
  v_mfma_f32_16x16x32_bf16 v[20:23], v[44:47], v[144:147], v[20:23]
  v_mfma_f32_16x16x32_bf16 v[24:27], v[48:51], v[144:147], v[24:27]
  v_mfma_f32_16x16x32_bf16 v[32:35], v[144:147], v[52:55], v[32:35]
  v_mfma_f32_16x16x32_bf16 v[40:43], v[144:147], v[56:59], v[40:43]
  ds_read_b64_tr_b16 v[44:45], v5 offset:20480
  ds_read_b64_tr_b16 v[46:47], v5 offset:20736
  ds_read_b64_tr_b16 v[48:49], v5 offset:20512
  ds_read_b64_tr_b16 v[50:51], v5 offset:20768
  ds_read_b64_tr_b16 v[52:53], v6 offset:20480
  ds_read_b64_tr_b16 v[54:55], v6 offset:20736
  ds_read_b64_tr_b16 v[56:57], v6 offset:20512
  ds_read_b64_tr_b16 v[58:59], v6 offset:20768
  s_waitcnt lgkmcnt(8)
  v_mfma_f32_16x16x32_bf16 v[12:15], v[60:63], v[148:151], v[12:15]
  v_mfma_f32_16x16x32_bf16 v[16:19], v[64:67], v[148:151], v[16:19]
  v_mfma_f32_16x16x32_bf16 v[28:31], v[148:151], v[68:71], v[28:31]
  v_mfma_f32_16x16x32_bf16 v[36:39], v[148:151], v[72:75], v[36:39]
  v_mfma_f32_16x16x32_bf16 v[20:23], v[60:63], v[152:155], v[20:23]
  v_mfma_f32_16x16x32_bf16 v[24:27], v[64:67], v[152:155], v[24:27]
  v_mfma_f32_16x16x32_bf16 v[32:35], v[152:155], v[68:71], v[32:35]
  v_mfma_f32_16x16x32_bf16 v[40:43], v[152:155], v[72:75], v[40:43]
  ds_read_b64_tr_b16 v[60:61], v5 offset:22528
  ds_read_b64_tr_b16 v[62:63], v5 offset:22784
  ds_read_b64_tr_b16 v[64:65], v5 offset:22560
  ds_read_b64_tr_b16 v[66:67], v5 offset:22816
  ds_read_b64_tr_b16 v[68:69], v6 offset:22528
  ds_read_b64_tr_b16 v[70:71], v6 offset:22784
  ds_read_b64_tr_b16 v[72:73], v6 offset:22560
  ds_read_b64_tr_b16 v[74:75], v6 offset:22816
  s_waitcnt lgkmcnt(8)
  v_mfma_f32_16x16x32_bf16 v[12:15], v[44:47], v[156:159], v[12:15]
  v_mfma_f32_16x16x32_bf16 v[16:19], v[48:51], v[156:159], v[16:19]
  v_mfma_f32_16x16x32_bf16 v[28:31], v[156:159], v[52:55], v[28:31]
  v_mfma_f32_16x16x32_bf16 v[36:39], v[156:159], v[56:59], v[36:39]
  v_mfma_f32_16x16x32_bf16 v[20:23], v[44:47], v[160:163], v[20:23]
  v_mfma_f32_16x16x32_bf16 v[24:27], v[48:51], v[160:163], v[24:27]
  v_mfma_f32_16x16x32_bf16 v[32:35], v[160:163], v[52:55], v[32:35]
  v_mfma_f32_16x16x32_bf16 v[40:43], v[160:163], v[56:59], v[40:43]
  ds_read_b64_tr_b16 v[44:45], v5 offset:24576
  ds_read_b64_tr_b16 v[46:47], v5 offset:24832
  ds_read_b64_tr_b16 v[48:49], v5 offset:24608
  ds_read_b64_tr_b16 v[50:51], v5 offset:24864
  ds_read_b64_tr_b16 v[52:53], v6 offset:24576
  ds_read_b64_tr_b16 v[54:55], v6 offset:24832
  ds_read_b64_tr_b16 v[56:57], v6 offset:24608
  ds_read_b64_tr_b16 v[58:59], v6 offset:24864
  s_waitcnt lgkmcnt(8)
  v_mfma_f32_16x16x32_bf16 v[12:15], v[60:63], v[164:167], v[12:15]
  v_mfma_f32_16x16x32_bf16 v[16:19], v[64:67], v[164:167], v[16:19]
  v_mfma_f32_16x16x32_bf16 v[28:31], v[164:167], v[68:71], v[28:31]
  v_mfma_f32_16x16x32_bf16 v[36:39], v[164:167], v[72:75], v[36:39]
  v_mfma_f32_16x16x32_bf16 v[20:23], v[60:63], v[168:171], v[20:23]
  v_mfma_f32_16x16x32_bf16 v[24:27], v[64:67], v[168:171], v[24:27]
  v_mfma_f32_16x16x32_bf16 v[32:35], v[168:171], v[68:71], v[32:35]
  v_mfma_f32_16x16x32_bf16 v[40:43], v[168:171], v[72:75], v[40:43]
  ds_read_b64_tr_b16 v[60:61], v5 offset:26624
  ds_read_b64_tr_b16 v[62:63], v5 offset:26880
  ds_read_b64_tr_b16 v[64:65], v5 offset:26656
  ds_read_b64_tr_b16 v[66:67], v5 offset:26912
  ds_read_b64_tr_b16 v[68:69], v6 offset:26624
  ds_read_b64_tr_b16 v[70:71], v6 offset:26880
  ds_read_b64_tr_b16 v[72:73], v6 offset:26656
  ds_read_b64_tr_b16 v[74:75], v6 offset:26912
  s_waitcnt lgkmcnt(8)
  v_mfma_f32_16x16x32_bf16 v[12:15], v[44:47], v[172:175], v[12:15]
  v_mfma_f32_16x16x32_bf16 v[16:19], v[48:51], v[172:175], v[16:19]
  v_mfma_f32_16x16x32_bf16 v[28:31], v[172:175], v[52:55], v[28:31]
  v_mfma_f32_16x16x32_bf16 v[36:39], v[172:175], v[56:59], v[36:39]
  v_mfma_f32_16x16x32_bf16 v[20:23], v[44:47], v[176:179], v[20:23]
  v_mfma_f32_16x16x32_bf16 v[24:27], v[48:51], v[176:179], v[24:27]
  v_mfma_f32_16x16x32_bf16 v[32:35], v[176:179], v[52:55], v[32:35]
  v_mfma_f32_16x16x32_bf16 v[40:43], v[176:179], v[56:59], v[40:43]
  ds_read_b64_tr_b16 v[44:45], v5 offset:28672
  ds_read_b64_tr_b16 v[46:47], v5 offset:28928
  ds_read_b64_tr_b16 v[48:49], v5 offset:28704
  ds_read_b64_tr_b16 v[50:51], v5 offset:28960
  ds_read_b64_tr_b16 v[52:53], v6 offset:28672
  ds_read_b64_tr_b16 v[54:55], v6 offset:28928
  ds_read_b64_tr_b16 v[56:57], v6 offset:28704
  ds_read_b64_tr_b16 v[58:59], v6 offset:28960
  s_waitcnt lgkmcnt(8)
  v_mfma_f32_16x16x32_bf16 v[12:15], v[60:63], v[180:183], v[12:15]
  v_mfma_f32_16x16x32_bf16 v[16:19], v[64:67], v[180:183], v[16:19]
  v_mfma_f32_16x16x32_bf16 v[28:31], v[180:183], v[68:71], v[28:31]
  v_mfma_f32_16x16x32_bf16 v[36:39], v[180:183], v[72:75], v[36:39]
  v_mfma_f32_16x16x32_bf16 v[20:23], v[60:63], v[184:187], v[20:23]
  v_mfma_f32_16x16x32_bf16 v[24:27], v[64:67], v[184:187], v[24:27]
  v_mfma_f32_16x16x32_bf16 v[32:35], v[184:187], v[68:71], v[32:35]
  v_mfma_f32_16x16x32_bf16 v[40:43], v[184:187], v[72:75], v[40:43]
  ds_read_b64_tr_b16 v[60:61], v5 offset:30720
  ds_read_b64_tr_b16 v[62:63], v5 offset:30976
  ds_read_b64_tr_b16 v[64:65], v5 offset:30752
  ds_read_b64_tr_b16 v[66:67], v5 offset:31008
  ds_read_b64_tr_b16 v[68:69], v6 offset:30720
  ds_read_b64_tr_b16 v[70:71], v6 offset:30976
  ds_read_b64_tr_b16 v[72:73], v6 offset:30752
  ds_read_b64_tr_b16 v[74:75], v6 offset:31008
  s_waitcnt lgkmcnt(8)
  v_mfma_f32_16x16x32_bf16 v[12:15], v[44:47], v[188:191], v[12:15]
  v_mfma_f32_16x16x32_bf16 v[16:19], v[48:51], v[188:191], v[16:19]
  v_mfma_f32_16x16x32_bf16 v[28:31], v[188:191], v[52:55], v[28:31]
  v_mfma_f32_16x16x32_bf16 v[36:39], v[188:191], v[56:59], v[36:39]
  v_mfma_f32_16x16x32_bf16 v[20:23], v[44:47], v[192:195], v[20:23]
  v_mfma_f32_16x16x32_bf16 v[24:27], v[48:51], v[192:195], v[24:27]
  v_mfma_f32_16x16x32_bf16 v[32:35], v[192:195], v[52:55], v[32:35]
  v_mfma_f32_16x16x32_bf16 v[40:43], v[192:195], v[56:59], v[40:43]
  ds_read_b64_tr_b16 v[44:45], v5 offset:32768
  ds_read_b64_tr_b16 v[46:47], v5 offset:33024
  ds_read_b64_tr_b16 v[48:49], v5 offset:32800
  ds_read_b64_tr_b16 v[50:51], v5 offset:33056
  ds_read_b64_tr_b16 v[52:53], v6 offset:32768
  ds_read_b64_tr_b16 v[54:55], v6 offset:33024
  ds_read_b64_tr_b16 v[56:57], v6 offset:32800
  ds_read_b64_tr_b16 v[58:59], v6 offset:33056
  s_waitcnt lgkmcnt(8)
  v_mfma_f32_16x16x32_bf16 v[12:15], v[60:63], v[196:199], v[12:15]
  v_mfma_f32_16x16x32_bf16 v[16:19], v[64:67], v[196:199], v[16:19]
  v_mfma_f32_16x16x32_bf16 v[28:31], v[196:199], v[68:71], v[28:31]
  v_mfma_f32_16x16x32_bf16 v[36:39], v[196:199], v[72:75], v[36:39]
  v_mfma_f32_16x16x32_bf16 v[20:23], v[60:63], v[200:203], v[20:23]
  v_mfma_f32_16x16x32_bf16 v[24:27], v[64:67], v[200:203], v[24:27]
  v_mfma_f32_16x16x32_bf16 v[32:35], v[200:203], v[68:71], v[32:35]
  v_mfma_f32_16x16x32_bf16 v[40:43], v[200:203], v[72:75], v[40:43]
  buffer_load_dwordx4 v[140:143], v4, s[44:47], 0 offen offset:1536
  buffer_load_dwordx4 v[144:147], v4, s[44:47], s33 offen offset:1536
  buffer_load_dwordx4 v[148:151], v4, s[44:47], 0 offen offset:1600
  buffer_load_dwordx4 v[152:155], v4, s[44:47], s33 offen offset:1600
  buffer_load_dwordx4 v[156:159], v4, s[44:47], 0 offen offset:1664
  buffer_load_dwordx4 v[160:163], v4, s[44:47], s33 offen offset:1664
  buffer_load_dwordx4 v[164:167], v4, s[44:47], 0 offen offset:1728
  buffer_load_dwordx4 v[168:171], v4, s[44:47], s33 offen offset:1728
  buffer_load_dwordx4 v[172:175], v4, s[44:47], 0 offen offset:1792
  buffer_load_dwordx4 v[176:179], v4, s[44:47], s33 offen offset:1792
  buffer_load_dwordx4 v[180:183], v4, s[44:47], 0 offen offset:1856
  buffer_load_dwordx4 v[184:187], v4, s[44:47], s33 offen offset:1856
  buffer_load_dwordx4 v[188:191], v4, s[44:47], 0 offen offset:1920
  buffer_load_dwordx4 v[192:195], v4, s[44:47], s33 offen offset:1920
  buffer_load_dwordx4 v[196:199], v4, s[44:47], 0 offen offset:1984
  buffer_load_dwordx4 v[200:203], v4, s[44:47], s33 offen offset:1984
  s_waitcnt vmcnt(16)
  ds_read_b64_tr_b16 v[60:61], v5 offset:34816
  ds_read_b64_tr_b16 v[62:63], v5 offset:35072
  ds_read_b64_tr_b16 v[64:65], v5 offset:34848
  ds_read_b64_tr_b16 v[66:67], v5 offset:35104
  ds_read_b64_tr_b16 v[68:69], v6 offset:34816
  ds_read_b64_tr_b16 v[70:71], v6 offset:35072
  ds_read_b64_tr_b16 v[72:73], v6 offset:34848
  ds_read_b64_tr_b16 v[74:75], v6 offset:35104
  s_waitcnt lgkmcnt(8)
  v_mfma_f32_16x16x32_bf16 v[12:15], v[44:47], v[76:79], v[12:15]
  v_mfma_f32_16x16x32_bf16 v[16:19], v[48:51], v[76:79], v[16:19]
  v_mfma_f32_16x16x32_bf16 v[28:31], v[76:79], v[52:55], v[28:31]
  v_mfma_f32_16x16x32_bf16 v[36:39], v[76:79], v[56:59], v[36:39]
  v_mfma_f32_16x16x32_bf16 v[20:23], v[44:47], v[80:83], v[20:23]
  v_mfma_f32_16x16x32_bf16 v[24:27], v[48:51], v[80:83], v[24:27]
  v_mfma_f32_16x16x32_bf16 v[32:35], v[80:83], v[52:55], v[32:35]
  v_mfma_f32_16x16x32_bf16 v[40:43], v[80:83], v[56:59], v[40:43]
  ds_read_b64_tr_b16 v[44:45], v5 offset:36864
  ds_read_b64_tr_b16 v[46:47], v5 offset:37120
  ds_read_b64_tr_b16 v[48:49], v5 offset:36896
  ds_read_b64_tr_b16 v[50:51], v5 offset:37152
  ds_read_b64_tr_b16 v[52:53], v6 offset:36864
  ds_read_b64_tr_b16 v[54:55], v6 offset:37120
  ds_read_b64_tr_b16 v[56:57], v6 offset:36896
  ds_read_b64_tr_b16 v[58:59], v6 offset:37152
  s_waitcnt lgkmcnt(8)
  v_mfma_f32_16x16x32_bf16 v[12:15], v[60:63], v[84:87], v[12:15]
  v_mfma_f32_16x16x32_bf16 v[16:19], v[64:67], v[84:87], v[16:19]
  v_mfma_f32_16x16x32_bf16 v[28:31], v[84:87], v[68:71], v[28:31]
  v_mfma_f32_16x16x32_bf16 v[36:39], v[84:87], v[72:75], v[36:39]
  v_mfma_f32_16x16x32_bf16 v[20:23], v[60:63], v[88:91], v[20:23]
  v_mfma_f32_16x16x32_bf16 v[24:27], v[64:67], v[88:91], v[24:27]
  v_mfma_f32_16x16x32_bf16 v[32:35], v[88:91], v[68:71], v[32:35]
  v_mfma_f32_16x16x32_bf16 v[40:43], v[88:91], v[72:75], v[40:43]
  ds_read_b64_tr_b16 v[60:61], v5 offset:38912
  ds_read_b64_tr_b16 v[62:63], v5 offset:39168
  ds_read_b64_tr_b16 v[64:65], v5 offset:38944
  ds_read_b64_tr_b16 v[66:67], v5 offset:39200
  ds_read_b64_tr_b16 v[68:69], v6 offset:38912
  ds_read_b64_tr_b16 v[70:71], v6 offset:39168
  ds_read_b64_tr_b16 v[72:73], v6 offset:38944
  ds_read_b64_tr_b16 v[74:75], v6 offset:39200
  s_waitcnt lgkmcnt(8)
  v_mfma_f32_16x16x32_bf16 v[12:15], v[44:47], v[92:95], v[12:15]
  v_mfma_f32_16x16x32_bf16 v[16:19], v[48:51], v[92:95], v[16:19]
  v_mfma_f32_16x16x32_bf16 v[28:31], v[92:95], v[52:55], v[28:31]
  v_mfma_f32_16x16x32_bf16 v[36:39], v[92:95], v[56:59], v[36:39]
  v_mfma_f32_16x16x32_bf16 v[20:23], v[44:47], v[96:99], v[20:23]
  v_mfma_f32_16x16x32_bf16 v[24:27], v[48:51], v[96:99], v[24:27]
  v_mfma_f32_16x16x32_bf16 v[32:35], v[96:99], v[52:55], v[32:35]
  v_mfma_f32_16x16x32_bf16 v[40:43], v[96:99], v[56:59], v[40:43]
  ds_read_b64_tr_b16 v[44:45], v5 offset:40960
  ds_read_b64_tr_b16 v[46:47], v5 offset:41216
  ds_read_b64_tr_b16 v[48:49], v5 offset:40992
  ds_read_b64_tr_b16 v[50:51], v5 offset:41248
  ds_read_b64_tr_b16 v[52:53], v6 offset:40960
  ds_read_b64_tr_b16 v[54:55], v6 offset:41216
  ds_read_b64_tr_b16 v[56:57], v6 offset:40992
  ds_read_b64_tr_b16 v[58:59], v6 offset:41248
  s_waitcnt lgkmcnt(8)
  v_mfma_f32_16x16x32_bf16 v[12:15], v[60:63], v[100:103], v[12:15]
  v_mfma_f32_16x16x32_bf16 v[16:19], v[64:67], v[100:103], v[16:19]
  v_mfma_f32_16x16x32_bf16 v[28:31], v[100:103], v[68:71], v[28:31]
  v_mfma_f32_16x16x32_bf16 v[36:39], v[100:103], v[72:75], v[36:39]
  v_mfma_f32_16x16x32_bf16 v[20:23], v[60:63], v[104:107], v[20:23]
  v_mfma_f32_16x16x32_bf16 v[24:27], v[64:67], v[104:107], v[24:27]
  v_mfma_f32_16x16x32_bf16 v[32:35], v[104:107], v[68:71], v[32:35]
  v_mfma_f32_16x16x32_bf16 v[40:43], v[104:107], v[72:75], v[40:43]
  ds_read_b64_tr_b16 v[60:61], v5 offset:43008
  ds_read_b64_tr_b16 v[62:63], v5 offset:43264
  ds_read_b64_tr_b16 v[64:65], v5 offset:43040
  ds_read_b64_tr_b16 v[66:67], v5 offset:43296
  ds_read_b64_tr_b16 v[68:69], v6 offset:43008
  ds_read_b64_tr_b16 v[70:71], v6 offset:43264
  ds_read_b64_tr_b16 v[72:73], v6 offset:43040
  ds_read_b64_tr_b16 v[74:75], v6 offset:43296
  s_waitcnt lgkmcnt(8)
  v_mfma_f32_16x16x32_bf16 v[12:15], v[44:47], v[108:111], v[12:15]
  v_mfma_f32_16x16x32_bf16 v[16:19], v[48:51], v[108:111], v[16:19]
  v_mfma_f32_16x16x32_bf16 v[28:31], v[108:111], v[52:55], v[28:31]
  v_mfma_f32_16x16x32_bf16 v[36:39], v[108:111], v[56:59], v[36:39]
  v_mfma_f32_16x16x32_bf16 v[20:23], v[44:47], v[112:115], v[20:23]
  v_mfma_f32_16x16x32_bf16 v[24:27], v[48:51], v[112:115], v[24:27]
  v_mfma_f32_16x16x32_bf16 v[32:35], v[112:115], v[52:55], v[32:35]
  v_mfma_f32_16x16x32_bf16 v[40:43], v[112:115], v[56:59], v[40:43]
  ds_read_b64_tr_b16 v[44:45], v5 offset:45056
  ds_read_b64_tr_b16 v[46:47], v5 offset:45312
  ds_read_b64_tr_b16 v[48:49], v5 offset:45088
  ds_read_b64_tr_b16 v[50:51], v5 offset:45344
  ds_read_b64_tr_b16 v[52:53], v6 offset:45056
  ds_read_b64_tr_b16 v[54:55], v6 offset:45312
  ds_read_b64_tr_b16 v[56:57], v6 offset:45088
  ds_read_b64_tr_b16 v[58:59], v6 offset:45344
  s_waitcnt lgkmcnt(8)
  v_mfma_f32_16x16x32_bf16 v[12:15], v[60:63], v[116:119], v[12:15]
  v_mfma_f32_16x16x32_bf16 v[16:19], v[64:67], v[116:119], v[16:19]
  v_mfma_f32_16x16x32_bf16 v[28:31], v[116:119], v[68:71], v[28:31]
  v_mfma_f32_16x16x32_bf16 v[36:39], v[116:119], v[72:75], v[36:39]
  v_mfma_f32_16x16x32_bf16 v[20:23], v[60:63], v[120:123], v[20:23]
  v_mfma_f32_16x16x32_bf16 v[24:27], v[64:67], v[120:123], v[24:27]
  v_mfma_f32_16x16x32_bf16 v[32:35], v[120:123], v[68:71], v[32:35]
  v_mfma_f32_16x16x32_bf16 v[40:43], v[120:123], v[72:75], v[40:43]
  ds_read_b64_tr_b16 v[60:61], v5 offset:47104
  ds_read_b64_tr_b16 v[62:63], v5 offset:47360
  ds_read_b64_tr_b16 v[64:65], v5 offset:47136
  ds_read_b64_tr_b16 v[66:67], v5 offset:47392
  ds_read_b64_tr_b16 v[68:69], v6 offset:47104
  ds_read_b64_tr_b16 v[70:71], v6 offset:47360
  ds_read_b64_tr_b16 v[72:73], v6 offset:47136
  ds_read_b64_tr_b16 v[74:75], v6 offset:47392
  s_waitcnt lgkmcnt(8)
  v_mfma_f32_16x16x32_bf16 v[12:15], v[44:47], v[124:127], v[12:15]
  v_mfma_f32_16x16x32_bf16 v[16:19], v[48:51], v[124:127], v[16:19]
  v_mfma_f32_16x16x32_bf16 v[28:31], v[124:127], v[52:55], v[28:31]
  v_mfma_f32_16x16x32_bf16 v[36:39], v[124:127], v[56:59], v[36:39]
  v_mfma_f32_16x16x32_bf16 v[20:23], v[44:47], v[128:131], v[20:23]
  v_mfma_f32_16x16x32_bf16 v[24:27], v[48:51], v[128:131], v[24:27]
  v_mfma_f32_16x16x32_bf16 v[32:35], v[128:131], v[52:55], v[32:35]
  v_mfma_f32_16x16x32_bf16 v[40:43], v[128:131], v[56:59], v[40:43]
  ds_read_b64_tr_b16 v[44:45], v5 offset:49152
  ds_read_b64_tr_b16 v[46:47], v5 offset:49408
  ds_read_b64_tr_b16 v[48:49], v5 offset:49184
  ds_read_b64_tr_b16 v[50:51], v5 offset:49440
  ds_read_b64_tr_b16 v[52:53], v6 offset:49152
  ds_read_b64_tr_b16 v[54:55], v6 offset:49408
  ds_read_b64_tr_b16 v[56:57], v6 offset:49184
  ds_read_b64_tr_b16 v[58:59], v6 offset:49440
  s_waitcnt lgkmcnt(8)
  v_mfma_f32_16x16x32_bf16 v[12:15], v[60:63], v[132:135], v[12:15]
  v_mfma_f32_16x16x32_bf16 v[16:19], v[64:67], v[132:135], v[16:19]
  v_mfma_f32_16x16x32_bf16 v[28:31], v[132:135], v[68:71], v[28:31]
  v_mfma_f32_16x16x32_bf16 v[36:39], v[132:135], v[72:75], v[36:39]
  v_mfma_f32_16x16x32_bf16 v[20:23], v[60:63], v[136:139], v[20:23]
  v_mfma_f32_16x16x32_bf16 v[24:27], v[64:67], v[136:139], v[24:27]
  v_mfma_f32_16x16x32_bf16 v[32:35], v[136:139], v[68:71], v[32:35]
  v_mfma_f32_16x16x32_bf16 v[40:43], v[136:139], v[72:75], v[40:43]
  s_waitcnt vmcnt(0)
  ds_read_b64_tr_b16 v[60:61], v5 offset:51200
  ds_read_b64_tr_b16 v[62:63], v5 offset:51456
  ds_read_b64_tr_b16 v[64:65], v5 offset:51232
  ds_read_b64_tr_b16 v[66:67], v5 offset:51488
  ds_read_b64_tr_b16 v[68:69], v6 offset:51200
  ds_read_b64_tr_b16 v[70:71], v6 offset:51456
  ds_read_b64_tr_b16 v[72:73], v6 offset:51232
  ds_read_b64_tr_b16 v[74:75], v6 offset:51488
  s_waitcnt lgkmcnt(8)
  v_mfma_f32_16x16x32_bf16 v[12:15], v[44:47], v[140:143], v[12:15]
  v_mfma_f32_16x16x32_bf16 v[16:19], v[48:51], v[140:143], v[16:19]
  v_mfma_f32_16x16x32_bf16 v[28:31], v[140:143], v[52:55], v[28:31]
  v_mfma_f32_16x16x32_bf16 v[36:39], v[140:143], v[56:59], v[36:39]
  v_mfma_f32_16x16x32_bf16 v[20:23], v[44:47], v[144:147], v[20:23]
  v_mfma_f32_16x16x32_bf16 v[24:27], v[48:51], v[144:147], v[24:27]
  v_mfma_f32_16x16x32_bf16 v[32:35], v[144:147], v[52:55], v[32:35]
  v_mfma_f32_16x16x32_bf16 v[40:43], v[144:147], v[56:59], v[40:43]
  ds_read_b64_tr_b16 v[44:45], v5 offset:53248
  ds_read_b64_tr_b16 v[46:47], v5 offset:53504
  ds_read_b64_tr_b16 v[48:49], v5 offset:53280
  ds_read_b64_tr_b16 v[50:51], v5 offset:53536
  ds_read_b64_tr_b16 v[52:53], v6 offset:53248
  ds_read_b64_tr_b16 v[54:55], v6 offset:53504
  ds_read_b64_tr_b16 v[56:57], v6 offset:53280
  ds_read_b64_tr_b16 v[58:59], v6 offset:53536
  s_waitcnt lgkmcnt(8)
  v_mfma_f32_16x16x32_bf16 v[12:15], v[60:63], v[148:151], v[12:15]
  v_mfma_f32_16x16x32_bf16 v[16:19], v[64:67], v[148:151], v[16:19]
  v_mfma_f32_16x16x32_bf16 v[28:31], v[148:151], v[68:71], v[28:31]
  v_mfma_f32_16x16x32_bf16 v[36:39], v[148:151], v[72:75], v[36:39]
  v_mfma_f32_16x16x32_bf16 v[20:23], v[60:63], v[152:155], v[20:23]
  v_mfma_f32_16x16x32_bf16 v[24:27], v[64:67], v[152:155], v[24:27]
  v_mfma_f32_16x16x32_bf16 v[32:35], v[152:155], v[68:71], v[32:35]
  v_mfma_f32_16x16x32_bf16 v[40:43], v[152:155], v[72:75], v[40:43]
  ds_read_b64_tr_b16 v[60:61], v5 offset:55296
  ds_read_b64_tr_b16 v[62:63], v5 offset:55552
  ds_read_b64_tr_b16 v[64:65], v5 offset:55328
  ds_read_b64_tr_b16 v[66:67], v5 offset:55584
  ds_read_b64_tr_b16 v[68:69], v6 offset:55296
  ds_read_b64_tr_b16 v[70:71], v6 offset:55552
  ds_read_b64_tr_b16 v[72:73], v6 offset:55328
  ds_read_b64_tr_b16 v[74:75], v6 offset:55584
  s_waitcnt lgkmcnt(8)
  v_mfma_f32_16x16x32_bf16 v[12:15], v[44:47], v[156:159], v[12:15]
  v_mfma_f32_16x16x32_bf16 v[16:19], v[48:51], v[156:159], v[16:19]
  v_mfma_f32_16x16x32_bf16 v[28:31], v[156:159], v[52:55], v[28:31]
  v_mfma_f32_16x16x32_bf16 v[36:39], v[156:159], v[56:59], v[36:39]
  v_mfma_f32_16x16x32_bf16 v[20:23], v[44:47], v[160:163], v[20:23]
  v_mfma_f32_16x16x32_bf16 v[24:27], v[48:51], v[160:163], v[24:27]
  v_mfma_f32_16x16x32_bf16 v[32:35], v[160:163], v[52:55], v[32:35]
  v_mfma_f32_16x16x32_bf16 v[40:43], v[160:163], v[56:59], v[40:43]
  ds_read_b64_tr_b16 v[44:45], v5 offset:57344
  ds_read_b64_tr_b16 v[46:47], v5 offset:57600
  ds_read_b64_tr_b16 v[48:49], v5 offset:57376
  ds_read_b64_tr_b16 v[50:51], v5 offset:57632
  ds_read_b64_tr_b16 v[52:53], v6 offset:57344
  ds_read_b64_tr_b16 v[54:55], v6 offset:57600
  ds_read_b64_tr_b16 v[56:57], v6 offset:57376
  ds_read_b64_tr_b16 v[58:59], v6 offset:57632
  s_waitcnt lgkmcnt(8)
  v_mfma_f32_16x16x32_bf16 v[12:15], v[60:63], v[164:167], v[12:15]
  v_mfma_f32_16x16x32_bf16 v[16:19], v[64:67], v[164:167], v[16:19]
  v_mfma_f32_16x16x32_bf16 v[28:31], v[164:167], v[68:71], v[28:31]
  v_mfma_f32_16x16x32_bf16 v[36:39], v[164:167], v[72:75], v[36:39]
  v_mfma_f32_16x16x32_bf16 v[20:23], v[60:63], v[168:171], v[20:23]
  v_mfma_f32_16x16x32_bf16 v[24:27], v[64:67], v[168:171], v[24:27]
  v_mfma_f32_16x16x32_bf16 v[32:35], v[168:171], v[68:71], v[32:35]
  v_mfma_f32_16x16x32_bf16 v[40:43], v[168:171], v[72:75], v[40:43]
  ds_read_b64_tr_b16 v[60:61], v5 offset:59392
  ds_read_b64_tr_b16 v[62:63], v5 offset:59648
  ds_read_b64_tr_b16 v[64:65], v5 offset:59424
  ds_read_b64_tr_b16 v[66:67], v5 offset:59680
  ds_read_b64_tr_b16 v[68:69], v6 offset:59392
  ds_read_b64_tr_b16 v[70:71], v6 offset:59648
  ds_read_b64_tr_b16 v[72:73], v6 offset:59424
  ds_read_b64_tr_b16 v[74:75], v6 offset:59680
  s_waitcnt lgkmcnt(8)
  v_mfma_f32_16x16x32_bf16 v[12:15], v[44:47], v[172:175], v[12:15]
  v_mfma_f32_16x16x32_bf16 v[16:19], v[48:51], v[172:175], v[16:19]
  v_mfma_f32_16x16x32_bf16 v[28:31], v[172:175], v[52:55], v[28:31]
  v_mfma_f32_16x16x32_bf16 v[36:39], v[172:175], v[56:59], v[36:39]
  v_mfma_f32_16x16x32_bf16 v[20:23], v[44:47], v[176:179], v[20:23]
  v_mfma_f32_16x16x32_bf16 v[24:27], v[48:51], v[176:179], v[24:27]
  v_mfma_f32_16x16x32_bf16 v[32:35], v[176:179], v[52:55], v[32:35]
  v_mfma_f32_16x16x32_bf16 v[40:43], v[176:179], v[56:59], v[40:43]
  ds_read_b64_tr_b16 v[44:45], v5 offset:61440
  ds_read_b64_tr_b16 v[46:47], v5 offset:61696
  ds_read_b64_tr_b16 v[48:49], v5 offset:61472
  ds_read_b64_tr_b16 v[50:51], v5 offset:61728
  ds_read_b64_tr_b16 v[52:53], v6 offset:61440
  ds_read_b64_tr_b16 v[54:55], v6 offset:61696
  ds_read_b64_tr_b16 v[56:57], v6 offset:61472
  ds_read_b64_tr_b16 v[58:59], v6 offset:61728
  s_waitcnt lgkmcnt(8)
  v_mfma_f32_16x16x32_bf16 v[12:15], v[60:63], v[180:183], v[12:15]
  v_mfma_f32_16x16x32_bf16 v[16:19], v[64:67], v[180:183], v[16:19]
  v_mfma_f32_16x16x32_bf16 v[28:31], v[180:183], v[68:71], v[28:31]
  v_mfma_f32_16x16x32_bf16 v[36:39], v[180:183], v[72:75], v[36:39]
  v_mfma_f32_16x16x32_bf16 v[20:23], v[60:63], v[184:187], v[20:23]
  v_mfma_f32_16x16x32_bf16 v[24:27], v[64:67], v[184:187], v[24:27]
  v_mfma_f32_16x16x32_bf16 v[32:35], v[184:187], v[68:71], v[32:35]
  v_mfma_f32_16x16x32_bf16 v[40:43], v[184:187], v[72:75], v[40:43]
  ds_read_b64_tr_b16 v[60:61], v5 offset:63488
  ds_read_b64_tr_b16 v[62:63], v5 offset:63744
  ds_read_b64_tr_b16 v[64:65], v5 offset:63520
  ds_read_b64_tr_b16 v[66:67], v5 offset:63776
  ds_read_b64_tr_b16 v[68:69], v6 offset:63488
  ds_read_b64_tr_b16 v[70:71], v6 offset:63744
  ds_read_b64_tr_b16 v[72:73], v6 offset:63520
  ds_read_b64_tr_b16 v[74:75], v6 offset:63776
  s_waitcnt lgkmcnt(8)
  v_mfma_f32_16x16x32_bf16 v[12:15], v[44:47], v[188:191], v[12:15]
  v_mfma_f32_16x16x32_bf16 v[16:19], v[48:51], v[188:191], v[16:19]
  v_mfma_f32_16x16x32_bf16 v[28:31], v[188:191], v[52:55], v[28:31]
  v_mfma_f32_16x16x32_bf16 v[36:39], v[188:191], v[56:59], v[36:39]
  v_mfma_f32_16x16x32_bf16 v[20:23], v[44:47], v[192:195], v[20:23]
  v_mfma_f32_16x16x32_bf16 v[24:27], v[48:51], v[192:195], v[24:27]
  v_mfma_f32_16x16x32_bf16 v[32:35], v[192:195], v[52:55], v[32:35]
  v_mfma_f32_16x16x32_bf16 v[40:43], v[192:195], v[56:59], v[40:43]
  s_waitcnt lgkmcnt(0)
  v_mfma_f32_16x16x32_bf16 v[12:15], v[60:63], v[196:199], v[12:15]
  v_mfma_f32_16x16x32_bf16 v[16:19], v[64:67], v[196:199], v[16:19]
  v_mfma_f32_16x16x32_bf16 v[28:31], v[196:199], v[68:71], v[28:31]
  v_mfma_f32_16x16x32_bf16 v[36:39], v[196:199], v[72:75], v[36:39]
  v_mfma_f32_16x16x32_bf16 v[20:23], v[60:63], v[200:203], v[20:23]
  v_mfma_f32_16x16x32_bf16 v[24:27], v[64:67], v[200:203], v[24:27]
  v_mfma_f32_16x16x32_bf16 v[32:35], v[200:203], v[68:71], v[32:35]
  v_mfma_f32_16x16x32_bf16 v[40:43], v[200:203], v[72:75], v[40:43]
  s_barrier
  s_cmp_lg_u32 s20, 0
  s_cbranch_scc1 w_pop_141
  s_mov_b64 exec, 1
  v_mov_b32 v255, 1
  buffer_atomic_add v255, off, s[8:11], s28 sc0 sc1
  s_mov_b64 exec, -1
w_pop_141:
  v_cvt_pk_bf16_f32 v12, v12, v13
  v_cvt_pk_bf16_f32 v13, v14, v15
  v_cvt_pk_bf16_f32 v14, v16, v17
  v_cvt_pk_bf16_f32 v15, v18, v19
  v_cvt_pk_bf16_f32 v20, v20, v21
  v_cvt_pk_bf16_f32 v21, v22, v23
  v_cvt_pk_bf16_f32 v22, v24, v25
  v_cvt_pk_bf16_f32 v23, v26, v27
  v_cvt_pk_bf16_f32 v28, v28, v29
  v_cvt_pk_bf16_f32 v29, v30, v31
  v_cvt_pk_bf16_f32 v30, v32, v33
  v_cvt_pk_bf16_f32 v31, v34, v35
  v_cvt_pk_bf16_f32 v36, v36, v37
  v_cvt_pk_bf16_f32 v37, v38, v39
  v_cvt_pk_bf16_f32 v38, v40, v41
  v_cvt_pk_bf16_f32 v39, v42, v43
  v_permlane16_swap_b32 v12, v14
  v_permlane16_swap_b32 v13, v15
  v_permlane16_swap_b32 v20, v22
  v_permlane16_swap_b32 v21, v23
  v_permlane16_swap_b32 v28, v30
  v_permlane16_swap_b32 v29, v31
  v_permlane16_swap_b32 v36, v38
  v_permlane16_swap_b32 v37, v39
  buffer_store_dwordx4 v[12:15], v7, s[56:59], 0 offen offset:0 sc1
  buffer_store_dwordx4 v[20:23], v7, s[56:59], 0 offen offset:256 sc1
  buffer_store_dwordx4 v[28:31], v8, s[56:59], 0 offen offset:2048 sc1
  buffer_store_dwordx4 v[36:39], v8, s[56:59], 0 offen offset:2112 sc1
  s_branch w_next_87
w_gate_101:
  s_mov_b32 s29, 124789760
  s_mov_b32 s30, 1
  s_lshl_b32 s60, s6, 1
  s_add_u32 s60, s60, s7
  s_lshl_b32 s60, s60, 2
w_gate_1011:
  s_load_dwordx2 s[44:45], s[0:1], 0
  s_load_dwordx2 s[48:49], s[0:1], 96
  s_load_dwordx2 s[52:53], s[0:1], 120
  v_and_b32 v1, 63, v0
  v_lshlrev_b32 v1, 5, v1
  s_waitcnt lgkmcnt(0)
  s_and_b32 s45, s45, 0xffff
  s_mov_b32 s46, 4194304
  s_mov_b32 s47, 0x20000
  s_and_b32 s49, s49, 0xffff
  s_mov_b32 s50, 2048
  s_mov_b32 s51, 0x20000
  s_add_u32 s52, s52, 54788096
  s_addc_u32 s53, s53, 0
  s_and_b32 s53, s53, 0xffff
  s_mov_b32 s54, 16384
  s_mov_b32 s55, 0x20000
  buffer_load_dwordx4 v[8:11], v1, s[48:51], 0 offen
  buffer_load_dwordx4 v[12:15], v1, s[48:51], 0 offen offset:16
  s_lshl_b32 s32, s60, 3
  s_add_u32 s32, s32, s20
  s_lshl_b32 s33, s32, 14
  buffer_load_dwordx4 v[32:35], v1, s[44:47], s33 offen
  buffer_load_dwordx4 v[36:39], v1, s[44:47], s33 offen offset:16
  s_add_u32 s33, s33, 2048
  buffer_load_dwordx4 v[40:43], v1, s[44:47], s33 offen
  buffer_load_dwordx4 v[44:47], v1, s[44:47], s33 offen offset:16
  s_add_u32 s33, s33, 2048
  buffer_load_dwordx4 v[48:51], v1, s[44:47], s33 offen
  buffer_load_dwordx4 v[52:55], v1, s[44:47], s33 offen offset:16
  s_add_u32 s33, s33, 2048
  buffer_load_dwordx4 v[56:59], v1, s[44:47], s33 offen
  buffer_load_dwordx4 v[60:63], v1, s[44:47], s33 offen offset:16
  s_add_u32 s33, s33, 2048
  buffer_load_dwordx4 v[64:67], v1, s[44:47], s33 offen
  buffer_load_dwordx4 v[68:71], v1, s[44:47], s33 offen offset:16
  s_add_u32 s33, s33, 2048
  buffer_load_dwordx4 v[72:75], v1, s[44:47], s33 offen
  buffer_load_dwordx4 v[76:79], v1, s[44:47], s33 offen offset:16
  s_add_u32 s33, s33, 2048
  buffer_load_dwordx4 v[80:83], v1, s[44:47], s33 offen
  buffer_load_dwordx4 v[84:87], v1, s[44:47], s33 offen offset:16
  s_add_u32 s33, s33, 2048
  buffer_load_dwordx4 v[88:91], v1, s[44:47], s33 offen
  buffer_load_dwordx4 v[92:95], v1, s[44:47], s33 offen offset:16
  s_add_u32 s33, s33, 2048
  s_waitcnt vmcnt(16)
  v_lshlrev_b32 v16, 16, v8
  v_and_b32 v17, 0xffff0000, v8
  v_lshlrev_b32 v18, 16, v9
  v_and_b32 v19, 0xffff0000, v9
  v_lshlrev_b32 v20, 16, v10
  v_and_b32 v21, 0xffff0000, v10
  v_lshlrev_b32 v22, 16, v11
  v_and_b32 v23, 0xffff0000, v11
  v_lshlrev_b32 v24, 16, v12
  v_and_b32 v25, 0xffff0000, v12
  v_lshlrev_b32 v26, 16, v13
  v_and_b32 v27, 0xffff0000, v13
  v_lshlrev_b32 v28, 16, v14
  v_and_b32 v29, 0xffff0000, v14
  v_lshlrev_b32 v30, 16, v15
  v_and_b32 v31, 0xffff0000, v15
  s_waitcnt vmcnt(14)
  v_lshlrev_b32 v112, 16, v32
  v_and_b32 v113, 0xffff0000, v32
  v_lshlrev_b32 v114, 16, v33
  v_and_b32 v115, 0xffff0000, v33
  v_lshlrev_b32 v116, 16, v34
  v_and_b32 v117, 0xffff0000, v34
  v_lshlrev_b32 v118, 16, v35
  v_and_b32 v119, 0xffff0000, v35
  v_lshlrev_b32 v120, 16, v36
  v_and_b32 v121, 0xffff0000, v36
  v_lshlrev_b32 v122, 16, v37
  v_and_b32 v123, 0xffff0000, v37
  v_lshlrev_b32 v124, 16, v38
  v_and_b32 v125, 0xffff0000, v38
  v_lshlrev_b32 v126, 16, v39
  v_and_b32 v127, 0xffff0000, v39
  v_mul_f32 v112, v112, v16
  v_mul_f32 v113, v113, v17
  v_mul_f32 v114, v114, v18
  v_mul_f32 v115, v115, v19
  v_mul_f32 v116, v116, v20
  v_mul_f32 v117, v117, v21
  v_mul_f32 v118, v118, v22
  v_mul_f32 v119, v119, v23
  v_mul_f32 v120, v120, v24
  v_mul_f32 v121, v121, v25
  v_mul_f32 v122, v122, v26
  v_mul_f32 v123, v123, v27
  v_mul_f32 v124, v124, v28
  v_mul_f32 v125, v125, v29
  v_mul_f32 v126, v126, v30
  v_mul_f32 v127, v127, v31
  v_cvt_pk_bf16_f32 v112, v112, v113
  v_cvt_pk_bf16_f32 v113, v114, v115
  v_cvt_pk_bf16_f32 v114, v116, v117
  v_cvt_pk_bf16_f32 v115, v118, v119
  v_cvt_pk_bf16_f32 v116, v120, v121
  v_cvt_pk_bf16_f32 v117, v122, v123
  v_cvt_pk_bf16_f32 v118, v124, v125
  v_cvt_pk_bf16_f32 v119, v126, v127
  v_lshlrev_b32 v120, 16, v112
  v_and_b32 v112, 0xffff0000, v112
  v_lshlrev_b32 v121, 16, v113
  v_and_b32 v113, 0xffff0000, v113
  v_lshlrev_b32 v122, 16, v114
  v_and_b32 v114, 0xffff0000, v114
  v_lshlrev_b32 v123, 16, v115
  v_and_b32 v115, 0xffff0000, v115
  v_lshlrev_b32 v124, 16, v116
  v_and_b32 v116, 0xffff0000, v116
  v_lshlrev_b32 v125, 16, v117
  v_and_b32 v117, 0xffff0000, v117
  v_lshlrev_b32 v126, 16, v118
  v_and_b32 v118, 0xffff0000, v118
  v_lshlrev_b32 v127, 16, v119
  v_and_b32 v119, 0xffff0000, v119
  v_add_f32 v112, v112, v120
  v_add_f32 v113, v113, v121
  v_add_f32 v114, v114, v122
  v_add_f32 v115, v115, v123
  v_add_f32 v116, v116, v124
  v_add_f32 v117, v117, v125
  v_add_f32 v118, v118, v126
  v_add_f32 v119, v119, v127
  v_add_f32 v112, v112, v116
  v_add_f32 v113, v113, v117
  v_add_f32 v114, v114, v118
  v_add_f32 v115, v115, v119
  v_add_f32 v112, v112, v114
  v_add_f32 v113, v113, v115
  v_add_f32 v96, v112, v113
  s_waitcnt vmcnt(12)
  v_lshlrev_b32 v112, 16, v40
  v_and_b32 v113, 0xffff0000, v40
  v_lshlrev_b32 v114, 16, v41
  v_and_b32 v115, 0xffff0000, v41
  v_lshlrev_b32 v116, 16, v42
  v_and_b32 v117, 0xffff0000, v42
  v_lshlrev_b32 v118, 16, v43
  v_and_b32 v119, 0xffff0000, v43
  v_lshlrev_b32 v120, 16, v44
  v_and_b32 v121, 0xffff0000, v44
  v_lshlrev_b32 v122, 16, v45
  v_and_b32 v123, 0xffff0000, v45
  v_lshlrev_b32 v124, 16, v46
  v_and_b32 v125, 0xffff0000, v46
  v_lshlrev_b32 v126, 16, v47
  v_and_b32 v127, 0xffff0000, v47
  v_mul_f32 v112, v112, v16
  v_mul_f32 v113, v113, v17
  v_mul_f32 v114, v114, v18
  v_mul_f32 v115, v115, v19
  v_mul_f32 v116, v116, v20
  v_mul_f32 v117, v117, v21
  v_mul_f32 v118, v118, v22
  v_mul_f32 v119, v119, v23
  v_mul_f32 v120, v120, v24
  v_mul_f32 v121, v121, v25
  v_mul_f32 v122, v122, v26
  v_mul_f32 v123, v123, v27
  v_mul_f32 v124, v124, v28
  v_mul_f32 v125, v125, v29
  v_mul_f32 v126, v126, v30
  v_mul_f32 v127, v127, v31
  v_cvt_pk_bf16_f32 v112, v112, v113
  v_cvt_pk_bf16_f32 v113, v114, v115
  v_cvt_pk_bf16_f32 v114, v116, v117
  v_cvt_pk_bf16_f32 v115, v118, v119
  v_cvt_pk_bf16_f32 v116, v120, v121
  v_cvt_pk_bf16_f32 v117, v122, v123
  v_cvt_pk_bf16_f32 v118, v124, v125
  v_cvt_pk_bf16_f32 v119, v126, v127
  v_lshlrev_b32 v120, 16, v112
  v_and_b32 v112, 0xffff0000, v112
  v_lshlrev_b32 v121, 16, v113
  v_and_b32 v113, 0xffff0000, v113
  v_lshlrev_b32 v122, 16, v114
  v_and_b32 v114, 0xffff0000, v114
  v_lshlrev_b32 v123, 16, v115
  v_and_b32 v115, 0xffff0000, v115
  v_lshlrev_b32 v124, 16, v116
  v_and_b32 v116, 0xffff0000, v116
  v_lshlrev_b32 v125, 16, v117
  v_and_b32 v117, 0xffff0000, v117
  v_lshlrev_b32 v126, 16, v118
  v_and_b32 v118, 0xffff0000, v118
  v_lshlrev_b32 v127, 16, v119
  v_and_b32 v119, 0xffff0000, v119
  v_add_f32 v112, v112, v120
  v_add_f32 v113, v113, v121
  v_add_f32 v114, v114, v122
  v_add_f32 v115, v115, v123
  v_add_f32 v116, v116, v124
  v_add_f32 v117, v117, v125
  v_add_f32 v118, v118, v126
  v_add_f32 v119, v119, v127
  v_add_f32 v112, v112, v116
  v_add_f32 v113, v113, v117
  v_add_f32 v114, v114, v118
  v_add_f32 v115, v115, v119
  v_add_f32 v112, v112, v114
  v_add_f32 v113, v113, v115
  v_add_f32 v97, v112, v113
  s_waitcnt vmcnt(10)
  v_lshlrev_b32 v112, 16, v48
  v_and_b32 v113, 0xffff0000, v48
  v_lshlrev_b32 v114, 16, v49
  v_and_b32 v115, 0xffff0000, v49
  v_lshlrev_b32 v116, 16, v50
  v_and_b32 v117, 0xffff0000, v50
  v_lshlrev_b32 v118, 16, v51
  v_and_b32 v119, 0xffff0000, v51
  v_lshlrev_b32 v120, 16, v52
  v_and_b32 v121, 0xffff0000, v52
  v_lshlrev_b32 v122, 16, v53
  v_and_b32 v123, 0xffff0000, v53
  v_lshlrev_b32 v124, 16, v54
  v_and_b32 v125, 0xffff0000, v54
  v_lshlrev_b32 v126, 16, v55
  v_and_b32 v127, 0xffff0000, v55
  v_mul_f32 v112, v112, v16
  v_mul_f32 v113, v113, v17
  v_mul_f32 v114, v114, v18
  v_mul_f32 v115, v115, v19
  v_mul_f32 v116, v116, v20
  v_mul_f32 v117, v117, v21
  v_mul_f32 v118, v118, v22
  v_mul_f32 v119, v119, v23
  v_mul_f32 v120, v120, v24
  v_mul_f32 v121, v121, v25
  v_mul_f32 v122, v122, v26
  v_mul_f32 v123, v123, v27
  v_mul_f32 v124, v124, v28
  v_mul_f32 v125, v125, v29
  v_mul_f32 v126, v126, v30
  v_mul_f32 v127, v127, v31
  v_cvt_pk_bf16_f32 v112, v112, v113
  v_cvt_pk_bf16_f32 v113, v114, v115
  v_cvt_pk_bf16_f32 v114, v116, v117
  v_cvt_pk_bf16_f32 v115, v118, v119
  v_cvt_pk_bf16_f32 v116, v120, v121
  v_cvt_pk_bf16_f32 v117, v122, v123
  v_cvt_pk_bf16_f32 v118, v124, v125
  v_cvt_pk_bf16_f32 v119, v126, v127
  v_lshlrev_b32 v120, 16, v112
  v_and_b32 v112, 0xffff0000, v112
  v_lshlrev_b32 v121, 16, v113
  v_and_b32 v113, 0xffff0000, v113
  v_lshlrev_b32 v122, 16, v114
  v_and_b32 v114, 0xffff0000, v114
  v_lshlrev_b32 v123, 16, v115
  v_and_b32 v115, 0xffff0000, v115
  v_lshlrev_b32 v124, 16, v116
  v_and_b32 v116, 0xffff0000, v116
  v_lshlrev_b32 v125, 16, v117
  v_and_b32 v117, 0xffff0000, v117
  v_lshlrev_b32 v126, 16, v118
  v_and_b32 v118, 0xffff0000, v118
  v_lshlrev_b32 v127, 16, v119
  v_and_b32 v119, 0xffff0000, v119
  v_add_f32 v112, v112, v120
  v_add_f32 v113, v113, v121
  v_add_f32 v114, v114, v122
  v_add_f32 v115, v115, v123
  v_add_f32 v116, v116, v124
  v_add_f32 v117, v117, v125
  v_add_f32 v118, v118, v126
  v_add_f32 v119, v119, v127
  v_add_f32 v112, v112, v116
  v_add_f32 v113, v113, v117
  v_add_f32 v114, v114, v118
  v_add_f32 v115, v115, v119
  v_add_f32 v112, v112, v114
  v_add_f32 v113, v113, v115
  v_add_f32 v98, v112, v113
  s_waitcnt vmcnt(8)
  v_lshlrev_b32 v112, 16, v56
  v_and_b32 v113, 0xffff0000, v56
  v_lshlrev_b32 v114, 16, v57
  v_and_b32 v115, 0xffff0000, v57
  v_lshlrev_b32 v116, 16, v58
  v_and_b32 v117, 0xffff0000, v58
  v_lshlrev_b32 v118, 16, v59
  v_and_b32 v119, 0xffff0000, v59
  v_lshlrev_b32 v120, 16, v60
  v_and_b32 v121, 0xffff0000, v60
  v_lshlrev_b32 v122, 16, v61
  v_and_b32 v123, 0xffff0000, v61
  v_lshlrev_b32 v124, 16, v62
  v_and_b32 v125, 0xffff0000, v62
  v_lshlrev_b32 v126, 16, v63
  v_and_b32 v127, 0xffff0000, v63
  v_mul_f32 v112, v112, v16
  v_mul_f32 v113, v113, v17
  v_mul_f32 v114, v114, v18
  v_mul_f32 v115, v115, v19
  v_mul_f32 v116, v116, v20
  v_mul_f32 v117, v117, v21
  v_mul_f32 v118, v118, v22
  v_mul_f32 v119, v119, v23
  v_mul_f32 v120, v120, v24
  v_mul_f32 v121, v121, v25
  v_mul_f32 v122, v122, v26
  v_mul_f32 v123, v123, v27
  v_mul_f32 v124, v124, v28
  v_mul_f32 v125, v125, v29
  v_mul_f32 v126, v126, v30
  v_mul_f32 v127, v127, v31
  v_cvt_pk_bf16_f32 v112, v112, v113
  v_cvt_pk_bf16_f32 v113, v114, v115
  v_cvt_pk_bf16_f32 v114, v116, v117
  v_cvt_pk_bf16_f32 v115, v118, v119
  v_cvt_pk_bf16_f32 v116, v120, v121
  v_cvt_pk_bf16_f32 v117, v122, v123
  v_cvt_pk_bf16_f32 v118, v124, v125
  v_cvt_pk_bf16_f32 v119, v126, v127
  v_lshlrev_b32 v120, 16, v112
  v_and_b32 v112, 0xffff0000, v112
  v_lshlrev_b32 v121, 16, v113
  v_and_b32 v113, 0xffff0000, v113
  v_lshlrev_b32 v122, 16, v114
  v_and_b32 v114, 0xffff0000, v114
  v_lshlrev_b32 v123, 16, v115
  v_and_b32 v115, 0xffff0000, v115
  v_lshlrev_b32 v124, 16, v116
  v_and_b32 v116, 0xffff0000, v116
  v_lshlrev_b32 v125, 16, v117
  v_and_b32 v117, 0xffff0000, v117
  v_lshlrev_b32 v126, 16, v118
  v_and_b32 v118, 0xffff0000, v118
  v_lshlrev_b32 v127, 16, v119
  v_and_b32 v119, 0xffff0000, v119
  v_add_f32 v112, v112, v120
  v_add_f32 v113, v113, v121
  v_add_f32 v114, v114, v122
  v_add_f32 v115, v115, v123
  v_add_f32 v116, v116, v124
  v_add_f32 v117, v117, v125
  v_add_f32 v118, v118, v126
  v_add_f32 v119, v119, v127
  v_add_f32 v112, v112, v116
  v_add_f32 v113, v113, v117
  v_add_f32 v114, v114, v118
  v_add_f32 v115, v115, v119
  v_add_f32 v112, v112, v114
  v_add_f32 v113, v113, v115
  v_add_f32 v99, v112, v113
  s_waitcnt vmcnt(6)
  v_lshlrev_b32 v112, 16, v64
  v_and_b32 v113, 0xffff0000, v64
  v_lshlrev_b32 v114, 16, v65
  v_and_b32 v115, 0xffff0000, v65
  v_lshlrev_b32 v116, 16, v66
  v_and_b32 v117, 0xffff0000, v66
  v_lshlrev_b32 v118, 16, v67
  v_and_b32 v119, 0xffff0000, v67
  v_lshlrev_b32 v120, 16, v68
  v_and_b32 v121, 0xffff0000, v68
  v_lshlrev_b32 v122, 16, v69
  v_and_b32 v123, 0xffff0000, v69
  v_lshlrev_b32 v124, 16, v70
  v_and_b32 v125, 0xffff0000, v70
  v_lshlrev_b32 v126, 16, v71
  v_and_b32 v127, 0xffff0000, v71
  v_mul_f32 v112, v112, v16
  v_mul_f32 v113, v113, v17
  v_mul_f32 v114, v114, v18
  v_mul_f32 v115, v115, v19
  v_mul_f32 v116, v116, v20
  v_mul_f32 v117, v117, v21
  v_mul_f32 v118, v118, v22
  v_mul_f32 v119, v119, v23
  v_mul_f32 v120, v120, v24
  v_mul_f32 v121, v121, v25
  v_mul_f32 v122, v122, v26
  v_mul_f32 v123, v123, v27
  v_mul_f32 v124, v124, v28
  v_mul_f32 v125, v125, v29
  v_mul_f32 v126, v126, v30
  v_mul_f32 v127, v127, v31
  v_cvt_pk_bf16_f32 v112, v112, v113
  v_cvt_pk_bf16_f32 v113, v114, v115
  v_cvt_pk_bf16_f32 v114, v116, v117
  v_cvt_pk_bf16_f32 v115, v118, v119
  v_cvt_pk_bf16_f32 v116, v120, v121
  v_cvt_pk_bf16_f32 v117, v122, v123
  v_cvt_pk_bf16_f32 v118, v124, v125
  v_cvt_pk_bf16_f32 v119, v126, v127
  v_lshlrev_b32 v120, 16, v112
  v_and_b32 v112, 0xffff0000, v112
  v_lshlrev_b32 v121, 16, v113
  v_and_b32 v113, 0xffff0000, v113
  v_lshlrev_b32 v122, 16, v114
  v_and_b32 v114, 0xffff0000, v114
  v_lshlrev_b32 v123, 16, v115
  v_and_b32 v115, 0xffff0000, v115
  v_lshlrev_b32 v124, 16, v116
  v_and_b32 v116, 0xffff0000, v116
  v_lshlrev_b32 v125, 16, v117
  v_and_b32 v117, 0xffff0000, v117
  v_lshlrev_b32 v126, 16, v118
  v_and_b32 v118, 0xffff0000, v118
  v_lshlrev_b32 v127, 16, v119
  v_and_b32 v119, 0xffff0000, v119
  v_add_f32 v112, v112, v120
  v_add_f32 v113, v113, v121
  v_add_f32 v114, v114, v122
  v_add_f32 v115, v115, v123
  v_add_f32 v116, v116, v124
  v_add_f32 v117, v117, v125
  v_add_f32 v118, v118, v126
  v_add_f32 v119, v119, v127
  v_add_f32 v112, v112, v116
  v_add_f32 v113, v113, v117
  v_add_f32 v114, v114, v118
  v_add_f32 v115, v115, v119
  v_add_f32 v112, v112, v114
  v_add_f32 v113, v113, v115
  v_add_f32 v100, v112, v113
  s_waitcnt vmcnt(4)
  v_lshlrev_b32 v112, 16, v72
  v_and_b32 v113, 0xffff0000, v72
  v_lshlrev_b32 v114, 16, v73
  v_and_b32 v115, 0xffff0000, v73
  v_lshlrev_b32 v116, 16, v74
  v_and_b32 v117, 0xffff0000, v74
  v_lshlrev_b32 v118, 16, v75
  v_and_b32 v119, 0xffff0000, v75
  v_lshlrev_b32 v120, 16, v76
  v_and_b32 v121, 0xffff0000, v76
  v_lshlrev_b32 v122, 16, v77
  v_and_b32 v123, 0xffff0000, v77
  v_lshlrev_b32 v124, 16, v78
  v_and_b32 v125, 0xffff0000, v78
  v_lshlrev_b32 v126, 16, v79
  v_and_b32 v127, 0xffff0000, v79
  v_mul_f32 v112, v112, v16
  v_mul_f32 v113, v113, v17
  v_mul_f32 v114, v114, v18
  v_mul_f32 v115, v115, v19
  v_mul_f32 v116, v116, v20
  v_mul_f32 v117, v117, v21
  v_mul_f32 v118, v118, v22
  v_mul_f32 v119, v119, v23
  v_mul_f32 v120, v120, v24
  v_mul_f32 v121, v121, v25
  v_mul_f32 v122, v122, v26
  v_mul_f32 v123, v123, v27
  v_mul_f32 v124, v124, v28
  v_mul_f32 v125, v125, v29
  v_mul_f32 v126, v126, v30
  v_mul_f32 v127, v127, v31
  v_cvt_pk_bf16_f32 v112, v112, v113
  v_cvt_pk_bf16_f32 v113, v114, v115
  v_cvt_pk_bf16_f32 v114, v116, v117
  v_cvt_pk_bf16_f32 v115, v118, v119
  v_cvt_pk_bf16_f32 v116, v120, v121
  v_cvt_pk_bf16_f32 v117, v122, v123
  v_cvt_pk_bf16_f32 v118, v124, v125
  v_cvt_pk_bf16_f32 v119, v126, v127
  v_lshlrev_b32 v120, 16, v112
  v_and_b32 v112, 0xffff0000, v112
  v_lshlrev_b32 v121, 16, v113
  v_and_b32 v113, 0xffff0000, v113
  v_lshlrev_b32 v122, 16, v114
  v_and_b32 v114, 0xffff0000, v114
  v_lshlrev_b32 v123, 16, v115
  v_and_b32 v115, 0xffff0000, v115
  v_lshlrev_b32 v124, 16, v116
  v_and_b32 v116, 0xffff0000, v116
  v_lshlrev_b32 v125, 16, v117
  v_and_b32 v117, 0xffff0000, v117
  v_lshlrev_b32 v126, 16, v118
  v_and_b32 v118, 0xffff0000, v118
  v_lshlrev_b32 v127, 16, v119
  v_and_b32 v119, 0xffff0000, v119
  v_add_f32 v112, v112, v120
  v_add_f32 v113, v113, v121
  v_add_f32 v114, v114, v122
  v_add_f32 v115, v115, v123
  v_add_f32 v116, v116, v124
  v_add_f32 v117, v117, v125
  v_add_f32 v118, v118, v126
  v_add_f32 v119, v119, v127
  v_add_f32 v112, v112, v116
  v_add_f32 v113, v113, v117
  v_add_f32 v114, v114, v118
  v_add_f32 v115, v115, v119
  v_add_f32 v112, v112, v114
  v_add_f32 v113, v113, v115
  v_add_f32 v101, v112, v113
  s_waitcnt vmcnt(2)
  v_lshlrev_b32 v112, 16, v80
  v_and_b32 v113, 0xffff0000, v80
  v_lshlrev_b32 v114, 16, v81
  v_and_b32 v115, 0xffff0000, v81
  v_lshlrev_b32 v116, 16, v82
  v_and_b32 v117, 0xffff0000, v82
  v_lshlrev_b32 v118, 16, v83
  v_and_b32 v119, 0xffff0000, v83
  v_lshlrev_b32 v120, 16, v84
  v_and_b32 v121, 0xffff0000, v84
  v_lshlrev_b32 v122, 16, v85
  v_and_b32 v123, 0xffff0000, v85
  v_lshlrev_b32 v124, 16, v86
  v_and_b32 v125, 0xffff0000, v86
  v_lshlrev_b32 v126, 16, v87
  v_and_b32 v127, 0xffff0000, v87
  v_mul_f32 v112, v112, v16
  v_mul_f32 v113, v113, v17
  v_mul_f32 v114, v114, v18
  v_mul_f32 v115, v115, v19
  v_mul_f32 v116, v116, v20
  v_mul_f32 v117, v117, v21
  v_mul_f32 v118, v118, v22
  v_mul_f32 v119, v119, v23
  v_mul_f32 v120, v120, v24
  v_mul_f32 v121, v121, v25
  v_mul_f32 v122, v122, v26
  v_mul_f32 v123, v123, v27
  v_mul_f32 v124, v124, v28
  v_mul_f32 v125, v125, v29
  v_mul_f32 v126, v126, v30
  v_mul_f32 v127, v127, v31
  v_cvt_pk_bf16_f32 v112, v112, v113
  v_cvt_pk_bf16_f32 v113, v114, v115
  v_cvt_pk_bf16_f32 v114, v116, v117
  v_cvt_pk_bf16_f32 v115, v118, v119
  v_cvt_pk_bf16_f32 v116, v120, v121
  v_cvt_pk_bf16_f32 v117, v122, v123
  v_cvt_pk_bf16_f32 v118, v124, v125
  v_cvt_pk_bf16_f32 v119, v126, v127
  v_lshlrev_b32 v120, 16, v112
  v_and_b32 v112, 0xffff0000, v112
  v_lshlrev_b32 v121, 16, v113
  v_and_b32 v113, 0xffff0000, v113
  v_lshlrev_b32 v122, 16, v114
  v_and_b32 v114, 0xffff0000, v114
  v_lshlrev_b32 v123, 16, v115
  v_and_b32 v115, 0xffff0000, v115
  v_lshlrev_b32 v124, 16, v116
  v_and_b32 v116, 0xffff0000, v116
  v_lshlrev_b32 v125, 16, v117
  v_and_b32 v117, 0xffff0000, v117
  v_lshlrev_b32 v126, 16, v118
  v_and_b32 v118, 0xffff0000, v118
  v_lshlrev_b32 v127, 16, v119
  v_and_b32 v119, 0xffff0000, v119
  v_add_f32 v112, v112, v120
  v_add_f32 v113, v113, v121
  v_add_f32 v114, v114, v122
  v_add_f32 v115, v115, v123
  v_add_f32 v116, v116, v124
  v_add_f32 v117, v117, v125
  v_add_f32 v118, v118, v126
  v_add_f32 v119, v119, v127
  v_add_f32 v112, v112, v116
  v_add_f32 v113, v113, v117
  v_add_f32 v114, v114, v118
  v_add_f32 v115, v115, v119
  v_add_f32 v112, v112, v114
  v_add_f32 v113, v113, v115
  v_add_f32 v102, v112, v113
  s_waitcnt vmcnt(0)
  v_lshlrev_b32 v112, 16, v88
  v_and_b32 v113, 0xffff0000, v88
  v_lshlrev_b32 v114, 16, v89
  v_and_b32 v115, 0xffff0000, v89
  v_lshlrev_b32 v116, 16, v90
  v_and_b32 v117, 0xffff0000, v90
  v_lshlrev_b32 v118, 16, v91
  v_and_b32 v119, 0xffff0000, v91
  v_lshlrev_b32 v120, 16, v92
  v_and_b32 v121, 0xffff0000, v92
  v_lshlrev_b32 v122, 16, v93
  v_and_b32 v123, 0xffff0000, v93
  v_lshlrev_b32 v124, 16, v94
  v_and_b32 v125, 0xffff0000, v94
  v_lshlrev_b32 v126, 16, v95
  v_and_b32 v127, 0xffff0000, v95
  v_mul_f32 v112, v112, v16
  v_mul_f32 v113, v113, v17
  v_mul_f32 v114, v114, v18
  v_mul_f32 v115, v115, v19
  v_mul_f32 v116, v116, v20
  v_mul_f32 v117, v117, v21
  v_mul_f32 v118, v118, v22
  v_mul_f32 v119, v119, v23
  v_mul_f32 v120, v120, v24
  v_mul_f32 v121, v121, v25
  v_mul_f32 v122, v122, v26
  v_mul_f32 v123, v123, v27
  v_mul_f32 v124, v124, v28
  v_mul_f32 v125, v125, v29
  v_mul_f32 v126, v126, v30
  v_mul_f32 v127, v127, v31
  v_cvt_pk_bf16_f32 v112, v112, v113
  v_cvt_pk_bf16_f32 v113, v114, v115
  v_cvt_pk_bf16_f32 v114, v116, v117
  v_cvt_pk_bf16_f32 v115, v118, v119
  v_cvt_pk_bf16_f32 v116, v120, v121
  v_cvt_pk_bf16_f32 v117, v122, v123
  v_cvt_pk_bf16_f32 v118, v124, v125
  v_cvt_pk_bf16_f32 v119, v126, v127
  v_lshlrev_b32 v120, 16, v112
  v_and_b32 v112, 0xffff0000, v112
  v_lshlrev_b32 v121, 16, v113
  v_and_b32 v113, 0xffff0000, v113
  v_lshlrev_b32 v122, 16, v114
  v_and_b32 v114, 0xffff0000, v114
  v_lshlrev_b32 v123, 16, v115
  v_and_b32 v115, 0xffff0000, v115
  v_lshlrev_b32 v124, 16, v116
  v_and_b32 v116, 0xffff0000, v116
  v_lshlrev_b32 v125, 16, v117
  v_and_b32 v117, 0xffff0000, v117
  v_lshlrev_b32 v126, 16, v118
  v_and_b32 v118, 0xffff0000, v118
  v_lshlrev_b32 v127, 16, v119
  v_and_b32 v119, 0xffff0000, v119
  v_add_f32 v112, v112, v120
  v_add_f32 v113, v113, v121
  v_add_f32 v114, v114, v122
  v_add_f32 v115, v115, v123
  v_add_f32 v116, v116, v124
  v_add_f32 v117, v117, v125
  v_add_f32 v118, v118, v126
  v_add_f32 v119, v119, v127
  v_add_f32 v112, v112, v116
  v_add_f32 v113, v113, v117
  v_add_f32 v114, v114, v118
  v_add_f32 v115, v115, v119
  v_add_f32 v112, v112, v114
  v_add_f32 v113, v113, v115
  v_add_f32 v103, v112, v113
  v_add_f32_dpp v96, v96, v96 row_shr:1 row_mask:0xf bank_mask:0xf bound_ctrl:0
  v_add_f32_dpp v97, v97, v97 row_shr:1 row_mask:0xf bank_mask:0xf bound_ctrl:0
  v_add_f32_dpp v98, v98, v98 row_shr:1 row_mask:0xf bank_mask:0xf bound_ctrl:0
  v_add_f32_dpp v99, v99, v99 row_shr:1 row_mask:0xf bank_mask:0xf bound_ctrl:0
  v_add_f32_dpp v100, v100, v100 row_shr:1 row_mask:0xf bank_mask:0xf bound_ctrl:0
  v_add_f32_dpp v101, v101, v101 row_shr:1 row_mask:0xf bank_mask:0xf bound_ctrl:0
  v_add_f32_dpp v102, v102, v102 row_shr:1 row_mask:0xf bank_mask:0xf bound_ctrl:0
  v_add_f32_dpp v103, v103, v103 row_shr:1 row_mask:0xf bank_mask:0xf bound_ctrl:0
  v_add_f32_dpp v96, v96, v96 row_shr:2 row_mask:0xf bank_mask:0xf bound_ctrl:0
  v_add_f32_dpp v97, v97, v97 row_shr:2 row_mask:0xf bank_mask:0xf bound_ctrl:0
  v_add_f32_dpp v98, v98, v98 row_shr:2 row_mask:0xf bank_mask:0xf bound_ctrl:0
  v_add_f32_dpp v99, v99, v99 row_shr:2 row_mask:0xf bank_mask:0xf bound_ctrl:0
  v_add_f32_dpp v100, v100, v100 row_shr:2 row_mask:0xf bank_mask:0xf bound_ctrl:0
  v_add_f32_dpp v101, v101, v101 row_shr:2 row_mask:0xf bank_mask:0xf bound_ctrl:0
  v_add_f32_dpp v102, v102, v102 row_shr:2 row_mask:0xf bank_mask:0xf bound_ctrl:0
  v_add_f32_dpp v103, v103, v103 row_shr:2 row_mask:0xf bank_mask:0xf bound_ctrl:0
  v_add_f32_dpp v96, v96, v96 row_shr:4 row_mask:0xf bank_mask:0xf bound_ctrl:0
  v_add_f32_dpp v97, v97, v97 row_shr:4 row_mask:0xf bank_mask:0xf bound_ctrl:0
  v_add_f32_dpp v98, v98, v98 row_shr:4 row_mask:0xf bank_mask:0xf bound_ctrl:0
  v_add_f32_dpp v99, v99, v99 row_shr:4 row_mask:0xf bank_mask:0xf bound_ctrl:0
  v_add_f32_dpp v100, v100, v100 row_shr:4 row_mask:0xf bank_mask:0xf bound_ctrl:0
  v_add_f32_dpp v101, v101, v101 row_shr:4 row_mask:0xf bank_mask:0xf bound_ctrl:0
  v_add_f32_dpp v102, v102, v102 row_shr:4 row_mask:0xf bank_mask:0xf bound_ctrl:0
  v_add_f32_dpp v103, v103, v103 row_shr:4 row_mask:0xf bank_mask:0xf bound_ctrl:0
  v_add_f32_dpp v96, v96, v96 row_shr:8 row_mask:0xf bank_mask:0xf bound_ctrl:0
  v_add_f32_dpp v97, v97, v97 row_shr:8 row_mask:0xf bank_mask:0xf bound_ctrl:0
  v_add_f32_dpp v98, v98, v98 row_shr:8 row_mask:0xf bank_mask:0xf bound_ctrl:0
  v_add_f32_dpp v99, v99, v99 row_shr:8 row_mask:0xf bank_mask:0xf bound_ctrl:0
  v_add_f32_dpp v100, v100, v100 row_shr:8 row_mask:0xf bank_mask:0xf bound_ctrl:0
  v_add_f32_dpp v101, v101, v101 row_shr:8 row_mask:0xf bank_mask:0xf bound_ctrl:0
  v_add_f32_dpp v102, v102, v102 row_shr:8 row_mask:0xf bank_mask:0xf bound_ctrl:0
  v_add_f32_dpp v103, v103, v103 row_shr:8 row_mask:0xf bank_mask:0xf bound_ctrl:0
  v_add_f32_dpp v96, v96, v96 row_bcast:15 row_mask:0xa bank_mask:0xf
  v_add_f32_dpp v97, v97, v97 row_bcast:15 row_mask:0xa bank_mask:0xf
  v_add_f32_dpp v98, v98, v98 row_bcast:15 row_mask:0xa bank_mask:0xf
  v_add_f32_dpp v99, v99, v99 row_bcast:15 row_mask:0xa bank_mask:0xf
  v_add_f32_dpp v100, v100, v100 row_bcast:15 row_mask:0xa bank_mask:0xf
  v_add_f32_dpp v101, v101, v101 row_bcast:15 row_mask:0xa bank_mask:0xf
  v_add_f32_dpp v102, v102, v102 row_bcast:15 row_mask:0xa bank_mask:0xf
  v_add_f32_dpp v103, v103, v103 row_bcast:15 row_mask:0xa bank_mask:0xf
  v_add_f32_dpp v96, v96, v96 row_bcast:31 row_mask:0xc bank_mask:0xf
  v_add_f32_dpp v97, v97, v97 row_bcast:31 row_mask:0xc bank_mask:0xf
  v_add_f32_dpp v98, v98, v98 row_bcast:31 row_mask:0xc bank_mask:0xf
  v_add_f32_dpp v99, v99, v99 row_bcast:31 row_mask:0xc bank_mask:0xf
  v_add_f32_dpp v100, v100, v100 row_bcast:31 row_mask:0xc bank_mask:0xf
  v_add_f32_dpp v101, v101, v101 row_bcast:31 row_mask:0xc bank_mask:0xf
  v_add_f32_dpp v102, v102, v102 row_bcast:31 row_mask:0xc bank_mask:0xf
  v_add_f32_dpp v103, v103, v103 row_bcast:31 row_mask:0xc bank_mask:0xf
  v_cvt_pk_bf16_f32 v96, v96, v96
  v_cvt_pk_bf16_f32 v97, v97, v97
  v_cvt_pk_bf16_f32 v98, v98, v98
  v_cvt_pk_bf16_f32 v99, v99, v99
  v_cvt_pk_bf16_f32 v100, v100, v100
  v_cvt_pk_bf16_f32 v101, v101, v101
  v_cvt_pk_bf16_f32 v102, v102, v102
  v_cvt_pk_bf16_f32 v103, v103, v103
  v_and_b32 v96, 0xffff0000, v96
  v_and_b32 v97, 0xffff0000, v97
  v_and_b32 v98, 0xffff0000, v98
  v_and_b32 v99, 0xffff0000, v99
  v_and_b32 v100, 0xffff0000, v100
  v_and_b32 v101, 0xffff0000, v101
  v_and_b32 v102, 0xffff0000, v102
  v_and_b32 v103, 0xffff0000, v103
  v_mul_f32 v96, 0xbfb8aa3b, v96
  v_mul_f32 v97, 0xbfb8aa3b, v97
  v_mul_f32 v98, 0xbfb8aa3b, v98
  v_mul_f32 v99, 0xbfb8aa3b, v99
  v_mul_f32 v100, 0xbfb8aa3b, v100
  v_mul_f32 v101, 0xbfb8aa3b, v101
  v_mul_f32 v102, 0xbfb8aa3b, v102
  v_mul_f32 v103, 0xbfb8aa3b, v103
  v_exp_f32 v96, v96
  v_exp_f32 v97, v97
  v_exp_f32 v98, v98
  v_exp_f32 v99, v99
  v_exp_f32 v100, v100
  v_exp_f32 v101, v101
  v_exp_f32 v102, v102
  v_exp_f32 v103, v103
  v_add_f32 v96, 1.0, v96
  v_add_f32 v97, 1.0, v97
  v_add_f32 v98, 1.0, v98
  v_add_f32 v99, 1.0, v99
  v_add_f32 v100, 1.0, v100
  v_add_f32 v101, 1.0, v101
  v_add_f32 v102, 1.0, v102
  v_add_f32 v103, 1.0, v103
  v_rcp_f32 v96, v96
  v_rcp_f32 v97, v97
  v_rcp_f32 v98, v98
  v_rcp_f32 v99, v99
  v_rcp_f32 v100, v100
  v_rcp_f32 v101, v101
  v_rcp_f32 v102, v102
  v_rcp_f32 v103, v103
  v_cvt_pk_bf16_f32 v96, v96, v96
  v_cvt_pk_bf16_f32 v97, v97, v97
  v_cvt_pk_bf16_f32 v98, v98, v98
  v_cvt_pk_bf16_f32 v99, v99, v99
  v_cvt_pk_bf16_f32 v100, v100, v100
  v_cvt_pk_bf16_f32 v101, v101, v101
  v_cvt_pk_bf16_f32 v102, v102, v102
  v_cvt_pk_bf16_f32 v103, v103, v103
  v_and_b32 v96, 0xffff0000, v96
  v_and_b32 v97, 0xffff0000, v97
  v_and_b32 v98, 0xffff0000, v98
  v_and_b32 v99, 0xffff0000, v99
  v_and_b32 v100, 0xffff0000, v100
  v_and_b32 v101, 0xffff0000, v101
  v_and_b32 v102, 0xffff0000, v102
  v_and_b32 v103, 0xffff0000, v103
  v_sub_f32 v104, 1.0, v96
  v_sub_f32 v105, 1.0, v97
  v_sub_f32 v106, 1.0, v98
  v_sub_f32 v107, 1.0, v99
  v_sub_f32 v108, 1.0, v100
  v_sub_f32 v109, 1.0, v101
  v_sub_f32 v110, 1.0, v102
  v_sub_f32 v111, 1.0, v103
  v_cvt_pk_bf16_f32 v104, v104, v104
  v_cvt_pk_bf16_f32 v105, v105, v105
  v_cvt_pk_bf16_f32 v106, v106, v106
  v_cvt_pk_bf16_f32 v107, v107, v107
  v_cvt_pk_bf16_f32 v108, v108, v108
  v_cvt_pk_bf16_f32 v109, v109, v109
  v_cvt_pk_bf16_f32 v110, v110, v110
  v_cvt_pk_bf16_f32 v111, v111, v111
  v_and_b32 v104, 0xffff0000, v104
  v_and_b32 v105, 0xffff0000, v105
  v_and_b32 v106, 0xffff0000, v106
  v_and_b32 v107, 0xffff0000, v107
  v_and_b32 v108, 0xffff0000, v108
  v_and_b32 v109, 0xffff0000, v109
  v_and_b32 v110, 0xffff0000, v110
  v_and_b32 v111, 0xffff0000, v111
  s_lshl_b32 s32, s32, 5
  v_mov_b32 v2, s32
  s_mov_b32 exec_lo, 0
  s_mov_b32 exec_hi, 0x80000000
  buffer_store_dwordx4 v[96:99], v2, s[52:55], 0 offen sc1
  buffer_store_dwordx4 v[100:103], v2, s[52:55], 0 offen offset:16 sc1
  s_mov_b32 s33, 8192
  buffer_store_dwordx4 v[104:107], v2, s[52:55], s33 offen sc1
  buffer_store_dwordx4 v[108:111], v2, s[52:55], s33 offen offset:16 sc1
  s_mov_b64 exec, -1
  s_add_u32 s60, s60, 1
  s_and_b32 s32, s60, 3
  s_cbranch_scc1 w_gate_1011
  s_cmp_lg_u32 s20, 0
  s_cbranch_scc1 w_pop_142
  s_mov_b64 exec, 1
  v_mov_b32 v255, 1
  buffer_atomic_add v255, off, s[8:11], s28 sc0 sc1
  s_mov_b64 exec, -1
w_pop_142:
  s_branch w_next_87
w_att_103:
  s_lshl_b32 s60, s6, 5
  s_add_u32 s60, s60, s7
  s_lshr_b32 s32, s60, 3
  s_lshl_b32 s29, s32, 7
  s_add_u32 s29, s29, 124790784
  s_mov_b32 s30, 1
  s_lshr_b32 s32, s60, 4
  s_lshl_b32 s32, s32, 7
  s_add_u32 s32, s32, 124788736
  s_mov_b32 s33, 124789760
  s_cmp_lg_u32 s20, 0
  s_cbranch_scc1 dpx_144
  s_mov_b32 s31, 400000
dp_143:
  buffer_load_dword v1, off, s[24:27], s32 sc1
  buffer_load_dword v2, off, s[24:27], s33 sc1
  s_sub_u32 s31, s31, 1
  s_cbranch_scc1 fused_kernel_end
  s_waitcnt vmcnt(0)
  v_cmp_gt_u32 vcc, 4, v1
  s_cbranch_vccnz dp_143_s
  v_cmp_gt_u32 vcc, 16, v2
  s_cbranch_vccnz dp_143_s
  s_branch dpx_144
dp_143_s:
  s_sleep 8
  s_branch dp_143
dpx_144:
  s_barrier
  s_mov_b32 s39, 2
  s_add_u32 s44, s4, 50331648
  s_addc_u32 s45, s5, 0
  s_and_b32 s45, s45, 0xffff
  s_mov_b32 s46, 4194304
  s_mov_b32 s47, 0x20000
  s_add_u32 s48, s4, 54525952
  s_addc_u32 s49, s5, 0
  s_and_b32 s49, s49, 0xffff
  s_mov_b32 s50, 262144
  s_mov_b32 s51, 0x20000
  s_add_u32 s52, s4, 54788096
  s_addc_u32 s53, s5, 0
  s_and_b32 s53, s53, 0xffff
  s_mov_b32 s54, 16384
  s_mov_b32 s55, 0x20000
  s_add_u32 s56, s4, 67108864
  s_addc_u32 s57, s5, 0
  s_and_b32 s57, s57, 0xffff
  s_mov_b32 s58, 4194304
  s_mov_b32 s59, 0x20000
  v_and_b32 v1, 63, v0
  v_lshlrev_b32 v6, 4, v0
  s_lshl_b32 s62, s60, 3
  s_add_u32 s62, s62, s20
  s_lshl_b32 s62, s62, 1
  v_and_b32 v2, 31, v1
  v_lshrrev_b32 v3, 5, v1
  v_lshlrev_b32 v7, 6, v2
  v_lshl_add_u32 v7, v3, 5, v7
  s_lshl_b32 s67, s62, 11
  buffer_load_dwordx4 v[16:19], v7, s[44:47], s67 offen offset:0
  buffer_load_dwordx4 v[20:23], v7, s[44:47], s67 offen offset:16
  buffer_load_dwordx4 v[24:27], v7, s[44:47], s67 offen offset:2048
  buffer_load_dwordx4 v[28:31], v7, s[44:47], s67 offen offset:2064
  s_lshl_b32 s67, s62, 2
  v_mov_b32 v2, s67
  buffer_load_dwordx2 v[10:11], v2, s[52:55], 0 offen
  v_mov_b32 v8, 0xdddddddd
  v_and_b32 v2, 7, v1
  v_mov_b32 v3, 0x3f803f80
  v_cmp_eq_u32 vcc, 0, v2
  s_nop 1
  v_cndmask_b32 v12, 0, v3, vcc
  v_cndmask_b32 v13, 0, v3, vcc
  v_cmp_eq_u32 vcc, 4, v2
  s_nop 1
  v_cndmask_b32 v14, 0, v3, vcc
  v_cndmask_b32 v15, 0, v3, vcc
  v_mov_b32 v72, 0
  v_mov_b32 v73, 0
  v_mov_b32 v74, 0
  v_mov_b32 v75, 0
  v_mov_b32 v76, 0
  v_mov_b32 v77, 0
  v_mov_b32 v78, 0
  v_mov_b32 v79, 0
  v_mov_b32 v80, 0
  v_mov_b32 v81, 0
  v_mov_b32 v82, 0
  v_mov_b32 v83, 0
  v_mov_b32 v84, 0
  v_mov_b32 v85, 0
  v_mov_b32 v86, 0
  v_mov_b32 v87, 0
  v_mov_b32 v88, 0
  v_mov_b32 v89, 0
  v_mov_b32 v90, 0
  v_mov_b32 v91, 0
  v_mov_b32 v92, 0
  v_mov_b32 v93, 0
  v_mov_b32 v94, 0
  v_mov_b32 v95, 0
  v_mov_b32 v96, 0
  v_mov_b32 v97, 0
  v_mov_b32 v98, 0
  v_mov_b32 v99, 0
  v_mov_b32 v100, 0
  v_mov_b32 v101, 0
  v_mov_b32 v102, 0
  v_mov_b32 v103, 0
  s_mov_b32 s66, 0
aa_re_145:
  s_lshl_b32 s63, s20, 10
  s_mov_b32 s64, 0
  s_add_u32 m0, s63, 0
  s_nop 0
  buffer_load_dwordx4 v6, s[48:51], s64 offen lds
  s_add_u32 s64, s64, 8192
  s_add_u32 m0, s63, 8192
  s_nop 0
  buffer_load_dwordx4 v6, s[48:51], s64 offen lds
  s_add_u32 s64, s64, 8192
  s_add_u32 m0, s63, 16384
  s_nop 0
  buffer_load_dwordx4 v6, s[48:51], s64 offen lds
  s_add_u32 s64, s64, 8192
  s_add_u32 m0, s63, 24576
  s_nop 0
  buffer_load_dwordx4 v6, s[48:51], s64 offen lds
  s_add_u32 s64, s64, 8192
  s_add_u32 s63, s63, 32768
  s_and_b32 s63, s63, 0x1ffff
  s_add_u32 m0, s63, 0
  s_nop 0
  buffer_load_dwordx4 v6, s[48:51], s64 offen lds
  s_add_u32 s64, s64, 8192
  s_add_u32 m0, s63, 8192
  s_nop 0
  buffer_load_dwordx4 v6, s[48:51], s64 offen lds
  s_add_u32 s64, s64, 8192
  s_add_u32 m0, s63, 16384
  s_nop 0
  buffer_load_dwordx4 v6, s[48:51], s64 offen lds
  s_add_u32 s64, s64, 8192
  s_add_u32 m0, s63, 24576
  s_nop 0
  buffer_load_dwordx4 v6, s[48:51], s64 offen lds
  s_add_u32 s64, s64, 8192
  s_add_u32 s63, s63, 32768
  s_and_b32 s63, s63, 0x1ffff
  s_add_u32 m0, s63, 0
  s_nop 0
  buffer_load_dwordx4 v6, s[48:51], s64 offen lds
  s_add_u32 s64, s64, 8192
  s_add_u32 m0, s63, 8192
  s_nop 0
  buffer_load_dwordx4 v6, s[48:51], s64 offen lds
  s_add_u32 s64, s64, 8192
  s_add_u32 m0, s63, 16384
  s_nop 0
  buffer_load_dwordx4 v6, s[48:51], s64 offen lds
  s_add_u32 s64, s64, 8192
  s_add_u32 m0, s63, 24576
  s_nop 0
  buffer_load_dwordx4 v6, s[48:51], s64 offen lds
  s_add_u32 s64, s64, 8192
  s_add_u32 s63, s63, 32768
  s_and_b32 s63, s63, 0x1ffff
  v_mov_b32 v32, 0
  v_mov_b32 v33, 0
  v_mov_b32 v34, 0
  v_mov_b32 v35, 0
  v_mov_b32 v36, 0
  v_mov_b32 v37, 0
  v_mov_b32 v38, 0
  v_mov_b32 v39, 0
  v_mov_b32 v40, 0
  v_mov_b32 v41, 0
  v_mov_b32 v42, 0
  v_mov_b32 v43, 0
  v_mov_b32 v44, 0
  v_mov_b32 v45, 0
  v_mov_b32 v46, 0
  v_mov_b32 v47, 0
  v_mov_b32 v48, 0
  v_mov_b32 v49, 0
  v_mov_b32 v50, 0
  v_mov_b32 v51, 0
  v_mov_b32 v52, 0
  v_mov_b32 v53, 0
  v_mov_b32 v54, 0
  v_mov_b32 v55, 0
  v_mov_b32 v56, 0
  v_mov_b32 v57, 0
  v_mov_b32 v58, 0
  v_mov_b32 v59, 0
  v_mov_b32 v60, 0
  v_mov_b32 v61, 0
  v_mov_b32 v62, 0
  v_mov_b32 v63, 0
  v_mov_b32 v64, 0
  v_mov_b32 v65, 0
  v_mov_b32 v66, 0
  v_mov_b32 v67, 0
  v_mov_b32 v68, 0
  v_mov_b32 v69, 0
  v_mov_b32 v70, 0
  v_mov_b32 v71, 0
  v_mov_b32 v152, 0
  v_mov_b32 v153, 0
  v_mov_b32 v154, 0
  v_mov_b32 v155, 0
  v_mov_b32 v156, 0
  v_mov_b32 v157, 0
  v_mov_b32 v158, 0
  v_mov_b32 v159, 0
  v_mov_b32 v160, 0
  v_mov_b32 v161, 0
  v_mov_b32 v162, 0
  v_mov_b32 v163, 0
  v_mov_b32 v164, 0
  v_mov_b32 v165, 0
  v_mov_b32 v166, 0
  v_mov_b32 v167, 0
  v_mov_b32 v192, 0
  v_mov_b32 v193, 0
  v_mov_b32 v194, 0
  v_mov_b32 v195, 0
  v_mov_b32 v196, 0
  v_mov_b32 v197, 0
  v_mov_b32 v198, 0
  v_mov_b32 v199, 0
  v_lshlrev_b32 v4, 4, v1
  v_lshlrev_b32 v5, 4, v1
  v_mov_b32 v2, 131072
  v_mov_b32 v3, 0
  ds_write_b32 v2, v3
  s_waitcnt vmcnt(8) lgkmcnt(0)
  s_barrier
  ds_read_b128 v[168:171], v4 offset:0
  ds_read_b128 v[172:175], v4 offset:1024
  ds_read_b128 v[176:179], v4 offset:4096
  ds_read_b128 v[180:183], v4 offset:5120
  s_waitcnt lgkmcnt(2)
  v_mfma_f32_32x32x16_bf16 v[104:119], v[168:171], v[16:19], v[72:87]
  v_mfma_f32_32x32x16_bf16 v[104:119], v[172:175], v[20:23], v[104:119]
  s_mov_b32 s65, 8
  s_nop 9
aa_loop_146:
  v_mfma_f32_32x32x16_bf16 v[120:135], v[168:171], v[24:27], v[88:103]
  ds_read_b128 v[184:187], v5 offset:2048
  v_exp_f32 v104, v104
  v_exp_f32 v105, v105
  v_exp_f32 v106, v106
  v_mfma_f32_32x32x16_bf16 v[120:135], v[172:175], v[28:31], v[120:135]
  ds_read_b128 v[188:191], v5 offset:3072
  v_exp_f32 v107, v107
  v_exp_f32 v108, v108
  v_exp_f32 v109, v109
  v_smfmac_f32_32x32x32_bf16 v[48:63], v[192:195], v[152:159], v8
  v_exp_f32 v110, v110
  v_exp_f32 v111, v111
  v_exp_f32 v112, v112
  v_smfmac_f32_16x16x64_bf16 v[68:71], v[12:15], v[152:159], v8
  v_exp_f32 v113, v113
  v_exp_f32 v114, v114
  v_smfmac_f32_32x32x32_bf16 v[48:63], v[196:199], v[160:167], v8
  v_exp_f32 v115, v115
  v_exp_f32 v116, v116
  v_exp_f32 v117, v117
  v_smfmac_f32_16x16x64_bf16 v[68:71], v[12:15], v[160:167], v8
  v_exp_f32 v118, v118
  v_exp_f32 v119, v119
  s_waitcnt lgkmcnt(0)
  v_mfma_f32_32x32x16_bf16 v[136:151], v[176:179], v[16:19], v[72:87]
  ds_read_b128 v[168:171], v4 offset:8192
  v_exp_f32 v120, v120
  v_exp_f32 v121, v121
  v_exp_f32 v122, v122
  v_mfma_f32_32x32x16_bf16 v[136:151], v[180:183], v[20:23], v[136:151]
  ds_read_b128 v[172:175], v4 offset:9216
  v_exp_f32 v123, v123
  v_exp_f32 v124, v124
  v_exp_f32 v125, v125
  v_smfmac_f32_32x32x32_bf16 v[32:47], v[184:187], v[104:111], v8
  v_exp_f32 v126, v126
  v_exp_f32 v127, v127
  v_exp_f32 v128, v128
  v_smfmac_f32_16x16x64_bf16 v[64:67], v[12:15], v[104:111], v8
  v_exp_f32 v129, v129
  v_exp_f32 v130, v130
  v_smfmac_f32_32x32x32_bf16 v[32:47], v[188:191], v[112:119], v8
  v_exp_f32 v131, v131
  v_exp_f32 v132, v132
  v_exp_f32 v133, v133
  v_smfmac_f32_16x16x64_bf16 v[64:67], v[12:15], v[112:119], v8
  v_exp_f32 v134, v134
  v_exp_f32 v135, v135
  v_mfma_f32_32x32x16_bf16 v[152:167], v[176:179], v[24:27], v[88:103]
  ds_read_b128 v[192:195], v5 offset:6144
  v_exp_f32 v136, v136
  v_exp_f32 v137, v137
  v_exp_f32 v138, v138
  v_mfma_f32_32x32x16_bf16 v[152:167], v[180:183], v[28:31], v[152:167]
  ds_read_b128 v[196:199], v5 offset:7168
  v_exp_f32 v139, v139
  v_exp_f32 v140, v140
  v_exp_f32 v141, v141
  v_smfmac_f32_32x32x32_bf16 v[48:63], v[184:187], v[120:127], v8
  v_exp_f32 v142, v142
  v_exp_f32 v143, v143
  v_exp_f32 v144, v144
  v_smfmac_f32_16x16x64_bf16 v[68:71], v[12:15], v[120:127], v8
  v_exp_f32 v145, v145
  v_exp_f32 v146, v146
  v_smfmac_f32_32x32x32_bf16 v[48:63], v[188:191], v[128:135], v8
  v_exp_f32 v147, v147
  v_exp_f32 v148, v148
  v_exp_f32 v149, v149
  v_smfmac_f32_16x16x64_bf16 v[68:71], v[12:15], v[128:135], v8
  v_exp_f32 v150, v150
  v_exp_f32 v151, v151
  s_waitcnt lgkmcnt(0)
  v_mfma_f32_32x32x16_bf16 v[104:119], v[168:171], v[16:19], v[72:87]
  ds_read_b128 v[176:179], v4 offset:12288
  v_exp_f32 v152, v152
  v_exp_f32 v153, v153
  v_exp_f32 v154, v154
  v_mfma_f32_32x32x16_bf16 v[104:119], v[172:175], v[20:23], v[104:119]
  ds_read_b128 v[180:183], v4 offset:13312
  v_exp_f32 v155, v155
  v_exp_f32 v156, v156
  v_exp_f32 v157, v157
  v_smfmac_f32_32x32x32_bf16 v[32:47], v[192:195], v[136:143], v8
  v_exp_f32 v158, v158
  v_exp_f32 v159, v159
  v_exp_f32 v160, v160
  v_smfmac_f32_16x16x64_bf16 v[64:67], v[12:15], v[136:143], v8
  v_exp_f32 v161, v161
  v_exp_f32 v162, v162
  v_smfmac_f32_32x32x32_bf16 v[32:47], v[196:199], v[144:151], v8
  v_exp_f32 v163, v163
  v_exp_f32 v164, v164
  v_exp_f32 v165, v165
  v_smfmac_f32_16x16x64_bf16 v[64:67], v[12:15], v[144:151], v8
  v_exp_f32 v166, v166
  v_exp_f32 v167, v167
  v_mfma_f32_32x32x16_bf16 v[120:135], v[168:171], v[24:27], v[88:103]
  ds_read_b128 v[184:187], v5 offset:10240
  v_exp_f32 v104, v104
  v_exp_f32 v105, v105
  v_exp_f32 v106, v106
  v_mfma_f32_32x32x16_bf16 v[120:135], v[172:175], v[28:31], v[120:135]
  ds_read_b128 v[188:191], v5 offset:11264
  v_exp_f32 v107, v107
  v_exp_f32 v108, v108
  v_exp_f32 v109, v109
  v_smfmac_f32_32x32x32_bf16 v[48:63], v[192:195], v[152:159], v8
  v_exp_f32 v110, v110
  v_exp_f32 v111, v111
  v_exp_f32 v112, v112
  v_smfmac_f32_16x16x64_bf16 v[68:71], v[12:15], v[152:159], v8
  v_exp_f32 v113, v113
  v_exp_f32 v114, v114
  v_smfmac_f32_32x32x32_bf16 v[48:63], v[196:199], v[160:167], v8
  v_exp_f32 v115, v115
  v_exp_f32 v116, v116
  v_exp_f32 v117, v117
  v_smfmac_f32_16x16x64_bf16 v[68:71], v[12:15], v[160:167], v8
  v_exp_f32 v118, v118
  v_exp_f32 v119, v119
  s_waitcnt lgkmcnt(0)
  v_mfma_f32_32x32x16_bf16 v[136:151], v[176:179], v[16:19], v[72:87]
  ds_read_b128 v[168:171], v4 offset:16384
  v_exp_f32 v120, v120
  v_exp_f32 v121, v121
  v_exp_f32 v122, v122
  v_mfma_f32_32x32x16_bf16 v[136:151], v[180:183], v[20:23], v[136:151]
  ds_read_b128 v[172:175], v4 offset:17408
  v_exp_f32 v123, v123
  v_exp_f32 v124, v124
  v_exp_f32 v125, v125
  v_smfmac_f32_32x32x32_bf16 v[32:47], v[184:187], v[104:111], v8
  v_exp_f32 v126, v126
  v_exp_f32 v127, v127
  v_exp_f32 v128, v128
  v_smfmac_f32_16x16x64_bf16 v[64:67], v[12:15], v[104:111], v8
  v_exp_f32 v129, v129
  v_exp_f32 v130, v130
  v_smfmac_f32_32x32x32_bf16 v[32:47], v[188:191], v[112:119], v8
  v_exp_f32 v131, v131
  v_exp_f32 v132, v132
  v_exp_f32 v133, v133
  v_smfmac_f32_16x16x64_bf16 v[64:67], v[12:15], v[112:119], v8
  v_exp_f32 v134, v134
  v_exp_f32 v135, v135
  v_mfma_f32_32x32x16_bf16 v[152:167], v[176:179], v[24:27], v[88:103]
  ds_read_b128 v[192:195], v5 offset:14336
  v_exp_f32 v136, v136
  v_exp_f32 v137, v137
  v_exp_f32 v138, v138
  v_mfma_f32_32x32x16_bf16 v[152:167], v[180:183], v[28:31], v[152:167]
  ds_read_b128 v[196:199], v5 offset:15360
  v_exp_f32 v139, v139
  v_exp_f32 v140, v140
  v_exp_f32 v141, v141
  v_smfmac_f32_32x32x32_bf16 v[48:63], v[184:187], v[120:127], v8
  v_exp_f32 v142, v142
  v_exp_f32 v143, v143
  v_exp_f32 v144, v144
  v_smfmac_f32_16x16x64_bf16 v[68:71], v[12:15], v[120:127], v8
  v_exp_f32 v145, v145
  v_exp_f32 v146, v146
  v_smfmac_f32_32x32x32_bf16 v[48:63], v[188:191], v[128:135], v8
  v_exp_f32 v147, v147
  v_exp_f32 v148, v148
  v_exp_f32 v149, v149
  v_smfmac_f32_16x16x64_bf16 v[68:71], v[12:15], v[128:135], v8
  v_exp_f32 v150, v150
  v_exp_f32 v151, v151
  s_waitcnt lgkmcnt(0)
  v_mfma_f32_32x32x16_bf16 v[104:119], v[168:171], v[16:19], v[72:87]
  ds_read_b128 v[176:179], v4 offset:20480
  v_exp_f32 v152, v152
  v_exp_f32 v153, v153
  v_exp_f32 v154, v154
  v_mfma_f32_32x32x16_bf16 v[104:119], v[172:175], v[20:23], v[104:119]
  ds_read_b128 v[180:183], v4 offset:21504
  v_exp_f32 v155, v155
  v_exp_f32 v156, v156
  v_exp_f32 v157, v157
  v_smfmac_f32_32x32x32_bf16 v[32:47], v[192:195], v[136:143], v8
  v_exp_f32 v158, v158
  v_exp_f32 v159, v159
  v_exp_f32 v160, v160
  v_smfmac_f32_16x16x64_bf16 v[64:67], v[12:15], v[136:143], v8
  v_exp_f32 v161, v161
  v_exp_f32 v162, v162
  v_smfmac_f32_32x32x32_bf16 v[32:47], v[196:199], v[144:151], v8
  v_exp_f32 v163, v163
  v_exp_f32 v164, v164
  v_exp_f32 v165, v165
  v_smfmac_f32_16x16x64_bf16 v[64:67], v[12:15], v[144:151], v8
  v_exp_f32 v166, v166
  v_exp_f32 v167, v167
  v_mfma_f32_32x32x16_bf16 v[120:135], v[168:171], v[24:27], v[88:103]
  ds_read_b128 v[184:187], v5 offset:18432
  v_exp_f32 v104, v104
  v_exp_f32 v105, v105
  v_exp_f32 v106, v106
  v_mfma_f32_32x32x16_bf16 v[120:135], v[172:175], v[28:31], v[120:135]
  ds_read_b128 v[188:191], v5 offset:19456
  v_exp_f32 v107, v107
  v_exp_f32 v108, v108
  v_exp_f32 v109, v109
  v_smfmac_f32_32x32x32_bf16 v[48:63], v[192:195], v[152:159], v8
  v_exp_f32 v110, v110
  v_exp_f32 v111, v111
  v_exp_f32 v112, v112
  v_smfmac_f32_16x16x64_bf16 v[68:71], v[12:15], v[152:159], v8
  v_exp_f32 v113, v113
  v_exp_f32 v114, v114
  v_smfmac_f32_32x32x32_bf16 v[48:63], v[196:199], v[160:167], v8
  v_exp_f32 v115, v115
  v_exp_f32 v116, v116
  v_exp_f32 v117, v117
  v_smfmac_f32_16x16x64_bf16 v[68:71], v[12:15], v[160:167], v8
  v_exp_f32 v118, v118
  v_exp_f32 v119, v119
  s_waitcnt lgkmcnt(0)
  v_mfma_f32_32x32x16_bf16 v[136:151], v[176:179], v[16:19], v[72:87]
  ds_read_b128 v[168:171], v4 offset:24576
  v_exp_f32 v120, v120
  v_exp_f32 v121, v121
  v_exp_f32 v122, v122
  v_mfma_f32_32x32x16_bf16 v[136:151], v[180:183], v[20:23], v[136:151]
  ds_read_b128 v[172:175], v4 offset:25600
  v_exp_f32 v123, v123
  v_exp_f32 v124, v124
  v_exp_f32 v125, v125
  v_smfmac_f32_32x32x32_bf16 v[32:47], v[184:187], v[104:111], v8
  v_exp_f32 v126, v126
  v_exp_f32 v127, v127
  v_exp_f32 v128, v128
  v_smfmac_f32_16x16x64_bf16 v[64:67], v[12:15], v[104:111], v8
  v_exp_f32 v129, v129
  v_exp_f32 v130, v130
  v_smfmac_f32_32x32x32_bf16 v[32:47], v[188:191], v[112:119], v8
  v_exp_f32 v131, v131
  v_exp_f32 v132, v132
  v_exp_f32 v133, v133
  v_smfmac_f32_16x16x64_bf16 v[64:67], v[12:15], v[112:119], v8
  v_exp_f32 v134, v134
  v_exp_f32 v135, v135
  v_mfma_f32_32x32x16_bf16 v[152:167], v[176:179], v[24:27], v[88:103]
  ds_read_b128 v[192:195], v5 offset:22528
  v_exp_f32 v136, v136
  v_exp_f32 v137, v137
  v_exp_f32 v138, v138
  v_mfma_f32_32x32x16_bf16 v[152:167], v[180:183], v[28:31], v[152:167]
  ds_read_b128 v[196:199], v5 offset:23552
  v_exp_f32 v139, v139
  v_exp_f32 v140, v140
  v_exp_f32 v141, v141
  v_smfmac_f32_32x32x32_bf16 v[48:63], v[184:187], v[120:127], v8
  v_exp_f32 v142, v142
  v_exp_f32 v143, v143
  v_exp_f32 v144, v144
  v_smfmac_f32_16x16x64_bf16 v[68:71], v[12:15], v[120:127], v8
  v_exp_f32 v145, v145
  v_exp_f32 v146, v146
  v_smfmac_f32_32x32x32_bf16 v[48:63], v[188:191], v[128:135], v8
  v_exp_f32 v147, v147
  v_exp_f32 v148, v148
  v_exp_f32 v149, v149
  v_smfmac_f32_16x16x64_bf16 v[68:71], v[12:15], v[128:135], v8
  v_exp_f32 v150, v150
  v_exp_f32 v151, v151
  s_waitcnt lgkmcnt(0)
  v_mfma_f32_32x32x16_bf16 v[104:119], v[168:171], v[16:19], v[72:87]
  ds_read_b128 v[176:179], v4 offset:28672
  v_exp_f32 v152, v152
  v_exp_f32 v153, v153
  v_exp_f32 v154, v154
  v_mfma_f32_32x32x16_bf16 v[104:119], v[172:175], v[20:23], v[104:119]
  ds_read_b128 v[180:183], v4 offset:29696
  v_exp_f32 v155, v155
  v_exp_f32 v156, v156
  v_exp_f32 v157, v157
  v_smfmac_f32_32x32x32_bf16 v[32:47], v[192:195], v[136:143], v8
  v_exp_f32 v158, v158
  v_exp_f32 v159, v159
  v_exp_f32 v160, v160
  v_smfmac_f32_16x16x64_bf16 v[64:67], v[12:15], v[136:143], v8
  v_exp_f32 v161, v161
  v_exp_f32 v162, v162
  v_smfmac_f32_32x32x32_bf16 v[32:47], v[196:199], v[144:151], v8
  v_exp_f32 v163, v163
  v_exp_f32 v164, v164
  v_exp_f32 v165, v165
  v_smfmac_f32_16x16x64_bf16 v[64:67], v[12:15], v[144:151], v8
  v_exp_f32 v166, v166
  v_exp_f32 v167, v167
  v_mfma_f32_32x32x16_bf16 v[120:135], v[168:171], v[24:27], v[88:103]
  ds_read_b128 v[184:187], v5 offset:26624
  v_exp_f32 v104, v104
  v_exp_f32 v105, v105
  v_exp_f32 v106, v106
  v_mfma_f32_32x32x16_bf16 v[120:135], v[172:175], v[28:31], v[120:135]
  ds_read_b128 v[188:191], v5 offset:27648
  v_exp_f32 v107, v107
  v_exp_f32 v108, v108
  v_exp_f32 v109, v109
  v_smfmac_f32_32x32x32_bf16 v[48:63], v[192:195], v[152:159], v8
  v_exp_f32 v110, v110
  v_exp_f32 v111, v111
  v_exp_f32 v112, v112
  v_smfmac_f32_16x16x64_bf16 v[68:71], v[12:15], v[152:159], v8
  v_exp_f32 v113, v113
  v_exp_f32 v114, v114
  v_smfmac_f32_32x32x32_bf16 v[48:63], v[196:199], v[160:167], v8
  v_exp_f32 v115, v115
  v_exp_f32 v116, v116
  v_exp_f32 v117, v117
  v_smfmac_f32_16x16x64_bf16 v[68:71], v[12:15], v[160:167], v8
  v_exp_f32 v118, v118
  v_exp_f32 v119, v119
  s_waitcnt vmcnt(4)
  s_barrier
  v_add_u32 v4, 32768, v4
  v_and_b32 v4, 0x1ffff, v4
  s_waitcnt lgkmcnt(0)
  s_add_u32 m0, s63, 0
  v_mfma_f32_32x32x16_bf16 v[136:151], v[176:179], v[16:19], v[72:87]
  buffer_load_dwordx4 v6, s[48:51], s64 offen lds
  s_add_u32 s64, s64, 8192
  ds_read_b128 v[168:171], v4 offset:0
  v_exp_f32 v120, v120
  v_exp_f32 v121, v121
  v_exp_f32 v122, v122
  s_add_u32 m0, s63, 8192
  v_mfma_f32_32x32x16_bf16 v[136:151], v[180:183], v[20:23], v[136:151]
  buffer_load_dwordx4 v6, s[48:51], s64 offen lds
  s_add_u32 s64, s64, 8192
  ds_read_b128 v[172:175], v4 offset:1024
  v_exp_f32 v123, v123
  v_exp_f32 v124, v124
  v_exp_f32 v125, v125
  s_add_u32 m0, s63, 16384
  v_smfmac_f32_32x32x32_bf16 v[32:47], v[184:187], v[104:111], v8
  buffer_load_dwordx4 v6, s[48:51], s64 offen lds
  s_add_u32 s64, s64, 8192
  v_exp_f32 v126, v126
  v_exp_f32 v127, v127
  v_exp_f32 v128, v128
  s_add_u32 m0, s63, 24576
  v_smfmac_f32_16x16x64_bf16 v[64:67], v[12:15], v[104:111], v8
  buffer_load_dwordx4 v6, s[48:51], s64 offen lds
  s_add_u32 s64, s64, 8192
  s_add_u32 s63, s63, 32768
  s_and_b32 s63, s63, 0x1ffff
  v_exp_f32 v129, v129
  v_exp_f32 v130, v130
  v_smfmac_f32_32x32x32_bf16 v[32:47], v[188:191], v[112:119], v8
  v_exp_f32 v131, v131
  v_exp_f32 v132, v132
  v_exp_f32 v133, v133
  v_smfmac_f32_16x16x64_bf16 v[64:67], v[12:15], v[112:119], v8
  v_exp_f32 v134, v134
  v_exp_f32 v135, v135
  v_mfma_f32_32x32x16_bf16 v[152:167], v[176:179], v[24:27], v[88:103]
  ds_read_b128 v[192:195], v5 offset:30720
  v_exp_f32 v136, v136
  v_exp_f32 v137, v137
  v_exp_f32 v138, v138
  v_mfma_f32_32x32x16_bf16 v[152:167], v[180:183], v[28:31], v[152:167]
  ds_read_b128 v[196:199], v5 offset:31744
  v_exp_f32 v139, v139
  v_exp_f32 v140, v140
  v_exp_f32 v141, v141
  v_smfmac_f32_32x32x32_bf16 v[48:63], v[184:187], v[120:127], v8
  v_exp_f32 v142, v142
  v_exp_f32 v143, v143
  v_exp_f32 v144, v144
  v_smfmac_f32_16x16x64_bf16 v[68:71], v[12:15], v[120:127], v8
  v_exp_f32 v145, v145
  v_exp_f32 v146, v146
  v_smfmac_f32_32x32x32_bf16 v[48:63], v[188:191], v[128:135], v8
  v_exp_f32 v147, v147
  v_exp_f32 v148, v148
  v_exp_f32 v149, v149
  v_smfmac_f32_16x16x64_bf16 v[68:71], v[12:15], v[128:135], v8
  v_exp_f32 v150, v150
  v_exp_f32 v151, v151
  v_add_u32 v5, 32768, v5
  v_and_b32 v5, 0x1ffff, v5
  s_waitcnt lgkmcnt(0)
  v_mfma_f32_32x32x16_bf16 v[104:119], v[168:171], v[16:19], v[72:87]
  ds_read_b128 v[176:179], v4 offset:4096
  v_exp_f32 v152, v152
  v_exp_f32 v153, v153
  v_exp_f32 v154, v154
  v_mfma_f32_32x32x16_bf16 v[104:119], v[172:175], v[20:23], v[104:119]
  ds_read_b128 v[180:183], v4 offset:5120
  v_exp_f32 v155, v155
  v_exp_f32 v156, v156
  v_exp_f32 v157, v157
  v_smfmac_f32_32x32x32_bf16 v[32:47], v[192:195], v[136:143], v8
  v_exp_f32 v158, v158
  v_exp_f32 v159, v159
  v_exp_f32 v160, v160
  v_smfmac_f32_16x16x64_bf16 v[64:67], v[12:15], v[136:143], v8
  v_exp_f32 v161, v161
  v_exp_f32 v162, v162
  v_smfmac_f32_32x32x32_bf16 v[32:47], v[196:199], v[144:151], v8
  v_exp_f32 v163, v163
  v_exp_f32 v164, v164
  v_exp_f32 v165, v165
  v_smfmac_f32_16x16x64_bf16 v[64:67], v[12:15], v[144:151], v8
  v_exp_f32 v166, v166
  v_exp_f32 v167, v167
  s_sub_u32 s65, s65, 1
  s_cmp_lg_u32 s65, 0
  s_cbranch_scc1 aa_loop_146
  v_smfmac_f32_32x32x32_bf16 v[48:63], v[192:195], v[152:159], v8
  v_smfmac_f32_16x16x64_bf16 v[68:71], v[12:15], v[152:159], v8
  v_smfmac_f32_32x32x32_bf16 v[48:63], v[196:199], v[160:167], v8
  v_smfmac_f32_16x16x64_bf16 v[68:71], v[12:15], v[160:167], v8
  v_subrev_u32 v2, 0x1f800000, v64
  s_nop 6
  v_subrev_u32 v3, 0x1f800000, v68
  v_max_u32 v2, v2, v3
  v_cmp_lt_u32 vcc, 0x40000000, v2
  v_mov_b32 v2, 131072
  s_cbranch_vccz aa_ok_148
  ds_write_b32 v2, v2
aa_ok_148:
  s_waitcnt vmcnt(0) lgkmcnt(0)
  s_barrier
  ds_read_b32 v3, v2
  s_waitcnt lgkmcnt(0)
  v_readfirstlane_b32 s67, v3
  s_nop 0
  s_cmp_eq_u32 s67, 0
  s_cbranch_scc1 aa_done_147
  s_cmp_lg_u32 s66, 0
  s_cbranch_scc1 aa_done_147
  s_barrier
  s_mov_b32 s66, 1
  v_lshlrev_b32 v4, 4, v1
  v_mov_b32 v2, 0xff7fffff
  v_mov_b32 v3, 0xff7fffff
  s_mov_b32 s64, 0
aa_mx_149:
  buffer_load_dwordx4 v[168:171], v4, s[48:51], s64 offen
  buffer_load_dwordx4 v[172:175], v4, s[48:51], s64 offen offset:1024
  s_waitcnt vmcnt(0)
  v_mfma_f32_32x32x16_bf16 v[104:119], v[168:171], v[16:19], 0
  v_mfma_f32_32x32x16_bf16 v[104:119], v[172:175], v[20:23], v[104:119]
  v_mfma_f32_32x32x16_bf16 v[120:135], v[168:171], v[24:27], 0
  v_mfma_f32_32x32x16_bf16 v[120:135], v[172:175], v[28:31], v[120:135]
  s_nop 9
  v_max3_f32 v2, v2, v104, v105
  v_max3_f32 v2, v2, v106, v107
  v_max3_f32 v2, v2, v108, v109
  v_max3_f32 v2, v2, v110, v111
  v_max3_f32 v2, v2, v112, v113
  v_max3_f32 v2, v2, v114, v115
  v_max3_f32 v2, v2, v116, v117
  v_max3_f32 v2, v2, v118, v119
  v_max3_f32 v3, v3, v120, v121
  v_max3_f32 v3, v3, v122, v123
  v_max3_f32 v3, v3, v124, v125
  v_max3_f32 v3, v3, v126, v127
  v_max3_f32 v3, v3, v128, v129
  v_max3_f32 v3, v3, v130, v131
  v_max3_f32 v3, v3, v132, v133
  v_max3_f32 v3, v3, v134, v135
  s_add_u32 s64, s64, 4096
  s_cmp_lt_u32 s64, 262144
  s_cbranch_scc1 aa_mx_149
  v_mov_b32 v104, v2
  s_nop 1
  v_permlane32_swap_b32 v104, v2
  v_max_f32 v104, v104, v2
  v_sub_f32 v72, 0, v104
  v_sub_f32 v73, 0, v104
  v_sub_f32 v74, 0, v104
  v_sub_f32 v75, 0, v104
  v_sub_f32 v76, 0, v104
  v_sub_f32 v77, 0, v104
  v_sub_f32 v78, 0, v104
  v_sub_f32 v79, 0, v104
  v_sub_f32 v80, 0, v104
  v_sub_f32 v81, 0, v104
  v_sub_f32 v82, 0, v104
  v_sub_f32 v83, 0, v104
  v_sub_f32 v84, 0, v104
  v_sub_f32 v85, 0, v104
  v_sub_f32 v86, 0, v104
  v_sub_f32 v87, 0, v104
  v_mov_b32 v104, v3
  s_nop 1
  v_permlane32_swap_b32 v104, v3
  v_max_f32 v104, v104, v3
  v_sub_f32 v88, 0, v104
  v_sub_f32 v89, 0, v104
  v_sub_f32 v90, 0, v104
  v_sub_f32 v91, 0, v104
  v_sub_f32 v92, 0, v104
  v_sub_f32 v93, 0, v104
  v_sub_f32 v94, 0, v104
  v_sub_f32 v95, 0, v104
  v_sub_f32 v96, 0, v104
  v_sub_f32 v97, 0, v104
  v_sub_f32 v98, 0, v104
  v_sub_f32 v99, 0, v104
  v_sub_f32 v100, 0, v104
  v_sub_f32 v101, 0, v104
  v_sub_f32 v102, 0, v104
  v_sub_f32 v103, 0, v104
  s_branch aa_re_145
aa_done_147:
  s_cmp_lg_u32 s20, 0
  s_cbranch_scc1 w_pop_150
  s_mov_b64 exec, 1
  v_mov_b32 v255, 1
  buffer_atomic_add v255, off, s[8:11], s28 sc0 sc1
  s_mov_b64 exec, -1
w_pop_150:
  s_mul_i32 s67, s62, 2048
  v_rcp_f32 v2, v64
  s_nop 0
  v_mul_f32 v2, v2, v10
  v_mul_f32 v32, v2, v32
  v_mul_f32 v33, v2, v33
  v_mul_f32 v34, v2, v34
  v_mul_f32 v35, v2, v35
  v_mul_f32 v36, v2, v36
  v_mul_f32 v37, v2, v37
  v_mul_f32 v38, v2, v38
  v_mul_f32 v39, v2, v39
  v_mul_f32 v40, v2, v40
  v_mul_f32 v41, v2, v41
  v_mul_f32 v42, v2, v42
  v_mul_f32 v43, v2, v43
  v_mul_f32 v44, v2, v44
  v_mul_f32 v45, v2, v45
  v_mul_f32 v46, v2, v46
  v_mul_f32 v47, v2, v47
  v_cvt_pk_bf16_f32 v32, v32, v33
  v_cvt_pk_bf16_f32 v33, v34, v35
  v_cvt_pk_bf16_f32 v34, v36, v37
  v_cvt_pk_bf16_f32 v35, v38, v39
  v_cvt_pk_bf16_f32 v36, v40, v41
  v_cvt_pk_bf16_f32 v37, v42, v43
  v_cvt_pk_bf16_f32 v38, v44, v45
  v_cvt_pk_bf16_f32 v39, v46, v47
  buffer_store_dwordx4 v[32:35], v7, s[56:59], s67 offen sc1
  buffer_store_dwordx4 v[36:39], v7, s[56:59], s67 offen offset:16 sc1
  s_add_u32 s67, s67, 2048
  v_rcp_f32 v2, v68
  s_nop 0
  v_mul_f32 v2, v2, v11
  v_mul_f32 v48, v2, v48
  v_mul_f32 v49, v2, v49
  v_mul_f32 v50, v2, v50
  v_mul_f32 v51, v2, v51
  v_mul_f32 v52, v2, v52
  v_mul_f32 v53, v2, v53
  v_mul_f32 v54, v2, v54
  v_mul_f32 v55, v2, v55
  v_mul_f32 v56, v2, v56
  v_mul_f32 v57, v2, v57
  v_mul_f32 v58, v2, v58
  v_mul_f32 v59, v2, v59
  v_mul_f32 v60, v2, v60
  v_mul_f32 v61, v2, v61
  v_mul_f32 v62, v2, v62
  v_mul_f32 v63, v2, v63
  v_cvt_pk_bf16_f32 v48, v48, v49
  v_cvt_pk_bf16_f32 v49, v50, v51
  v_cvt_pk_bf16_f32 v50, v52, v53
  v_cvt_pk_bf16_f32 v51, v54, v55
  v_cvt_pk_bf16_f32 v52, v56, v57
  v_cvt_pk_bf16_f32 v53, v58, v59
  v_cvt_pk_bf16_f32 v54, v60, v61
  v_cvt_pk_bf16_f32 v55, v62, v63
  buffer_store_dwordx4 v[48:51], v7, s[56:59], s67 offen sc1
  buffer_store_dwordx4 v[52:55], v7, s[56:59], s67 offen offset:16 sc1
  s_add_u32 s67, s67, 2048
  s_branch w_next_87
w_att_103h:
  s_lshl_b32 s60, s6, 6
  s_add_u32 s60, s60, s7
  s_lshr_b32 s32, s60, 4
  s_lshl_b32 s29, s32, 7
  s_add_u32 s29, s29, 124790784
  s_mov_b32 s30, 1
  s_lshr_b32 s32, s60, 5
  s_lshl_b32 s32, s32, 7
  s_add_u32 s32, s32, 124788736
  s_mov_b32 s33, 124789760
  s_cmp_lg_u32 s20, 0
  s_cbranch_scc1 dpx_152
  s_mov_b32 s31, 400000
dp_151:
  buffer_load_dword v1, off, s[24:27], s32 sc1
  buffer_load_dword v2, off, s[24:27], s33 sc1
  s_sub_u32 s31, s31, 1
  s_cbranch_scc1 fused_kernel_end
  s_waitcnt vmcnt(0)
  v_cmp_gt_u32 vcc, 4, v1
  s_cbranch_vccnz dp_151_s
  v_cmp_gt_u32 vcc, 16, v2
  s_cbranch_vccnz dp_151_s
  s_branch dpx_152
dp_151_s:
  s_sleep 8
  s_branch dp_151
dpx_152:
  s_barrier
  s_add_u32 s44, s4, 50331648
  s_addc_u32 s45, s5, 0
  s_and_b32 s45, s45, 0xffff
  s_mov_b32 s46, 4194304
  s_mov_b32 s47, 0x20000
  s_add_u32 s48, s4, 54525952
  s_addc_u32 s49, s5, 0
  s_and_b32 s49, s49, 0xffff
  s_mov_b32 s50, 262144
  s_mov_b32 s51, 0x20000
  s_add_u32 s52, s4, 54788096
  s_addc_u32 s53, s5, 0
  s_and_b32 s53, s53, 0xffff
  s_mov_b32 s54, 16384
  s_mov_b32 s55, 0x20000
  s_add_u32 s56, s4, 67108864
  s_addc_u32 s57, s5, 0
  s_and_b32 s57, s57, 0xffff
  s_mov_b32 s58, 4194304
  s_mov_b32 s59, 0x20000
  v_and_b32 v1, 63, v0
  v_lshlrev_b32 v6, 4, v0
  s_and_b32 s67, s20, 3
  s_lshl_b32 s62, s60, 2
  s_add_u32 s62, s62, s67
  s_lshl_b32 s62, s62, 1
  s_lshr_b32 s67, s20, 2
  s_add_u32 s62, s62, s67
  v_and_b32 v2, 31, v1
  v_lshrrev_b32 v3, 5, v1
  v_lshlrev_b32 v7, 6, v2
  v_lshl_add_u32 v7, v3, 5, v7
  s_lshl_b32 s67, s62, 11
  buffer_load_dwordx4 v[16:19], v7, s[44:47], s67 offen offset:0
  buffer_load_dwordx4 v[20:23], v7, s[44:47], s67 offen offset:16
  s_xor_b32 s67, s67, 2048
  buffer_load_dwordx4 v[24:27], v7, s[44:47], s67 offen offset:0
  buffer_load_dwordx4 v[28:31], v7, s[44:47], s67 offen offset:16
  s_lshl_b32 s67, s62, 2
  v_mov_b32 v2, s67
  buffer_load_dword v10, v2, s[52:55], 0 offen
  v_mov_b32 v8, 0xdddddddd
  v_and_b32 v2, 7, v1
  v_mov_b32 v3, 0x3f803f80
  v_cmp_eq_u32 vcc, 0, v2
  s_nop 1
  v_cndmask_b32 v12, 0, v3, vcc
  v_cndmask_b32 v13, 0, v3, vcc
  v_cmp_eq_u32 vcc, 4, v2
  s_nop 1
  v_cndmask_b32 v14, 0, v3, vcc
  v_cndmask_b32 v15, 0, v3, vcc
  v_mov_b32 v72, 0
  v_mov_b32 v73, 0
  v_mov_b32 v74, 0
  v_mov_b32 v75, 0
  v_mov_b32 v76, 0
  v_mov_b32 v77, 0
  v_mov_b32 v78, 0
  v_mov_b32 v79, 0
  v_mov_b32 v80, 0
  v_mov_b32 v81, 0
  v_mov_b32 v82, 0
  v_mov_b32 v83, 0
  v_mov_b32 v84, 0
  v_mov_b32 v85, 0
  v_mov_b32 v86, 0
  v_mov_b32 v87, 0
  v_mov_b32 v88, 0
  v_mov_b32 v89, 0
  v_mov_b32 v90, 0
  v_mov_b32 v91, 0
  v_mov_b32 v92, 0
  v_mov_b32 v93, 0
  v_mov_b32 v94, 0
  v_mov_b32 v95, 0
  v_mov_b32 v96, 0
  v_mov_b32 v97, 0
  v_mov_b32 v98, 0
  v_mov_b32 v99, 0
  v_mov_b32 v100, 0
  v_mov_b32 v101, 0
  v_mov_b32 v102, 0
  v_mov_b32 v103, 0
  s_mov_b32 s66, 0
aa_re_153:
  s_lshl_b32 s63, s20, 10
  s_mov_b32 s64, 0
  s_add_u32 m0, s63, 0
  s_nop 0
  buffer_load_dwordx4 v6, s[48:51], s64 offen lds
  s_add_u32 s64, s64, 8192
  s_add_u32 m0, s63, 8192
  s_nop 0
  buffer_load_dwordx4 v6, s[48:51], s64 offen lds
  s_add_u32 s64, s64, 8192
  s_add_u32 m0, s63, 16384
  s_nop 0
  buffer_load_dwordx4 v6, s[48:51], s64 offen lds
  s_add_u32 s64, s64, 8192
  s_add_u32 m0, s63, 24576
  s_nop 0
  buffer_load_dwordx4 v6, s[48:51], s64 offen lds
  s_add_u32 s64, s64, 8192
  s_add_u32 s63, s63, 32768
  s_and_b32 s63, s63, 0x1ffff
  s_add_u32 m0, s63, 0
  s_nop 0
  buffer_load_dwordx4 v6, s[48:51], s64 offen lds
  s_add_u32 s64, s64, 8192
  s_add_u32 m0, s63, 8192
  s_nop 0
  buffer_load_dwordx4 v6, s[48:51], s64 offen lds
  s_add_u32 s64, s64, 8192
  s_add_u32 m0, s63, 16384
  s_nop 0
  buffer_load_dwordx4 v6, s[48:51], s64 offen lds
  s_add_u32 s64, s64, 8192
  s_add_u32 m0, s63, 24576
  s_nop 0
  buffer_load_dwordx4 v6, s[48:51], s64 offen lds
  s_add_u32 s64, s64, 8192
  s_add_u32 s63, s63, 32768
  s_and_b32 s63, s63, 0x1ffff
  s_add_u32 m0, s63, 0
  s_nop 0
  buffer_load_dwordx4 v6, s[48:51], s64 offen lds
  s_add_u32 s64, s64, 8192
  s_add_u32 m0, s63, 8192
  s_nop 0
  buffer_load_dwordx4 v6, s[48:51], s64 offen lds
  s_add_u32 s64, s64, 8192
  s_add_u32 m0, s63, 16384
  s_nop 0
  buffer_load_dwordx4 v6, s[48:51], s64 offen lds
  s_add_u32 s64, s64, 8192
  s_add_u32 m0, s63, 24576
  s_nop 0
  buffer_load_dwordx4 v6, s[48:51], s64 offen lds
  s_add_u32 s64, s64, 8192
  s_add_u32 s63, s63, 32768
  s_and_b32 s63, s63, 0x1ffff
  v_mov_b32 v32, 0
  v_mov_b32 v33, 0
  v_mov_b32 v34, 0
  v_mov_b32 v35, 0
  v_mov_b32 v36, 0
  v_mov_b32 v37, 0
  v_mov_b32 v38, 0
  v_mov_b32 v39, 0
  v_mov_b32 v40, 0
  v_mov_b32 v41, 0
  v_mov_b32 v42, 0
  v_mov_b32 v43, 0
  v_mov_b32 v44, 0
  v_mov_b32 v45, 0
  v_mov_b32 v46, 0
  v_mov_b32 v47, 0
  v_mov_b32 v48, 0
  v_mov_b32 v49, 0
  v_mov_b32 v50, 0
  v_mov_b32 v51, 0
  v_mov_b32 v52, 0
  v_mov_b32 v53, 0
  v_mov_b32 v54, 0
  v_mov_b32 v55, 0
  v_mov_b32 v56, 0
  v_mov_b32 v57, 0
  v_mov_b32 v58, 0
  v_mov_b32 v59, 0
  v_mov_b32 v60, 0
  v_mov_b32 v61, 0
  v_mov_b32 v62, 0
  v_mov_b32 v63, 0
  v_mov_b32 v64, 0
  v_mov_b32 v65, 0
  v_mov_b32 v66, 0
  v_mov_b32 v67, 0
  v_mov_b32 v68, 0
  v_mov_b32 v69, 0
  v_mov_b32 v70, 0
  v_mov_b32 v71, 0
  v_mov_b32 v152, 0
  v_mov_b32 v153, 0
  v_mov_b32 v154, 0
  v_mov_b32 v155, 0
  v_mov_b32 v156, 0
  v_mov_b32 v157, 0
  v_mov_b32 v158, 0
  v_mov_b32 v159, 0
  v_mov_b32 v160, 0
  v_mov_b32 v161, 0
  v_mov_b32 v162, 0
  v_mov_b32 v163, 0
  v_mov_b32 v164, 0
  v_mov_b32 v165, 0
  v_mov_b32 v166, 0
  v_mov_b32 v167, 0
  v_mov_b32 v192, 0
  v_mov_b32 v193, 0
  v_mov_b32 v194, 0
  v_mov_b32 v195, 0
  v_mov_b32 v196, 0
  v_mov_b32 v197, 0
  v_mov_b32 v198, 0
  v_mov_b32 v199, 0
  s_lshr_b32 s67, s20, 2
  s_lshl_b32 s67, s67, 12
  v_lshl_add_u32 v4, v1, 4, s67
  v_mov_b32 v5, v4
  v_mov_b32 v2, 131072
  v_mov_b32 v3, 0
  ds_write_b32 v2, v3
  s_waitcnt vmcnt(8) lgkmcnt(0)
  s_barrier
  ds_read_b128 v[168:171], v4 offset:0
  ds_read_b128 v[172:175], v4 offset:1024
  ds_read_b128 v[176:179], v4 offset:8192
  ds_read_b128 v[180:183], v4 offset:9216
  s_waitcnt lgkmcnt(2)
  v_mfma_f32_32x32x16_bf16 v[104:119], v[168:171], v[16:19], v[72:87]
  v_mfma_f32_32x32x16_bf16 v[104:119], v[172:175], v[20:23], v[104:119]
  s_mov_b32 s65, 4
  s_nop 9
aa_loop_154:
  v_mfma_f32_32x32x16_bf16 v[120:135], v[168:171], v[24:27], v[88:103]
  ds_read_b128 v[184:187], v5 offset:2048
  v_exp_f32 v104, v104
  v_exp_f32 v105, v105
  v_exp_f32 v106, v106
  v_mfma_f32_32x32x16_bf16 v[120:135], v[172:175], v[28:31], v[120:135]
  ds_read_b128 v[188:191], v5 offset:3072
  v_exp_f32 v107, v107
  v_exp_f32 v108, v108
  v_exp_f32 v109, v109
  v_smfmac_f32_32x32x32_bf16 v[48:63], v[192:195], v[152:159], v8
  v_exp_f32 v110, v110
  v_exp_f32 v111, v111
  v_exp_f32 v112, v112
  v_smfmac_f32_16x16x64_bf16 v[68:71], v[12:15], v[152:159], v8
  v_exp_f32 v113, v113
  v_exp_f32 v114, v114
  v_smfmac_f32_32x32x32_bf16 v[48:63], v[196:199], v[160:167], v8
  v_exp_f32 v115, v115
  v_exp_f32 v116, v116
  v_exp_f32 v117, v117
  v_smfmac_f32_16x16x64_bf16 v[68:71], v[12:15], v[160:167], v8
  v_exp_f32 v118, v118
  v_exp_f32 v119, v119
  s_waitcnt lgkmcnt(0)
  v_mfma_f32_32x32x16_bf16 v[136:151], v[176:179], v[16:19], v[72:87]
  ds_read_b128 v[168:171], v4 offset:16384
  v_exp_f32 v120, v120
  v_exp_f32 v121, v121
  v_exp_f32 v122, v122
  v_mfma_f32_32x32x16_bf16 v[136:151], v[180:183], v[20:23], v[136:151]
  ds_read_b128 v[172:175], v4 offset:17408
  v_exp_f32 v123, v123
  v_exp_f32 v124, v124
  v_exp_f32 v125, v125
  v_smfmac_f32_32x32x32_bf16 v[32:47], v[184:187], v[104:111], v8
  v_exp_f32 v126, v126
  v_exp_f32 v127, v127
  v_exp_f32 v128, v128
  v_smfmac_f32_16x16x64_bf16 v[64:67], v[12:15], v[104:111], v8
  v_exp_f32 v129, v129
  v_exp_f32 v130, v130
  v_smfmac_f32_32x32x32_bf16 v[32:47], v[188:191], v[112:119], v8
  v_exp_f32 v131, v131
  v_exp_f32 v132, v132
  v_exp_f32 v133, v133
  v_smfmac_f32_16x16x64_bf16 v[64:67], v[12:15], v[112:119], v8
  v_exp_f32 v134, v134
  v_exp_f32 v135, v135
  v_mfma_f32_32x32x16_bf16 v[152:167], v[176:179], v[24:27], v[88:103]
  ds_read_b128 v[192:195], v5 offset:10240
  v_exp_f32 v136, v136
  v_exp_f32 v137, v137
  v_exp_f32 v138, v138
  v_mfma_f32_32x32x16_bf16 v[152:167], v[180:183], v[28:31], v[152:167]
  ds_read_b128 v[196:199], v5 offset:11264
  v_exp_f32 v139, v139
  v_exp_f32 v140, v140
  v_exp_f32 v141, v141
  v_smfmac_f32_32x32x32_bf16 v[48:63], v[184:187], v[120:127], v8
  v_exp_f32 v142, v142
  v_exp_f32 v143, v143
  v_exp_f32 v144, v144
  v_smfmac_f32_16x16x64_bf16 v[68:71], v[12:15], v[120:127], v8
  v_exp_f32 v145, v145
  v_exp_f32 v146, v146
  v_smfmac_f32_32x32x32_bf16 v[48:63], v[188:191], v[128:135], v8
  v_exp_f32 v147, v147
  v_exp_f32 v148, v148
  v_exp_f32 v149, v149
  v_smfmac_f32_16x16x64_bf16 v[68:71], v[12:15], v[128:135], v8
  v_exp_f32 v150, v150
  v_exp_f32 v151, v151
  s_waitcnt lgkmcnt(0)
  v_mfma_f32_32x32x16_bf16 v[104:119], v[168:171], v[16:19], v[72:87]
  ds_read_b128 v[176:179], v4 offset:24576
  v_exp_f32 v152, v152
  v_exp_f32 v153, v153
  v_exp_f32 v154, v154
  v_mfma_f32_32x32x16_bf16 v[104:119], v[172:175], v[20:23], v[104:119]
  ds_read_b128 v[180:183], v4 offset:25600
  v_exp_f32 v155, v155
  v_exp_f32 v156, v156
  v_exp_f32 v157, v157
  v_smfmac_f32_32x32x32_bf16 v[32:47], v[192:195], v[136:143], v8
  v_exp_f32 v158, v158
  v_exp_f32 v159, v159
  v_exp_f32 v160, v160
  v_smfmac_f32_16x16x64_bf16 v[64:67], v[12:15], v[136:143], v8
  v_exp_f32 v161, v161
  v_exp_f32 v162, v162
  v_smfmac_f32_32x32x32_bf16 v[32:47], v[196:199], v[144:151], v8
  v_exp_f32 v163, v163
  v_exp_f32 v164, v164
  v_exp_f32 v165, v165
  v_smfmac_f32_16x16x64_bf16 v[64:67], v[12:15], v[144:151], v8
  v_exp_f32 v166, v166
  v_exp_f32 v167, v167
  v_mfma_f32_32x32x16_bf16 v[120:135], v[168:171], v[24:27], v[88:103]
  ds_read_b128 v[184:187], v5 offset:18432
  v_exp_f32 v104, v104
  v_exp_f32 v105, v105
  v_exp_f32 v106, v106
  v_mfma_f32_32x32x16_bf16 v[120:135], v[172:175], v[28:31], v[120:135]
  ds_read_b128 v[188:191], v5 offset:19456
  v_exp_f32 v107, v107
  v_exp_f32 v108, v108
  v_exp_f32 v109, v109
  v_smfmac_f32_32x32x32_bf16 v[48:63], v[192:195], v[152:159], v8
  v_exp_f32 v110, v110
  v_exp_f32 v111, v111
  v_exp_f32 v112, v112
  v_smfmac_f32_16x16x64_bf16 v[68:71], v[12:15], v[152:159], v8
  v_exp_f32 v113, v113
  v_exp_f32 v114, v114
  v_smfmac_f32_32x32x32_bf16 v[48:63], v[196:199], v[160:167], v8
  v_exp_f32 v115, v115
  v_exp_f32 v116, v116
  v_exp_f32 v117, v117
  v_smfmac_f32_16x16x64_bf16 v[68:71], v[12:15], v[160:167], v8
  v_exp_f32 v118, v118
  v_exp_f32 v119, v119
  s_waitcnt vmcnt(4)
  s_barrier
  v_add_u32 v4, 32768, v4
  v_and_b32 v4, 0x1ffff, v4
  s_waitcnt lgkmcnt(0)
  s_add_u32 m0, s63, 0
  v_mfma_f32_32x32x16_bf16 v[136:151], v[176:179], v[16:19], v[72:87]
  buffer_load_dwordx4 v6, s[48:51], s64 offen lds
  s_add_u32 s64, s64, 8192
  ds_read_b128 v[168:171], v4 offset:0
  v_exp_f32 v120, v120
  v_exp_f32 v121, v121
  v_exp_f32 v122, v122
  s_add_u32 m0, s63, 8192
  v_mfma_f32_32x32x16_bf16 v[136:151], v[180:183], v[20:23], v[136:151]
  buffer_load_dwordx4 v6, s[48:51], s64 offen lds
  s_add_u32 s64, s64, 8192
  ds_read_b128 v[172:175], v4 offset:1024
  v_exp_f32 v123, v123
  v_exp_f32 v124, v124
  v_exp_f32 v125, v125
  s_add_u32 m0, s63, 16384
  v_smfmac_f32_32x32x32_bf16 v[32:47], v[184:187], v[104:111], v8
  buffer_load_dwordx4 v6, s[48:51], s64 offen lds
  s_add_u32 s64, s64, 8192
  v_exp_f32 v126, v126
  v_exp_f32 v127, v127
  v_exp_f32 v128, v128
  s_add_u32 m0, s63, 24576
  v_smfmac_f32_16x16x64_bf16 v[64:67], v[12:15], v[104:111], v8
  buffer_load_dwordx4 v6, s[48:51], s64 offen lds
  s_add_u32 s64, s64, 8192
  s_add_u32 s63, s63, 32768
  s_and_b32 s63, s63, 0x1ffff
  v_exp_f32 v129, v129
  v_exp_f32 v130, v130
  v_smfmac_f32_32x32x32_bf16 v[32:47], v[188:191], v[112:119], v8
  v_exp_f32 v131, v131
  v_exp_f32 v132, v132
  v_exp_f32 v133, v133
  v_smfmac_f32_16x16x64_bf16 v[64:67], v[12:15], v[112:119], v8
  v_exp_f32 v134, v134
  v_exp_f32 v135, v135
  v_mfma_f32_32x32x16_bf16 v[152:167], v[176:179], v[24:27], v[88:103]
  ds_read_b128 v[192:195], v5 offset:26624
  v_exp_f32 v136, v136
  v_exp_f32 v137, v137
  v_exp_f32 v138, v138
  v_mfma_f32_32x32x16_bf16 v[152:167], v[180:183], v[28:31], v[152:167]
  ds_read_b128 v[196:199], v5 offset:27648
  v_exp_f32 v139, v139
  v_exp_f32 v140, v140
  v_exp_f32 v141, v141
  v_smfmac_f32_32x32x32_bf16 v[48:63], v[184:187], v[120:127], v8
  v_exp_f32 v142, v142
  v_exp_f32 v143, v143
  v_exp_f32 v144, v144
  v_smfmac_f32_16x16x64_bf16 v[68:71], v[12:15], v[120:127], v8
  v_exp_f32 v145, v145
  v_exp_f32 v146, v146
  v_smfmac_f32_32x32x32_bf16 v[48:63], v[188:191], v[128:135], v8
  v_exp_f32 v147, v147
  v_exp_f32 v148, v148
  v_exp_f32 v149, v149
  v_smfmac_f32_16x16x64_bf16 v[68:71], v[12:15], v[128:135], v8
  v_exp_f32 v150, v150
  v_exp_f32 v151, v151
  v_add_u32 v5, 32768, v5
  v_and_b32 v5, 0x1ffff, v5
  s_waitcnt lgkmcnt(0)
  v_mfma_f32_32x32x16_bf16 v[104:119], v[168:171], v[16:19], v[72:87]
  ds_read_b128 v[176:179], v4 offset:8192
  v_exp_f32 v152, v152
  v_exp_f32 v153, v153
  v_exp_f32 v154, v154
  v_mfma_f32_32x32x16_bf16 v[104:119], v[172:175], v[20:23], v[104:119]
  ds_read_b128 v[180:183], v4 offset:9216
  v_exp_f32 v155, v155
  v_exp_f32 v156, v156
  v_exp_f32 v157, v157
  v_smfmac_f32_32x32x32_bf16 v[32:47], v[192:195], v[136:143], v8
  v_exp_f32 v158, v158
  v_exp_f32 v159, v159
  v_exp_f32 v160, v160
  v_smfmac_f32_16x16x64_bf16 v[64:67], v[12:15], v[136:143], v8
  v_exp_f32 v161, v161
  v_exp_f32 v162, v162
  v_smfmac_f32_32x32x32_bf16 v[32:47], v[196:199], v[144:151], v8
  v_exp_f32 v163, v163
  v_exp_f32 v164, v164
  v_exp_f32 v165, v165
  v_smfmac_f32_16x16x64_bf16 v[64:67], v[12:15], v[144:151], v8
  v_exp_f32 v166, v166
  v_exp_f32 v167, v167
  v_mfma_f32_32x32x16_bf16 v[120:135], v[168:171], v[24:27], v[88:103]
  ds_read_b128 v[184:187], v5 offset:2048
  v_exp_f32 v104, v104
  v_exp_f32 v105, v105
  v_exp_f32 v106, v106
  v_mfma_f32_32x32x16_bf16 v[120:135], v[172:175], v[28:31], v[120:135]
  ds_read_b128 v[188:191], v5 offset:3072
  v_exp_f32 v107, v107
  v_exp_f32 v108, v108
  v_exp_f32 v109, v109
  v_smfmac_f32_32x32x32_bf16 v[48:63], v[192:195], v[152:159], v8
  v_exp_f32 v110, v110
  v_exp_f32 v111, v111
  v_exp_f32 v112, v112
  v_smfmac_f32_16x16x64_bf16 v[68:71], v[12:15], v[152:159], v8
  v_exp_f32 v113, v113
  v_exp_f32 v114, v114
  v_smfmac_f32_32x32x32_bf16 v[48:63], v[196:199], v[160:167], v8
  v_exp_f32 v115, v115
  v_exp_f32 v116, v116
  v_exp_f32 v117, v117
  v_smfmac_f32_16x16x64_bf16 v[68:71], v[12:15], v[160:167], v8
  v_exp_f32 v118, v118
  v_exp_f32 v119, v119
  s_waitcnt lgkmcnt(0)
  v_mfma_f32_32x32x16_bf16 v[136:151], v[176:179], v[16:19], v[72:87]
  ds_read_b128 v[168:171], v4 offset:16384
  v_exp_f32 v120, v120
  v_exp_f32 v121, v121
  v_exp_f32 v122, v122
  v_mfma_f32_32x32x16_bf16 v[136:151], v[180:183], v[20:23], v[136:151]
  ds_read_b128 v[172:175], v4 offset:17408
  v_exp_f32 v123, v123
  v_exp_f32 v124, v124
  v_exp_f32 v125, v125
  v_smfmac_f32_32x32x32_bf16 v[32:47], v[184:187], v[104:111], v8
  v_exp_f32 v126, v126
  v_exp_f32 v127, v127
  v_exp_f32 v128, v128
  v_smfmac_f32_16x16x64_bf16 v[64:67], v[12:15], v[104:111], v8
  v_exp_f32 v129, v129
  v_exp_f32 v130, v130
  v_smfmac_f32_32x32x32_bf16 v[32:47], v[188:191], v[112:119], v8
  v_exp_f32 v131, v131
  v_exp_f32 v132, v132
  v_exp_f32 v133, v133
  v_smfmac_f32_16x16x64_bf16 v[64:67], v[12:15], v[112:119], v8
  v_exp_f32 v134, v134
  v_exp_f32 v135, v135
  v_mfma_f32_32x32x16_bf16 v[152:167], v[176:179], v[24:27], v[88:103]
  ds_read_b128 v[192:195], v5 offset:10240
  v_exp_f32 v136, v136
  v_exp_f32 v137, v137
  v_exp_f32 v138, v138
  v_mfma_f32_32x32x16_bf16 v[152:167], v[180:183], v[28:31], v[152:167]
  ds_read_b128 v[196:199], v5 offset:11264
  v_exp_f32 v139, v139
  v_exp_f32 v140, v140
  v_exp_f32 v141, v141
  v_smfmac_f32_32x32x32_bf16 v[48:63], v[184:187], v[120:127], v8
  v_exp_f32 v142, v142
  v_exp_f32 v143, v143
  v_exp_f32 v144, v144
  v_smfmac_f32_16x16x64_bf16 v[68:71], v[12:15], v[120:127], v8
  v_exp_f32 v145, v145
  v_exp_f32 v146, v146
  v_smfmac_f32_32x32x32_bf16 v[48:63], v[188:191], v[128:135], v8
  v_exp_f32 v147, v147
  v_exp_f32 v148, v148
  v_exp_f32 v149, v149
  v_smfmac_f32_16x16x64_bf16 v[68:71], v[12:15], v[128:135], v8
  v_exp_f32 v150, v150
  v_exp_f32 v151, v151
  s_waitcnt lgkmcnt(0)
  v_mfma_f32_32x32x16_bf16 v[104:119], v[168:171], v[16:19], v[72:87]
  ds_read_b128 v[176:179], v4 offset:24576
  v_exp_f32 v152, v152
  v_exp_f32 v153, v153
  v_exp_f32 v154, v154
  v_mfma_f32_32x32x16_bf16 v[104:119], v[172:175], v[20:23], v[104:119]
  ds_read_b128 v[180:183], v4 offset:25600
  v_exp_f32 v155, v155
  v_exp_f32 v156, v156
  v_exp_f32 v157, v157
  v_smfmac_f32_32x32x32_bf16 v[32:47], v[192:195], v[136:143], v8
  v_exp_f32 v158, v158
  v_exp_f32 v159, v159
  v_exp_f32 v160, v160
  v_smfmac_f32_16x16x64_bf16 v[64:67], v[12:15], v[136:143], v8
  v_exp_f32 v161, v161
  v_exp_f32 v162, v162
  v_smfmac_f32_32x32x32_bf16 v[32:47], v[196:199], v[144:151], v8
  v_exp_f32 v163, v163
  v_exp_f32 v164, v164
  v_exp_f32 v165, v165
  v_smfmac_f32_16x16x64_bf16 v[64:67], v[12:15], v[144:151], v8
  v_exp_f32 v166, v166
  v_exp_f32 v167, v167
  v_mfma_f32_32x32x16_bf16 v[120:135], v[168:171], v[24:27], v[88:103]
  ds_read_b128 v[184:187], v5 offset:18432
  v_exp_f32 v104, v104
  v_exp_f32 v105, v105
  v_exp_f32 v106, v106
  v_mfma_f32_32x32x16_bf16 v[120:135], v[172:175], v[28:31], v[120:135]
  ds_read_b128 v[188:191], v5 offset:19456
  v_exp_f32 v107, v107
  v_exp_f32 v108, v108
  v_exp_f32 v109, v109
  v_smfmac_f32_32x32x32_bf16 v[48:63], v[192:195], v[152:159], v8
  v_exp_f32 v110, v110
  v_exp_f32 v111, v111
  v_exp_f32 v112, v112
  v_smfmac_f32_16x16x64_bf16 v[68:71], v[12:15], v[152:159], v8
  v_exp_f32 v113, v113
  v_exp_f32 v114, v114
  v_smfmac_f32_32x32x32_bf16 v[48:63], v[196:199], v[160:167], v8
  v_exp_f32 v115, v115
  v_exp_f32 v116, v116
  v_exp_f32 v117, v117
  v_smfmac_f32_16x16x64_bf16 v[68:71], v[12:15], v[160:167], v8
  v_exp_f32 v118, v118
  v_exp_f32 v119, v119
  s_waitcnt vmcnt(4)
  s_barrier
  v_add_u32 v4, 32768, v4
  v_and_b32 v4, 0x1ffff, v4
  s_waitcnt lgkmcnt(0)
  s_add_u32 m0, s63, 0
  v_mfma_f32_32x32x16_bf16 v[136:151], v[176:179], v[16:19], v[72:87]
  buffer_load_dwordx4 v6, s[48:51], s64 offen lds
  s_add_u32 s64, s64, 8192
  ds_read_b128 v[168:171], v4 offset:0
  v_exp_f32 v120, v120
  v_exp_f32 v121, v121
  v_exp_f32 v122, v122
  s_add_u32 m0, s63, 8192
  v_mfma_f32_32x32x16_bf16 v[136:151], v[180:183], v[20:23], v[136:151]
  buffer_load_dwordx4 v6, s[48:51], s64 offen lds
  s_add_u32 s64, s64, 8192
  ds_read_b128 v[172:175], v4 offset:1024
  v_exp_f32 v123, v123
  v_exp_f32 v124, v124
  v_exp_f32 v125, v125
  s_add_u32 m0, s63, 16384
  v_smfmac_f32_32x32x32_bf16 v[32:47], v[184:187], v[104:111], v8
  buffer_load_dwordx4 v6, s[48:51], s64 offen lds
  s_add_u32 s64, s64, 8192
  v_exp_f32 v126, v126
  v_exp_f32 v127, v127
  v_exp_f32 v128, v128
  s_add_u32 m0, s63, 24576
  v_smfmac_f32_16x16x64_bf16 v[64:67], v[12:15], v[104:111], v8
  buffer_load_dwordx4 v6, s[48:51], s64 offen lds
  s_add_u32 s64, s64, 8192
  s_add_u32 s63, s63, 32768
  s_and_b32 s63, s63, 0x1ffff
  v_exp_f32 v129, v129
  v_exp_f32 v130, v130
  v_smfmac_f32_32x32x32_bf16 v[32:47], v[188:191], v[112:119], v8
  v_exp_f32 v131, v131
  v_exp_f32 v132, v132
  v_exp_f32 v133, v133
  v_smfmac_f32_16x16x64_bf16 v[64:67], v[12:15], v[112:119], v8
  v_exp_f32 v134, v134
  v_exp_f32 v135, v135
  v_mfma_f32_32x32x16_bf16 v[152:167], v[176:179], v[24:27], v[88:103]
  ds_read_b128 v[192:195], v5 offset:26624
  v_exp_f32 v136, v136
  v_exp_f32 v137, v137
  v_exp_f32 v138, v138
  v_mfma_f32_32x32x16_bf16 v[152:167], v[180:183], v[28:31], v[152:167]
  ds_read_b128 v[196:199], v5 offset:27648
  v_exp_f32 v139, v139
  v_exp_f32 v140, v140
  v_exp_f32 v141, v141
  v_smfmac_f32_32x32x32_bf16 v[48:63], v[184:187], v[120:127], v8
  v_exp_f32 v142, v142
  v_exp_f32 v143, v143
  v_exp_f32 v144, v144
  v_smfmac_f32_16x16x64_bf16 v[68:71], v[12:15], v[120:127], v8
  v_exp_f32 v145, v145
  v_exp_f32 v146, v146
  v_smfmac_f32_32x32x32_bf16 v[48:63], v[188:191], v[128:135], v8
  v_exp_f32 v147, v147
  v_exp_f32 v148, v148
  v_exp_f32 v149, v149
  v_smfmac_f32_16x16x64_bf16 v[68:71], v[12:15], v[128:135], v8
  v_exp_f32 v150, v150
  v_exp_f32 v151, v151
  v_add_u32 v5, 32768, v5
  v_and_b32 v5, 0x1ffff, v5
  s_waitcnt lgkmcnt(0)
  v_mfma_f32_32x32x16_bf16 v[104:119], v[168:171], v[16:19], v[72:87]
  ds_read_b128 v[176:179], v4 offset:8192
  v_exp_f32 v152, v152
  v_exp_f32 v153, v153
  v_exp_f32 v154, v154
  v_mfma_f32_32x32x16_bf16 v[104:119], v[172:175], v[20:23], v[104:119]
  ds_read_b128 v[180:183], v4 offset:9216
  v_exp_f32 v155, v155
  v_exp_f32 v156, v156
  v_exp_f32 v157, v157
  v_smfmac_f32_32x32x32_bf16 v[32:47], v[192:195], v[136:143], v8
  v_exp_f32 v158, v158
  v_exp_f32 v159, v159
  v_exp_f32 v160, v160
  v_smfmac_f32_16x16x64_bf16 v[64:67], v[12:15], v[136:143], v8
  v_exp_f32 v161, v161
  v_exp_f32 v162, v162
  v_smfmac_f32_32x32x32_bf16 v[32:47], v[196:199], v[144:151], v8
  v_exp_f32 v163, v163
  v_exp_f32 v164, v164
  v_exp_f32 v165, v165
  v_smfmac_f32_16x16x64_bf16 v[64:67], v[12:15], v[144:151], v8
  v_exp_f32 v166, v166
  v_exp_f32 v167, v167
  s_sub_u32 s65, s65, 1
  s_cmp_lg_u32 s65, 0
  s_cbranch_scc1 aa_loop_154
  v_smfmac_f32_32x32x32_bf16 v[48:63], v[192:195], v[152:159], v8
  v_smfmac_f32_16x16x64_bf16 v[68:71], v[12:15], v[152:159], v8
  v_smfmac_f32_32x32x32_bf16 v[48:63], v[196:199], v[160:167], v8
  v_smfmac_f32_16x16x64_bf16 v[68:71], v[12:15], v[160:167], v8
  s_lshl_b32 s67, s20, 13
  v_lshl_add_u32 v2, v1, 4, s67
  v_xor_b32 v3, 32768, v2
  s_waitcnt vmcnt(0) lgkmcnt(0)
  s_barrier
  s_nop 5
  ds_write_b128 v2, v[48:51] offset:0
  ds_write_b128 v2, v[52:55] offset:1024
  ds_write_b128 v2, v[56:59] offset:2048
  ds_write_b128 v2, v[60:63] offset:3072
  ds_write_b32 v2, v68 offset:4096
  s_waitcnt lgkmcnt(0)
  s_barrier
  ds_read_b128 v[48:51], v3 offset:0
  ds_read_b128 v[52:55], v3 offset:1024
  ds_read_b128 v[56:59], v3 offset:2048
  ds_read_b128 v[60:63], v3 offset:3072
  ds_read_b32 v68, v3 offset:4096
  s_waitcnt lgkmcnt(0)
  v_add_f32 v32, v32, v48
  v_add_f32 v33, v33, v49
  v_add_f32 v34, v34, v50
  v_add_f32 v35, v35, v51
  v_add_f32 v36, v36, v52
  v_add_f32 v37, v37, v53
  v_add_f32 v38, v38, v54
  v_add_f32 v39, v39, v55
  v_add_f32 v40, v40, v56
  v_add_f32 v41, v41, v57
  v_add_f32 v42, v42, v58
  v_add_f32 v43, v43, v59
  v_add_f32 v44, v44, v60
  v_add_f32 v45, v45, v61
  v_add_f32 v46, v46, v62
  v_add_f32 v47, v47, v63
  v_add_f32 v64, v64, v68
  v_subrev_u32 v2, 0x1f800000, v64
  v_cmp_lt_u32 vcc, 0x40000000, v2
  v_mov_b32 v2, 131072
  s_cbranch_vccz aa_ok_156
  ds_write_b32 v2, v2
aa_ok_156:
  s_waitcnt vmcnt(0) lgkmcnt(0)
  s_barrier
  ds_read_b32 v3, v2
  s_waitcnt lgkmcnt(0)
  v_readfirstlane_b32 s67, v3
  s_nop 0
  s_cmp_eq_u32 s67, 0
  s_cbranch_scc1 aa_done_155
  s_cmp_lg_u32 s66, 0
  s_cbranch_scc1 aa_done_155
  s_barrier
  s_mov_b32 s66, 1
  v_lshlrev_b32 v4, 4, v1
  v_mov_b32 v2, 0xff7fffff
  v_mov_b32 v3, 0xff7fffff
  s_mov_b32 s64, 0
aa_mx_157:
  buffer_load_dwordx4 v[168:171], v4, s[48:51], s64 offen
  buffer_load_dwordx4 v[172:175], v4, s[48:51], s64 offen offset:1024
  s_waitcnt vmcnt(0)
  v_mfma_f32_32x32x16_bf16 v[104:119], v[168:171], v[16:19], 0
  v_mfma_f32_32x32x16_bf16 v[104:119], v[172:175], v[20:23], v[104:119]
  v_mfma_f32_32x32x16_bf16 v[120:135], v[168:171], v[24:27], 0
  v_mfma_f32_32x32x16_bf16 v[120:135], v[172:175], v[28:31], v[120:135]
  s_nop 9
  v_max3_f32 v2, v2, v104, v105
  v_max3_f32 v2, v2, v106, v107
  v_max3_f32 v2, v2, v108, v109
  v_max3_f32 v2, v2, v110, v111
  v_max3_f32 v2, v2, v112, v113
  v_max3_f32 v2, v2, v114, v115
  v_max3_f32 v2, v2, v116, v117
  v_max3_f32 v2, v2, v118, v119
  v_max3_f32 v3, v3, v120, v121
  v_max3_f32 v3, v3, v122, v123
  v_max3_f32 v3, v3, v124, v125
  v_max3_f32 v3, v3, v126, v127
  v_max3_f32 v3, v3, v128, v129
  v_max3_f32 v3, v3, v130, v131
  v_max3_f32 v3, v3, v132, v133
  v_max3_f32 v3, v3, v134, v135
  s_add_u32 s64, s64, 4096
  s_cmp_lt_u32 s64, 262144
  s_cbranch_scc1 aa_mx_157
  v_mov_b32 v104, v2
  s_nop 1
  v_permlane32_swap_b32 v104, v2
  v_max_f32 v104, v104, v2
  v_sub_f32 v72, 0, v104
  v_sub_f32 v73, 0, v104
  v_sub_f32 v74, 0, v104
  v_sub_f32 v75, 0, v104
  v_sub_f32 v76, 0, v104
  v_sub_f32 v77, 0, v104
  v_sub_f32 v78, 0, v104
  v_sub_f32 v79, 0, v104
  v_sub_f32 v80, 0, v104
  v_sub_f32 v81, 0, v104
  v_sub_f32 v82, 0, v104
  v_sub_f32 v83, 0, v104
  v_sub_f32 v84, 0, v104
  v_sub_f32 v85, 0, v104
  v_sub_f32 v86, 0, v104
  v_sub_f32 v87, 0, v104
  v_mov_b32 v104, v3
  s_nop 1
  v_permlane32_swap_b32 v104, v3
  v_max_f32 v104, v104, v3
  v_sub_f32 v88, 0, v104
  v_sub_f32 v89, 0, v104
  v_sub_f32 v90, 0, v104
  v_sub_f32 v91, 0, v104
  v_sub_f32 v92, 0, v104
  v_sub_f32 v93, 0, v104
  v_sub_f32 v94, 0, v104
  v_sub_f32 v95, 0, v104
  v_sub_f32 v96, 0, v104
  v_sub_f32 v97, 0, v104
  v_sub_f32 v98, 0, v104
  v_sub_f32 v99, 0, v104
  v_sub_f32 v100, 0, v104
  v_sub_f32 v101, 0, v104
  v_sub_f32 v102, 0, v104
  v_sub_f32 v103, 0, v104
  s_branch aa_re_153
aa_done_155:
  s_cmp_lg_u32 s20, 0
  s_cbranch_scc1 w_pop_158
  s_mov_b64 exec, 1
  v_mov_b32 v255, 1
  buffer_atomic_add v255, off, s[8:11], s28 sc0 sc1
  s_mov_b64 exec, -1
w_pop_158:
  s_mul_i32 s67, s62, 2048
  v_rcp_f32 v2, v64
  s_nop 0
  v_mul_f32 v2, v2, v10
  v_mul_f32 v32, v2, v32
  v_mul_f32 v33, v2, v33
  v_mul_f32 v34, v2, v34
  v_mul_f32 v35, v2, v35
  v_mul_f32 v36, v2, v36
  v_mul_f32 v37, v2, v37
  v_mul_f32 v38, v2, v38
  v_mul_f32 v39, v2, v39
  v_mul_f32 v40, v2, v40
  v_mul_f32 v41, v2, v41
  v_mul_f32 v42, v2, v42
  v_mul_f32 v43, v2, v43
  v_mul_f32 v44, v2, v44
  v_mul_f32 v45, v2, v45
  v_mul_f32 v46, v2, v46
  v_mul_f32 v47, v2, v47
  v_cvt_pk_bf16_f32 v32, v32, v33
  v_cvt_pk_bf16_f32 v33, v34, v35
  v_cvt_pk_bf16_f32 v34, v36, v37
  v_cvt_pk_bf16_f32 v35, v38, v39
  v_cvt_pk_bf16_f32 v36, v40, v41
  v_cvt_pk_bf16_f32 v37, v42, v43
  v_cvt_pk_bf16_f32 v38, v44, v45
  v_cvt_pk_bf16_f32 v39, v46, v47
  buffer_store_dwordx4 v[32:35], v7, s[56:59], s67 offen sc1
  buffer_store_dwordx4 v[36:39], v7, s[56:59], s67 offen offset:16 sc1
  s_add_u32 s67, s67, 2048
  s_branch w_next_87
w_fin_104:
  s_load_dwordx2 s[48:49], s[0:1], 32
  s_mov_b32 s32, s7
  s_lshr_b32 s33, s32, 3
  s_lshl_b32 s85, s6, 2
  s_lshl_b32 s34, s33, 0
  s_add_u32 s85, s85, s34
  s_lshl_b32 s29, s85, 7
  s_add_u32 s29, s29, 124792832
  s_mov_b32 s30, 1
  s_cmp_eq_u32 s85, 15
  s_cselect_b32 s29, 124780544, s29
  s_cselect_b32 s30, 0xffff, s30
  s_lshl_b32 s33, s85, 7
  s_add_u32 s33, s33, 124790784
  s_cmp_lg_u32 s20, 0
  s_cbranch_scc1 dpx_160
  s_mov_b32 s31, 400000
dp_159:
  buffer_load_dword v1, off, s[24:27], s33 sc1
  s_sub_u32 s31, s31, 1
  s_cbranch_scc1 fused_kernel_end
  s_waitcnt vmcnt(0)
  v_cmp_gt_u32 vcc, 16, v1
  s_cbranch_vccnz dp_159_s
  s_branch dpx_160
dp_159_s:
  s_sleep 8
  s_branch dp_159
dpx_160:
  s_barrier
  s_and_b32 s32, s32, 7
  s_lshl_b32 s32, s32, 8
  s_lshl_b32 s56, s85, 18
  s_add_u32 s56, s56, 71303168
  s_add_u32 s56, s56, s32
  s_mov_b32 s67, 0
  s_mov_b32 s58, 2048
  s_mov_b32 s35, 2097152
  s_mov_b32 s65, 1.0
  s_mov_b32 s40, 67108864
  s_mov_b64 s[44:45], s[4:5]
  s_branch w_t_105r
w_t_105:
  s_load_dwordx2 s[44:45], s[0:1], 0
  s_bfe_u32 s33, s7, 131075
  s_cmp_lg_u32 s33, 0
  s_cbranch_scc1 w_t_105m0
  s_load_dwordx2 s[48:49], s[0:1], 56
  s_branch w_t_105m2
w_t_105m0:
  s_cmp_lg_u32 s33, 1
  s_cbranch_scc1 w_t_105m1
  s_load_dwordx2 s[48:49], s[0:1], 64
  s_branch w_t_105m2
w_t_105m1:
  s_load_dwordx2 s[48:49], s[0:1], 72
w_t_105m2:
  s_cmp_eq_u32 s33, 1
  s_cselect_b32 s65, 0x3e0293ee, 1.0
  s_lshr_b32 s85, s7, 5
  s_and_b32 s32, s7, 7
  s_lshl_b32 s34, s6, 3
  s_add_u32 s34, s34, s32
  s_lshl_b32 s56, s33, 24
  s_lshl_b32 s32, s34, 13
  s_add_u32 s56, s56, s32
  s_lshl_b32 s32, s85, 20
  s_add_u32 s56, s56, s32
  s_lshr_b32 s33, s34, 2
  s_lshl_b32 s29, s33, 11
  s_lshl_b32 s32, s85, 7
  s_add_u32 s29, s29, s32
  s_add_u32 s29, s29, 124813312
  s_cmp_lg_u32 s85, 3
  s_cbranch_scc1 w_t_105a
  s_and_b32 s32, s34, 3
  s_lshl_b32 s32, s32, 16
  s_lshl_b32 s33, s33, 22
  s_add_u32 s32, s32, s33
  s_add_u32 s32, s32, 87818240
  v_lshlrev_b32 v1, 4, v0
  v_mov_b32 v4, -1
  v_mov_b32 v5, -1
  v_mov_b32 v6, -1
  v_mov_b32 v7, -1
  buffer_store_dwordx4 v[4:7], v1, s[24:27], s32 offen sc1
  s_add_u32 s32, s32, 8192
  buffer_store_dwordx4 v[4:7], v1, s[24:27], s32 offen sc1
  s_add_u32 s32, s32, 8192
  buffer_store_dwordx4 v[4:7], v1, s[24:27], s32 offen sc1
  s_add_u32 s32, s32, 8192
  buffer_store_dwordx4 v[4:7], v1, s[24:27], s32 offen sc1
  s_add_u32 s32, s32, 8192
  buffer_store_dwordx4 v[4:7], v1, s[24:27], s32 offen sc1
  s_add_u32 s32, s32, 8192
  buffer_store_dwordx4 v[4:7], v1, s[24:27], s32 offen sc1
  s_add_u32 s32, s32, 8192
  buffer_store_dwordx4 v[4:7], v1, s[24:27], s32 offen sc1
  s_add_u32 s32, s32, 8192
  buffer_store_dwordx4 v[4:7], v1, s[24:27], s32 offen sc1
w_t_105a:
  s_lshl_b32 s32, s34, 8
  s_mov_b32 s30, 1
  s_mov_b32 s40, 0
  s_mov_b32 s67, 1
  s_mov_b32 s58, 8192
  s_mov_b32 s35, 8388608
w_t_105r:
  s_mov_b32 s59, 2048
  v_and_b32 v10, 63, v0
  s_lshl_b32 s63, s20, 10
  s_lshl_b32 s62, s58, 5
  v_lshrrev_b32 v11, 4, v0
  v_and_b32 v12, 3, v11
  v_lshlrev_b32 v12, 1, v12
  v_and_b32 v13, 8, v11
  v_or_b32 v12, v12, v13
  v_and_b32 v13, 15, v10
  v_xor_b32 v12, v12, v13
  v_lshlrev_b32 v12, 4, v12
  v_mul_lo_u32 v11, v11, s58
  v_add_u32 v5, v11, v12
  v_lshrrev_b32 v11, 3, v0
  v_lshrrev_b32 v12, 4, v0
  v_xor_b32 v12, v12, v10
  v_and_b32 v12, 7, v12
  v_lshlrev_b32 v12, 4, v12
  v_lshl_add_u32 v6, v11, 11, v12
  v_add_u32 v7, 131072, v6
  s_lshl_b32 s34, s85, 18
  s_waitcnt lgkmcnt(0)
  s_add_u32 s34, s34, s40
  s_add_u32 s44, s44, s34
  s_addc_u32 s45, s45, 0
  s_and_b32 s45, s45, 0xffff
  s_mov_b32 s46, 262144
  s_mov_b32 s47, 0x20000
  s_sub_u32 s34, s35, s32
  s_add_u32 s48, s48, s32
  s_addc_u32 s49, s49, 0
  s_and_b32 s49, s49, 0xffff
  s_mov_b32 s50, s34
  s_mov_b32 s51, 0x20000
  s_bfe_u32 s32, s85, 131072
  s_mul_i32 s76, s58, 13248
  s_mul_i32 s82, s58, 272
  s_mov_b32 s60, 0
  s_mov_b32 s61, 0
  s_mov_b32 s83, 0
  s_mov_b32 s77, 0
  s_bitcmp1_b32 s16, 2
  s_cselect_b32 s57, 1920, 0
  s_mul_i32 s84, s57, s58
  s_lshr_b32 s84, s84, 1
  s_mov_b32 s83, s57
  s_mov_b32 s77, s84
  s_add_u32 m0, s63, 65536
  s_nop 0
  buffer_load_dwordx4 v6, s[44:47], s83 offen lds
  s_add_u32 m0, s63, 73728
  s_nop 0
  buffer_load_dwordx4 v7, s[44:47], s83 offen lds
  s_add_u32 s60, s60, 544
  s_and_b32 s83, s60, 0x780
  s_xor_b32 s83, s83, s57
  s_bitcmp1_b32 s60, 13
  s_cselect_b32 s83, 1073741824, s83
  s_add_u32 m0, s63, 0
  s_nop 0
  buffer_load_dwordx4 v5, s[48:51], s77 offen lds
  s_add_u32 s77, s77, s62
  s_add_u32 m0, s63, 8192
  s_nop 0
  buffer_load_dwordx4 v5, s[48:51], s77 offen lds
  s_add_u32 s61, s61, s82
  s_and_b32 s77, s61, s76
  s_xor_b32 s77, s77, s84
  s_add_u32 m0, s63, 81920
  s_nop 0
  buffer_load_dwordx4 v6, s[44:47], s83 offen lds
  s_add_u32 m0, s63, 90112
  s_nop 0
  buffer_load_dwordx4 v7, s[44:47], s83 offen lds
  s_add_u32 s60, s60, 544
  s_and_b32 s83, s60, 0x780
  s_xor_b32 s83, s83, s57
  s_bitcmp1_b32 s60, 13
  s_cselect_b32 s83, 1073741824, s83
  s_add_u32 m0, s63, 16384
  s_nop 0
  buffer_load_dwordx4 v5, s[48:51], s77 offen lds
  s_add_u32 s77, s77, s62
  s_add_u32 m0, s63, 24576
  s_nop 0
  buffer_load_dwordx4 v5, s[48:51], s77 offen lds
  s_add_u32 s61, s61, s82
  s_and_b32 s77, s61, s76
  s_xor_b32 s77, s77, s84
  s_add_u32 m0, s63, 98304
  s_nop 0
  buffer_load_dwordx4 v6, s[44:47], s83 offen lds
  s_add_u32 m0, s63, 106496
  s_nop 0
  buffer_load_dwordx4 v7, s[44:47], s83 offen lds
  s_add_u32 s60, s60, 544
  s_and_b32 s83, s60, 0x780
  s_xor_b32 s83, s83, s57
  s_bitcmp1_b32 s60, 13
  s_cselect_b32 s83, 1073741824, s83
  s_add_u32 m0, s63, 32768
  s_nop 0
  buffer_load_dwordx4 v5, s[48:51], s77 offen lds
  s_add_u32 s77, s77, s62
  s_add_u32 m0, s63, 40960
  s_nop 0
  buffer_load_dwordx4 v5, s[48:51], s77 offen lds
  s_add_u32 s61, s61, s82
  s_and_b32 s77, s61, s76
  s_xor_b32 s77, s77, s84
  s_add_u32 m0, s63, 114688
  s_nop 0
  buffer_load_dwordx4 v6, s[44:47], s83 offen lds
  s_add_u32 m0, s63, 122880
  s_nop 0
  buffer_load_dwordx4 v7, s[44:47], s83 offen lds
  s_add_u32 s60, s60, 544
  s_and_b32 s83, s60, 0x780
  s_xor_b32 s83, s83, s57
  s_bitcmp1_b32 s60, 13
  s_cselect_b32 s83, 1073741824, s83
  s_add_u32 m0, s63, 49152
  s_nop 0
  buffer_load_dwordx4 v5, s[48:51], s77 offen lds
  s_add_u32 s77, s77, s62
  s_add_u32 m0, s63, 57344
  s_nop 0
  buffer_load_dwordx4 v5, s[48:51], s77 offen lds
  s_add_u32 s61, s61, s82
  s_and_b32 s77, s61, s76
  s_xor_b32 s77, s77, s84
  v_lshrrev_b32 v11, 2, v10
  v_and_b32 v13, 7, v11
  v_and_b32 v11, 3, v11
  v_lshrrev_b32 v12, 4, v10
  v_lshl_add_u32 v12, v12, 3, v11
  v_lshlrev_b32 v12, 8, v12
  s_and_b32 s66, s20, 3
  s_mul_i32 s66, s66, 2
  v_xor_b32 v13, s66, v13
  v_lshl_add_u32 v12, v13, 5, v12
  v_and_b32 v11, 3, v10
  v_lshl_add_u32 v1, v11, 3, v12
  v_xor_b32 v2, 32, v1
  s_lshr_b32 s66, s20, 2
  s_mul_i32 s66, s66, 64
  v_and_b32 v11, 15, v10
  v_add_u32 v13, s66, v11
  v_lshrrev_b32 v11, 1, v11
  v_lshrrev_b32 v12, 4, v10
  v_xor_b32 v11, v11, v12
  v_lshlrev_b32 v11, 4, v11
  v_lshl_add_u32 v11, v13, 7, v11
  v_add_u32 v3, 65536, v11
  v_xor_b32 v4, 64, v3
  s_and_b32 s66, s20, 3
  s_lshr_b32 s71, s20, 2
  v_and_b32 v11, 15, v10
  s_cmp_lg_u32 s67, 0
  s_cbranch_scc1 go_f_161
  s_mul_i32 s71, s71, 64
  v_add_u32 v13, s71, v11
  v_mul_lo_u32 v13, v13, s59
  v_and_b32 v11, 16, v10
  v_lshl_add_u32 v13, v11, 1, v13
  v_lshrrev_b32 v11, 5, v10
  v_lshl_add_u32 v13, v11, 4, v13
  s_mul_i32 s66, s66, 64
  v_add_u32 v8, s66, v13
  s_lshl_b32 s68, s59, 4
  s_lshl_b32 s69, s59, 5
  s_mov_b32 s70, 64
  s_branch go_d_163
go_f_161:
  v_lshlrev_b32 v13, 4, v11
  s_mov_b32 s68, 1024
  s_cmp_eq_u32 s67, 1
  s_cbranch_scc1 go_k_162
  v_and_b32 v13, 3, v10
  v_lshlrev_b32 v13, 4, v13
  v_and_b32 v11, 8, v10
  v_lshl_add_u32 v13, v11, 3, v13
  v_and_b32 v11, 4, v10
  v_lshl_add_u32 v13, v11, 8, v13
  s_mov_b32 s68, 128
go_k_162:
  v_and_b32 v11, 16, v10
  v_lshl_add_u32 v13, v11, 5, v13
  v_and_b32 v11, 32, v10
  v_lshl_add_u32 v13, v11, 3, v13
  s_mul_i32 s66, s66, 2048
  s_mul_i32 s71, s71, 524288
  s_add_u32 s66, s66, s71
  v_add_u32 v8, s66, v13
  s_mov_b32 s69, 262144
  s_mov_b32 s70, 2048
go_d_163:
  v_mov_b32 v64, 0
  v_mov_b32 v65, 0
  v_mov_b32 v66, 0
  v_mov_b32 v67, 0
  v_mov_b32 v68, 0
  v_mov_b32 v69, 0
  v_mov_b32 v70, 0
  v_mov_b32 v71, 0
  v_mov_b32 v72, 0
  v_mov_b32 v73, 0
  v_mov_b32 v74, 0
  v_mov_b32 v75, 0
  v_mov_b32 v76, 0
  v_mov_b32 v77, 0
  v_mov_b32 v78, 0
  v_mov_b32 v79, 0
  v_mov_b32 v80, 0
  v_mov_b32 v81, 0
  v_mov_b32 v82, 0
  v_mov_b32 v83, 0
  v_mov_b32 v84, 0
  v_mov_b32 v85, 0
  v_mov_b32 v86, 0
  v_mov_b32 v87, 0
  v_mov_b32 v88, 0
  v_mov_b32 v89, 0
  v_mov_b32 v90, 0
  v_mov_b32 v91, 0
  v_mov_b32 v92, 0
  v_mov_b32 v93, 0
  v_mov_b32 v94, 0
  v_mov_b32 v95, 0
  s_mov_b32 s72, s63
  s_mov_b32 s73, 8192
  s_mov_b32 s75, 8192
  s_add_u32 s74, s63, 57344
  s_add_u32 s80, s63, 131072
  s_mov_b32 s78, s80
  s_mov_b32 s79, -65536
  s_mov_b32 s81, 16384
  s_mov_b32 s64, 16
  s_waitcnt vmcnt(12)
  s_barrier
  ds_read_b64_tr_b16 v[16:17], v1
  ds_read_b64_tr_b16 v[18:19], v1 offset:1024
  ds_read_b128 v[32:35], v3 offset:0
  ds_read_b128 v[36:39], v3 offset:2048
  ds_read_b128 v[40:43], v3 offset:4096
  ds_read_b128 v[44:47], v3 offset:6144
  ds_read_b64_tr_b16 v[20:21], v2
  ds_read_b64_tr_b16 v[22:23], v2 offset:1024
  v_add_u32 v1, s73, v1
  v_add_u32 v2, s73, v2
gk_166:
  s_waitcnt lgkmcnt(0)
  s_add_u32 m0, s78, 0
  v_mfma_f32_16x16x32_bf16 v[64:67], v[16:19], v[32:35], v[64:67]
  buffer_load_dwordx4 v6, s[44:47], s83 offen lds
  ds_read_b64_tr_b16 v[24:25], v1
  v_mfma_f32_16x16x32_bf16 v[72:75], v[16:19], v[36:39], v[72:75]
  ds_read_b64_tr_b16 v[26:27], v1 offset:1024
  s_add_u32 m0, s78, 8192
  v_mfma_f32_16x16x32_bf16 v[80:83], v[16:19], v[40:43], v[80:83]
  buffer_load_dwordx4 v7, s[44:47], s83 offen lds
  s_add_u32 s60, s60, 544
  s_and_b32 s83, s60, 0x780
  s_xor_b32 s83, s83, s57
  s_bitcmp1_b32 s60, 13
  s_cselect_b32 s83, 1073741824, s83
  ds_read_b128 v[48:51], v4 offset:0
  v_mfma_f32_16x16x32_bf16 v[88:91], v[16:19], v[44:47], v[88:91]
  ds_read_b128 v[52:55], v4 offset:2048
  v_mfma_f32_16x16x32_bf16 v[68:71], v[20:23], v[32:35], v[68:71]
  ds_read_b128 v[56:59], v4 offset:4096
  v_mfma_f32_16x16x32_bf16 v[76:79], v[20:23], v[36:39], v[76:79]
  ds_read_b128 v[60:63], v4 offset:6144
  v_mfma_f32_16x16x32_bf16 v[84:87], v[20:23], v[40:43], v[84:87]
  ds_read_b64_tr_b16 v[28:29], v2
  v_mfma_f32_16x16x32_bf16 v[92:95], v[20:23], v[44:47], v[92:95]
  ds_read_b64_tr_b16 v[30:31], v2 offset:1024
  s_add_u32 s72, s72, s73
  s_cmp_eq_u32 s72, s74
  s_cselect_b32 s73, -57344, s75
  v_add_u32 v1, s73, v1
  v_add_u32 v2, s73, v2
  s_add_u32 s78, s78, s79
  s_cmp_eq_u32 s78, s80
  s_cselect_b32 s79, -65536, s81
  v_add_u32 v3, s79, v3
  s_waitcnt vmcnt(10) lgkmcnt(0)
  s_barrier
  s_add_u32 m0, s72, -8192
  v_mfma_f32_16x16x32_bf16 v[64:67], v[24:27], v[48:51], v[64:67]
  buffer_load_dwordx4 v5, s[48:51], s77 offen lds
  s_add_u32 s77, s77, s62
  ds_read_b64_tr_b16 v[16:17], v1
  v_mfma_f32_16x16x32_bf16 v[72:75], v[24:27], v[52:55], v[72:75]
  ds_read_b64_tr_b16 v[18:19], v1 offset:1024
  s_add_u32 m0, s72, 0
  v_mfma_f32_16x16x32_bf16 v[80:83], v[24:27], v[56:59], v[80:83]
  buffer_load_dwordx4 v5, s[48:51], s77 offen lds
  s_add_u32 s61, s61, s82
  s_and_b32 s77, s61, s76
  s_xor_b32 s77, s77, s84
  ds_read_b128 v[32:35], v3 offset:0
  v_mfma_f32_16x16x32_bf16 v[88:91], v[24:27], v[60:63], v[88:91]
  ds_read_b128 v[36:39], v3 offset:2048
  v_mfma_f32_16x16x32_bf16 v[68:71], v[28:31], v[48:51], v[68:71]
  ds_read_b128 v[40:43], v3 offset:4096
  v_mfma_f32_16x16x32_bf16 v[76:79], v[28:31], v[52:55], v[76:79]
  ds_read_b128 v[44:47], v3 offset:6144
  v_mfma_f32_16x16x32_bf16 v[84:87], v[28:31], v[56:59], v[84:87]
  ds_read_b64_tr_b16 v[20:21], v2
  v_mfma_f32_16x16x32_bf16 v[92:95], v[28:31], v[60:63], v[92:95]
  ds_read_b64_tr_b16 v[22:23], v2 offset:1024
  s_add_u32 s72, s72, s73
  s_cmp_eq_u32 s72, s74
  s_cselect_b32 s73, -57344, s75
  v_add_u32 v1, s73, v1
  v_add_u32 v2, s73, v2
  v_xor_b32 v4, 64, v3
  s_sub_u32 s64, s64, 1
  s_cmp_lg_u32 s64, 0
  s_cbranch_scc1 gk_166
ge_164:
  s_waitcnt vmcnt(0) lgkmcnt(0)
  s_barrier
  s_cmp_lg_u32 s20, 0
  s_cbranch_scc1 w_pop_167
  s_mov_b64 exec, 1
  v_mov_b32 v255, 1
  buffer_atomic_add v255, off, s[8:11], s28 sc0 sc1
  s_mov_b64 exec, -1
w_pop_167:
  s_mov_b32 s66, s56
  v_mul_f32 v64, s65, v64
  v_mul_f32 v65, s65, v65
  v_mul_f32 v66, s65, v66
  v_mul_f32 v67, s65, v67
  v_mul_f32 v68, s65, v68
  v_mul_f32 v69, s65, v69
  v_mul_f32 v70, s65, v70
  v_mul_f32 v71, s65, v71
  v_cvt_pk_bf16_f32 v64, v64, v65
  v_cvt_pk_bf16_f32 v65, v66, v67
  v_cvt_pk_bf16_f32 v66, v68, v69
  v_cvt_pk_bf16_f32 v67, v70, v71
  s_nop 0
  v_permlane16_swap_b32 v64, v66
  v_permlane16_swap_b32 v65, v67
  s_mov_b32 s71, s66
  buffer_store_dwordx4 v[64:67], v8, s[24:27], s71 offen sc1
  v_mul_f32 v72, s65, v72
  v_mul_f32 v73, s65, v73
  v_mul_f32 v74, s65, v74
  v_mul_f32 v75, s65, v75
  v_mul_f32 v76, s65, v76
  v_mul_f32 v77, s65, v77
  v_mul_f32 v78, s65, v78
  v_mul_f32 v79, s65, v79
  v_cvt_pk_bf16_f32 v72, v72, v73
  v_cvt_pk_bf16_f32 v73, v74, v75
  v_cvt_pk_bf16_f32 v74, v76, v77
  v_cvt_pk_bf16_f32 v75, v78, v79
  s_nop 0
  v_permlane16_swap_b32 v72, v74
  v_permlane16_swap_b32 v73, v75
  s_add_u32 s71, s66, s68
  buffer_store_dwordx4 v[72:75], v8, s[24:27], s71 offen sc1
  s_add_u32 s66, s66, s69
  v_mul_f32 v80, s65, v80
  v_mul_f32 v81, s65, v81
  v_mul_f32 v82, s65, v82
  v_mul_f32 v83, s65, v83
  v_mul_f32 v84, s65, v84
  v_mul_f32 v85, s65, v85
  v_mul_f32 v86, s65, v86
  v_mul_f32 v87, s65, v87
  v_cvt_pk_bf16_f32 v80, v80, v81
  v_cvt_pk_bf16_f32 v81, v82, v83
  v_cvt_pk_bf16_f32 v82, v84, v85
  v_cvt_pk_bf16_f32 v83, v86, v87
  s_nop 0
  v_permlane16_swap_b32 v80, v82
  v_permlane16_swap_b32 v81, v83
  s_mov_b32 s71, s66
  buffer_store_dwordx4 v[80:83], v8, s[24:27], s71 offen sc1
  v_mul_f32 v88, s65, v88
  v_mul_f32 v89, s65, v89
  v_mul_f32 v90, s65, v90
  v_mul_f32 v91, s65, v91
  v_mul_f32 v92, s65, v92
  v_mul_f32 v93, s65, v93
  v_mul_f32 v94, s65, v94
  v_mul_f32 v95, s65, v95
  v_cvt_pk_bf16_f32 v88, v88, v89
  v_cvt_pk_bf16_f32 v89, v90, v91
  v_cvt_pk_bf16_f32 v90, v92, v93
  v_cvt_pk_bf16_f32 v91, v94, v95
  s_nop 0
  v_permlane16_swap_b32 v88, v90
  v_permlane16_swap_b32 v89, v91
  s_add_u32 s71, s66, s68
  buffer_store_dwordx4 v[88:91], v8, s[24:27], s71 offen sc1
  s_add_u32 s66, s66, s69
  s_branch w_next_87
w_p0_106:
  s_lshr_b32 s32, s7, 1
  s_lshl_b32 s33, s6, 1
  s_add_u32 s32, s32, s33
  s_and_b32 s33, s7, 1
  s_lshr_b32 s34, s20, 2
  s_and_b32 s35, s20, 3
  s_lshl_b32 s87, s33, 6
  s_lshl_b32 s88, s34, 5
  s_add_u32 s87, s87, s88
  s_lshl_b32 s88, s32, 2
  s_add_u32 s87, s87, s88
  s_lshl_b32 s88, s35, 0
  s_add_u32 s87, s87, s88
  s_lshl_b32 s32, s32, 11
  s_add_u32 s32, s32, 124813312
  v_and_b32 v9, 63, v0
  v_lshlrev_b32 v8, 4, v9
  v_lshrrev_b32 v10, 2, v9
  v_and_b32 v10, 12, v10
  v_and_b32 v9, 15, v9
  v_sub_u32 v9, v9, v10
  v_mov_b32 v10, 0xf149f2ca
  v_cmp_le_i32 vcc, 0, v9
  s_nop 1
  v_cndmask_b32 v12, v10, 0, vcc
  v_cmp_le_i32 vcc, 1, v9
  s_nop 1
  v_cndmask_b32 v13, v10, 0, vcc
  v_cmp_le_i32 vcc, 2, v9
  s_nop 1
  v_cndmask_b32 v14, v10, 0, vcc
  v_cmp_le_i32 vcc, 3, v9
  s_nop 1
  v_cndmask_b32 v15, v10, 0, vcc
  s_cmp_lg_u32 s20, 0
  s_cbranch_scc1 dpx_169
  s_mov_b32 s31, 400000
dp_168:
  buffer_load_dword v1, off, s[24:27], s32 sc1
  s_sub_u32 s31, s31, 1
  s_cbranch_scc1 fused_kernel_end
  s_waitcnt vmcnt(0)
  v_cmp_gt_u32 vcc, 12, v1
  s_cbranch_vccnz dp_168_s
  s_branch dpx_169
dp_168_s:
  s_sleep 1
  s_branch dp_168
dpx_169:
  s_barrier
  s_lshl_b32 s88, s87, 13
  s_add_u32 s89, s88, 16777216
  s_add_u32 s88, s88, 0
  buffer_load_dwordx4 v[48:51], v8, s[24:27], s89 offen offset:0 sc1
  buffer_load_dwordx4 v[16:19], v8, s[24:27], s88 offen offset:0 sc1
  buffer_load_dwordx4 v[64:67], v8, s[24:27], s89 offen offset:1024 sc1
  buffer_load_dwordx4 v[32:35], v8, s[24:27], s88 offen offset:1024 sc1
  buffer_load_dwordx4 v[52:55], v8, s[24:27], s89 offen offset:2048 sc1
  buffer_load_dwordx4 v[20:23], v8, s[24:27], s88 offen offset:2048 sc1
  buffer_load_dwordx4 v[68:71], v8, s[24:27], s89 offen offset:3072 sc1
  buffer_load_dwordx4 v[36:39], v8, s[24:27], s88 offen offset:3072 sc1
  s_lshl_b32 s88, s87, 13
  s_add_u32 s89, s88, 16781312
  s_add_u32 s88, s88, 4096
  buffer_load_dwordx4 v[56:59], v8, s[24:27], s89 offen offset:0 sc1
  buffer_load_dwordx4 v[24:27], v8, s[24:27], s88 offen offset:0 sc1
  buffer_load_dwordx4 v[72:75], v8, s[24:27], s89 offen offset:1024 sc1
  buffer_load_dwordx4 v[40:43], v8, s[24:27], s88 offen offset:1024 sc1
  buffer_load_dwordx4 v[60:63], v8, s[24:27], s89 offen offset:2048 sc1
  buffer_load_dwordx4 v[28:31], v8, s[24:27], s88 offen offset:2048 sc1
  buffer_load_dwordx4 v[76:79], v8, s[24:27], s89 offen offset:3072 sc1
  buffer_load_dwordx4 v[44:47], v8, s[24:27], s88 offen offset:3072 sc1
  s_lshr_b32 s88, s87, 5
  s_lshl_b32 s88, s88, 18
  s_and_b32 s89, s87, 31
  s_lshl_b32 s89, s89, 11
  s_add_u32 s88, s88, s89
  s_add_u32 s88, s88, 134283264
  s_waitcnt vmcnt(12)
  v_mfma_f32_16x16x32_bf16 v[80:83], v[48:51], v[16:19], v[12:15]
  v_mfma_f32_16x16x32_bf16 v[84:87], v[48:51], v[32:35], 0
  v_mfma_f32_16x16x32_bf16 v[88:91], v[64:67], v[32:35], v[12:15]
  s_waitcnt vmcnt(8)
  v_mfma_f32_16x16x32_bf16 v[80:83], v[52:55], v[20:23], v[80:83]
  v_mfma_f32_16x16x32_bf16 v[84:87], v[52:55], v[36:39], v[84:87]
  v_mfma_f32_16x16x32_bf16 v[88:91], v[68:71], v[36:39], v[88:91]
  s_waitcnt vmcnt(4)
  v_mfma_f32_16x16x32_bf16 v[80:83], v[56:59], v[24:27], v[80:83]
  v_mfma_f32_16x16x32_bf16 v[84:87], v[56:59], v[40:43], v[84:87]
  v_mfma_f32_16x16x32_bf16 v[88:91], v[72:75], v[40:43], v[88:91]
  s_waitcnt vmcnt(0)
  v_mfma_f32_16x16x32_bf16 v[80:83], v[60:63], v[28:31], v[80:83]
  v_mfma_f32_16x16x32_bf16 v[84:87], v[60:63], v[44:47], v[84:87]
  v_mfma_f32_16x16x32_bf16 v[88:91], v[76:79], v[44:47], v[88:91]
  s_nop 5
  v_max3_f32 v92, v80, v81, v82
  v_max3_f32 v93, v84, v85, v86
  v_max_f32 v92, v92, v83
  v_max3_f32 v93, v93, v87, v88
  v_max3_f32 v93, v93, v89, v90
  v_max_f32 v93, v93, v91
  v_mov_b32 v9, v92
  v_mov_b32 v10, v93
  s_nop 0
  v_permlane16_swap_b32 v9, v92
  v_permlane16_swap_b32 v10, v93
  v_max_f32 v92, v92, v9
  v_max_f32 v93, v93, v10
  v_mov_b32 v9, v92
  v_mov_b32 v10, v93
  s_nop 0
  v_permlane32_swap_b32 v9, v92
  v_permlane32_swap_b32 v10, v93
  v_max_f32 v92, v92, v9
  v_max_f32 v93, v93, v10
  v_sub_f32 v80, v80, v92
  v_sub_f32 v81, v81, v92
  v_sub_f32 v82, v82, v92
  v_sub_f32 v83, v83, v92
  v_sub_f32 v84, v84, v93
  v_sub_f32 v85, v85, v93
  v_sub_f32 v86, v86, v93
  v_sub_f32 v87, v87, v93
  v_sub_f32 v88, v88, v93
  v_sub_f32 v89, v89, v93
  v_sub_f32 v90, v90, v93
  v_sub_f32 v91, v91, v93
  v_exp_f32 v80, v80
  v_exp_f32 v81, v81
  v_exp_f32 v82, v82
  v_exp_f32 v83, v83
  v_exp_f32 v84, v84
  v_exp_f32 v85, v85
  v_exp_f32 v86, v86
  v_exp_f32 v87, v87
  v_exp_f32 v88, v88
  v_exp_f32 v89, v89
  v_exp_f32 v90, v90
  v_exp_f32 v91, v91
  v_cvt_pk_bf16_f32 v94, v80, v81
  v_cvt_pk_bf16_f32 v95, v82, v83
  v_cvt_pk_bf16_f32 v96, v84, v85
  v_cvt_pk_bf16_f32 v97, v86, v87
  v_cvt_pk_bf16_f32 v98, v88, v89
  v_cvt_pk_bf16_f32 v99, v90, v91
  buffer_store_dwordx4 v[92:95], v8, s[24:27], s88 offen sc1
  buffer_store_dwordx4 v[96:99], v8, s[24:27], s88 offen offset:1024 sc1
  s_cmp_lg_u32 s20, 0
  s_cbranch_scc1 w_pop_170
  s_mov_b64 exec, 1
  v_mov_b32 v255, 1
  buffer_atomic_add v255, off, s[8:11], s28 sc0 sc1
  s_mov_b64 exec, -1
w_pop_170:
  s_branch w_next_87
w_first_890:
  s_cmp_lg_u32 s20, 7
  s_cbranch_scc1 w_first_894
  v_and_b32 v1, 63, v0
  v_lshlrev_b32 v1, 24, v1
  s_mov_b32 s32, 124780544
  v_writelane_b32 v1, s32, 4
  s_mov_b64 exec, 279
  buffer_load_dword v252, v1, s[24:27], 0 offen sc1
  s_mov_b64 exec, 1
  buffer_load_dword v253, off, s[8:11], 0 sc1
  v_mov_b32 v2, 0
  s_lshl_b32 s32, s6, 12
  s_lshl_b32 s33, s7, 7
  s_add_u32 s32, s32, s33
  s_add_u32 s32, s32, 125304832
  s_mov_b64 exec, -1
w_first_894:
  s_cmp_ge_u32 s20, 3
  s_cbranch_scc1 w_first_89
  s_load_dwordx2 s[44:45], s[0:1], 0
  v_and_b32 v1, 63, v0
  v_lshlrev_b32 v1, 7, v1
  s_lshl_b32 s32, s20, 18
  s_lshl_b32 s33, s7, 13
  s_add_u32 s32, s32, s33
  s_waitcnt lgkmcnt(0)
  s_and_b32 s45, s45, 0xffff
  s_mov_b32 s46, 4194304
  s_mov_b32 s47, 0x20000
  buffer_load_dword v253, v1, s[44:47], s32 offen
  s_branch w_first_89
w_sw_96:
  s_cmp_eq_u32 s28, 144
  s_cbranch_scc1 fused_kernel_end
  s_mov_b32 s28, 144
  s_cmp_lg_u32 s20, 0
  s_cbranch_scc1 w_pop_171
  s_mov_b64 exec, 1
  v_mov_b32 v255, 1
  buffer_atomic_add v255, off, s[8:11], s28 sc0 sc1
  s_mov_b64 exec, -1
w_pop_171:
  s_branch w_next_87
w_red_95:
  s_load_dwordx2 s[44:45], s[0:1], 104
  s_mov_b32 s32, 0x62951840
  s_mov_b32 s33, 0xb73dca
  s_lshr_b32 s34, s7, 3
  s_lshl_b32 s34, s34, 2
  s_lshr_b64 s[32:33], s[32:33], s34
  s_and_b32 s32, s32, 15
  s_and_b32 s33, s7, 7
  s_lshl_b32 s60, s32, 6
  s_lshl_b32 s34, s33, 3
  s_add_u32 s60, s60, s34
  s_lshl_b32 s34, s20, 0
  s_add_u32 s60, s60, s34
  s_cmp_lt_u32 s7, 112
  s_cbranch_scc1 w_red_951
  s_lshl_b32 s60, s7, 1
  s_lshl_b32 s32, s20, 0
  s_add_u32 s60, s60, s32
  s_add_u32 s60, s60, 672
  s_cmp_ge_u32 s20, 2
  s_cbranch_scc1 w_next_87
w_red_951:
  v_and_b32 v2, 63, v0
  v_lshlrev_b32 v1, 4, v2
  v_and_b32 v5, 15, v2
  v_lshlrev_b32 v4, 11, v5
  v_lshlrev_b32 v5, 2, v5
  v_lshrrev_b32 v3, 4, v2
  v_lshl_add_u32 v3, v3, 3, v4
  v_and_b32 v6, 16, v2
  v_lshl_add_u32 v4, v6, 1, v4
  v_lshrrev_b32 v6, 5, v2
  v_lshl_add_u32 v4, v6, 4, v4
  s_lshr_b32 s32, s60, 6
  s_lshl_b32 s32, s32, 7
  s_add_u32 s32, s32, 124792832
  s_and_b32 s33, s60, 15
  s_lshl_b32 s33, s33, 10
  s_add_u32 s33, s33, 124796928
  s_lshr_b32 s34, s60, 4
  v_lshlrev_b32 v2, 3, v1
  v_and_b32 v2, 0x380, v2
  s_mov_b32 s31, 400000
  s_waitcnt lgkmcnt(0)
  s_and_b32 s45, s45, 0xffff
  s_mov_b32 s46, 4194304
  s_mov_b32 s47, 0x20000
rd_p_172:
  buffer_load_dword v184, v2, s[24:27], s33 offen sc1
  s_sub_u32 s31, s31, 1
  s_cbranch_scc1 fused_kernel_end
  s_waitcnt vmcnt(0)
  v_cmp_ge_u32 vcc, s34, v184
  s_cbranch_vccz rd_g_173
  s_sleep 8
  s_branch rd_p_172
rd_g_173:
  buffer_load_dword v186, off, s[24:27], s32 sc1
  s_lshr_b32 s62, s60, 4
  s_lshl_b32 s63, s60, 12
  s_add_u32 s63, s63, 83886080
  buffer_load_dwordx4 v[24:27], v1, s[24:27], s63 offen offset:0
  buffer_load_dwordx4 v[28:31], v1, s[24:27], s63 offen offset:1024
  buffer_load_dwordx4 v[32:35], v1, s[24:27], s63 offen offset:2048
  buffer_load_dwordx4 v[36:39], v1, s[24:27], s63 offen offset:3072
  s_add_u32 s63, s63, 4194304
  buffer_load_dwordx4 v[40:43], v1, s[24:27], s63 offen offset:0
  buffer_load_dwordx4 v[44:47], v1, s[24:27], s63 offen offset:1024
  buffer_load_dwordx4 v[48:51], v1, s[24:27], s63 offen offset:2048
  buffer_load_dwordx4 v[52:55], v1, s[24:27], s63 offen offset:3072
  s_add_u32 s63, s63, 4194304
  buffer_load_dwordx4 v[56:59], v1, s[24:27], s63 offen offset:0
  buffer_load_dwordx4 v[60:63], v1, s[24:27], s63 offen offset:1024
  buffer_load_dwordx4 v[64:67], v1, s[24:27], s63 offen offset:2048
  buffer_load_dwordx4 v[68:71], v1, s[24:27], s63 offen offset:3072
  s_add_u32 s63, s63, 4194304
  buffer_load_dwordx4 v[72:75], v1, s[24:27], s63 offen offset:0
  buffer_load_dwordx4 v[76:79], v1, s[24:27], s63 offen offset:1024
  buffer_load_dwordx4 v[80:83], v1, s[24:27], s63 offen offset:2048
  buffer_load_dwordx4 v[84:87], v1, s[24:27], s63 offen offset:3072
  s_add_u32 s63, s63, 4194304
  buffer_load_dwordx4 v[88:91], v1, s[24:27], s63 offen offset:0
  buffer_load_dwordx4 v[92:95], v1, s[24:27], s63 offen offset:1024
  buffer_load_dwordx4 v[96:99], v1, s[24:27], s63 offen offset:2048
  buffer_load_dwordx4 v[100:103], v1, s[24:27], s63 offen offset:3072
  s_add_u32 s63, s63, 4194304
  buffer_load_dwordx4 v[104:107], v1, s[24:27], s63 offen offset:0
  buffer_load_dwordx4 v[108:111], v1, s[24:27], s63 offen offset:1024
  buffer_load_dwordx4 v[112:115], v1, s[24:27], s63 offen offset:2048
  buffer_load_dwordx4 v[116:119], v1, s[24:27], s63 offen offset:3072
  s_add_u32 s63, s63, 4194304
  buffer_load_dwordx4 v[120:123], v1, s[24:27], s63 offen offset:0
  buffer_load_dwordx4 v[124:127], v1, s[24:27], s63 offen offset:1024
  buffer_load_dwordx4 v[128:131], v1, s[24:27], s63 offen offset:2048
  buffer_load_dwordx4 v[132:135], v1, s[24:27], s63 offen offset:3072
  s_add_u32 s63, s63, 4194304
  buffer_load_dwordx4 v[136:139], v1, s[24:27], s63 offen offset:0
  buffer_load_dwordx4 v[140:143], v1, s[24:27], s63 offen offset:1024
  buffer_load_dwordx4 v[144:147], v1, s[24:27], s63 offen offset:2048
  buffer_load_dwordx4 v[148:151], v1, s[24:27], s63 offen offset:3072
  s_waitcnt vmcnt(28)
  v_lshlrev_b32 v152, 16, v24
  v_and_b32 v153, 0xffff0000, v24
  v_lshlrev_b32 v154, 16, v25
  v_and_b32 v155, 0xffff0000, v25
  v_lshlrev_b32 v156, 16, v26
  v_and_b32 v157, 0xffff0000, v26
  v_lshlrev_b32 v158, 16, v27
  v_and_b32 v159, 0xffff0000, v27
  v_lshlrev_b32 v160, 16, v28
  v_and_b32 v161, 0xffff0000, v28
  v_lshlrev_b32 v162, 16, v29
  v_and_b32 v163, 0xffff0000, v29
  v_lshlrev_b32 v164, 16, v30
  v_and_b32 v165, 0xffff0000, v30
  v_lshlrev_b32 v166, 16, v31
  v_and_b32 v167, 0xffff0000, v31
  v_lshlrev_b32 v168, 16, v32
  v_and_b32 v169, 0xffff0000, v32
  v_lshlrev_b32 v170, 16, v33
  v_and_b32 v171, 0xffff0000, v33
  v_lshlrev_b32 v172, 16, v34
  v_and_b32 v173, 0xffff0000, v34
  v_lshlrev_b32 v174, 16, v35
  v_and_b32 v175, 0xffff0000, v35
  v_lshlrev_b32 v176, 16, v36
  v_and_b32 v177, 0xffff0000, v36
  v_lshlrev_b32 v178, 16, v37
  v_and_b32 v179, 0xffff0000, v37
  v_lshlrev_b32 v180, 16, v38
  v_and_b32 v181, 0xffff0000, v38
  v_lshlrev_b32 v182, 16, v39
  v_and_b32 v183, 0xffff0000, v39
  s_waitcnt vmcnt(24)
  v_lshlrev_b32 v184, 16, v40
  v_and_b32 v40, 0xffff0000, v40
  v_add_f32 v152, v152, v184
  v_add_f32 v153, v153, v40
  v_lshlrev_b32 v185, 16, v41
  v_and_b32 v41, 0xffff0000, v41
  v_add_f32 v154, v154, v185
  v_add_f32 v155, v155, v41
  v_lshlrev_b32 v184, 16, v42
  v_and_b32 v42, 0xffff0000, v42
  v_add_f32 v156, v156, v184
  v_add_f32 v157, v157, v42
  v_lshlrev_b32 v185, 16, v43
  v_and_b32 v43, 0xffff0000, v43
  v_add_f32 v158, v158, v185
  v_add_f32 v159, v159, v43
  v_lshlrev_b32 v184, 16, v44
  v_and_b32 v44, 0xffff0000, v44
  v_add_f32 v160, v160, v184
  v_add_f32 v161, v161, v44
  v_lshlrev_b32 v185, 16, v45
  v_and_b32 v45, 0xffff0000, v45
  v_add_f32 v162, v162, v185
  v_add_f32 v163, v163, v45
  v_lshlrev_b32 v184, 16, v46
  v_and_b32 v46, 0xffff0000, v46
  v_add_f32 v164, v164, v184
  v_add_f32 v165, v165, v46
  v_lshlrev_b32 v185, 16, v47
  v_and_b32 v47, 0xffff0000, v47
  v_add_f32 v166, v166, v185
  v_add_f32 v167, v167, v47
  v_lshlrev_b32 v184, 16, v48
  v_and_b32 v48, 0xffff0000, v48
  v_add_f32 v168, v168, v184
  v_add_f32 v169, v169, v48
  v_lshlrev_b32 v185, 16, v49
  v_and_b32 v49, 0xffff0000, v49
  v_add_f32 v170, v170, v185
  v_add_f32 v171, v171, v49
  v_lshlrev_b32 v184, 16, v50
  v_and_b32 v50, 0xffff0000, v50
  v_add_f32 v172, v172, v184
  v_add_f32 v173, v173, v50
  v_lshlrev_b32 v185, 16, v51
  v_and_b32 v51, 0xffff0000, v51
  v_add_f32 v174, v174, v185
  v_add_f32 v175, v175, v51
  v_lshlrev_b32 v184, 16, v52
  v_and_b32 v52, 0xffff0000, v52
  v_add_f32 v176, v176, v184
  v_add_f32 v177, v177, v52
  v_lshlrev_b32 v185, 16, v53
  v_and_b32 v53, 0xffff0000, v53
  v_add_f32 v178, v178, v185
  v_add_f32 v179, v179, v53
  v_lshlrev_b32 v184, 16, v54
  v_and_b32 v54, 0xffff0000, v54
  v_add_f32 v180, v180, v184
  v_add_f32 v181, v181, v54
  v_lshlrev_b32 v185, 16, v55
  v_and_b32 v55, 0xffff0000, v55
  v_add_f32 v182, v182, v185
  v_add_f32 v183, v183, v55
  s_waitcnt vmcnt(20)
  v_lshlrev_b32 v184, 16, v56
  v_and_b32 v56, 0xffff0000, v56
  v_add_f32 v152, v152, v184
  v_add_f32 v153, v153, v56
  v_lshlrev_b32 v185, 16, v57
  v_and_b32 v57, 0xffff0000, v57
  v_add_f32 v154, v154, v185
  v_add_f32 v155, v155, v57
  v_lshlrev_b32 v184, 16, v58
  v_and_b32 v58, 0xffff0000, v58
  v_add_f32 v156, v156, v184
  v_add_f32 v157, v157, v58
  v_lshlrev_b32 v185, 16, v59
  v_and_b32 v59, 0xffff0000, v59
  v_add_f32 v158, v158, v185
  v_add_f32 v159, v159, v59
  v_lshlrev_b32 v184, 16, v60
  v_and_b32 v60, 0xffff0000, v60
  v_add_f32 v160, v160, v184
  v_add_f32 v161, v161, v60
  v_lshlrev_b32 v185, 16, v61
  v_and_b32 v61, 0xffff0000, v61
  v_add_f32 v162, v162, v185
  v_add_f32 v163, v163, v61
  v_lshlrev_b32 v184, 16, v62
  v_and_b32 v62, 0xffff0000, v62
  v_add_f32 v164, v164, v184
  v_add_f32 v165, v165, v62
  v_lshlrev_b32 v185, 16, v63
  v_and_b32 v63, 0xffff0000, v63
  v_add_f32 v166, v166, v185
  v_add_f32 v167, v167, v63
  v_lshlrev_b32 v184, 16, v64
  v_and_b32 v64, 0xffff0000, v64
  v_add_f32 v168, v168, v184
  v_add_f32 v169, v169, v64
  v_lshlrev_b32 v185, 16, v65
  v_and_b32 v65, 0xffff0000, v65
  v_add_f32 v170, v170, v185
  v_add_f32 v171, v171, v65
  v_lshlrev_b32 v184, 16, v66
  v_and_b32 v66, 0xffff0000, v66
  v_add_f32 v172, v172, v184
  v_add_f32 v173, v173, v66
  v_lshlrev_b32 v185, 16, v67
  v_and_b32 v67, 0xffff0000, v67
  v_add_f32 v174, v174, v185
  v_add_f32 v175, v175, v67
  v_lshlrev_b32 v184, 16, v68
  v_and_b32 v68, 0xffff0000, v68
  v_add_f32 v176, v176, v184
  v_add_f32 v177, v177, v68
  v_lshlrev_b32 v185, 16, v69
  v_and_b32 v69, 0xffff0000, v69
  v_add_f32 v178, v178, v185
  v_add_f32 v179, v179, v69
  v_lshlrev_b32 v184, 16, v70
  v_and_b32 v70, 0xffff0000, v70
  v_add_f32 v180, v180, v184
  v_add_f32 v181, v181, v70
  v_lshlrev_b32 v185, 16, v71
  v_and_b32 v71, 0xffff0000, v71
  v_add_f32 v182, v182, v185
  v_add_f32 v183, v183, v71
  s_waitcnt vmcnt(16)
  v_lshlrev_b32 v184, 16, v72
  v_and_b32 v72, 0xffff0000, v72
  v_add_f32 v152, v152, v184
  v_add_f32 v153, v153, v72
  v_lshlrev_b32 v185, 16, v73
  v_and_b32 v73, 0xffff0000, v73
  v_add_f32 v154, v154, v185
  v_add_f32 v155, v155, v73
  v_lshlrev_b32 v184, 16, v74
  v_and_b32 v74, 0xffff0000, v74
  v_add_f32 v156, v156, v184
  v_add_f32 v157, v157, v74
  v_lshlrev_b32 v185, 16, v75
  v_and_b32 v75, 0xffff0000, v75
  v_add_f32 v158, v158, v185
  v_add_f32 v159, v159, v75
  v_lshlrev_b32 v184, 16, v76
  v_and_b32 v76, 0xffff0000, v76
  v_add_f32 v160, v160, v184
  v_add_f32 v161, v161, v76
  v_lshlrev_b32 v185, 16, v77
  v_and_b32 v77, 0xffff0000, v77
  v_add_f32 v162, v162, v185
  v_add_f32 v163, v163, v77
  v_lshlrev_b32 v184, 16, v78
  v_and_b32 v78, 0xffff0000, v78
  v_add_f32 v164, v164, v184
  v_add_f32 v165, v165, v78
  v_lshlrev_b32 v185, 16, v79
  v_and_b32 v79, 0xffff0000, v79
  v_add_f32 v166, v166, v185
  v_add_f32 v167, v167, v79
  v_lshlrev_b32 v184, 16, v80
  v_and_b32 v80, 0xffff0000, v80
  v_add_f32 v168, v168, v184
  v_add_f32 v169, v169, v80
  v_lshlrev_b32 v185, 16, v81
  v_and_b32 v81, 0xffff0000, v81
  v_add_f32 v170, v170, v185
  v_add_f32 v171, v171, v81
  v_lshlrev_b32 v184, 16, v82
  v_and_b32 v82, 0xffff0000, v82
  v_add_f32 v172, v172, v184
  v_add_f32 v173, v173, v82
  v_lshlrev_b32 v185, 16, v83
  v_and_b32 v83, 0xffff0000, v83
  v_add_f32 v174, v174, v185
  v_add_f32 v175, v175, v83
  v_lshlrev_b32 v184, 16, v84
  v_and_b32 v84, 0xffff0000, v84
  v_add_f32 v176, v176, v184
  v_add_f32 v177, v177, v84
  v_lshlrev_b32 v185, 16, v85
  v_and_b32 v85, 0xffff0000, v85
  v_add_f32 v178, v178, v185
  v_add_f32 v179, v179, v85
  v_lshlrev_b32 v184, 16, v86
  v_and_b32 v86, 0xffff0000, v86
  v_add_f32 v180, v180, v184
  v_add_f32 v181, v181, v86
  v_lshlrev_b32 v185, 16, v87
  v_and_b32 v87, 0xffff0000, v87
  v_add_f32 v182, v182, v185
  v_add_f32 v183, v183, v87
  s_waitcnt vmcnt(12)
  v_lshlrev_b32 v184, 16, v88
  v_and_b32 v88, 0xffff0000, v88
  v_add_f32 v152, v152, v184
  v_add_f32 v153, v153, v88
  v_lshlrev_b32 v185, 16, v89
  v_and_b32 v89, 0xffff0000, v89
  v_add_f32 v154, v154, v185
  v_add_f32 v155, v155, v89
  v_lshlrev_b32 v184, 16, v90
  v_and_b32 v90, 0xffff0000, v90
  v_add_f32 v156, v156, v184
  v_add_f32 v157, v157, v90
  v_lshlrev_b32 v185, 16, v91
  v_and_b32 v91, 0xffff0000, v91
  v_add_f32 v158, v158, v185
  v_add_f32 v159, v159, v91
  v_lshlrev_b32 v184, 16, v92
  v_and_b32 v92, 0xffff0000, v92
  v_add_f32 v160, v160, v184
  v_add_f32 v161, v161, v92
  v_lshlrev_b32 v185, 16, v93
  v_and_b32 v93, 0xffff0000, v93
  v_add_f32 v162, v162, v185
  v_add_f32 v163, v163, v93
  v_lshlrev_b32 v184, 16, v94
  v_and_b32 v94, 0xffff0000, v94
  v_add_f32 v164, v164, v184
  v_add_f32 v165, v165, v94
  v_lshlrev_b32 v185, 16, v95
  v_and_b32 v95, 0xffff0000, v95
  v_add_f32 v166, v166, v185
  v_add_f32 v167, v167, v95
  v_lshlrev_b32 v184, 16, v96
  v_and_b32 v96, 0xffff0000, v96
  v_add_f32 v168, v168, v184
  v_add_f32 v169, v169, v96
  v_lshlrev_b32 v185, 16, v97
  v_and_b32 v97, 0xffff0000, v97
  v_add_f32 v170, v170, v185
  v_add_f32 v171, v171, v97
  v_lshlrev_b32 v184, 16, v98
  v_and_b32 v98, 0xffff0000, v98
  v_add_f32 v172, v172, v184
  v_add_f32 v173, v173, v98
  v_lshlrev_b32 v185, 16, v99
  v_and_b32 v99, 0xffff0000, v99
  v_add_f32 v174, v174, v185
  v_add_f32 v175, v175, v99
  v_lshlrev_b32 v184, 16, v100
  v_and_b32 v100, 0xffff0000, v100
  v_add_f32 v176, v176, v184
  v_add_f32 v177, v177, v100
  v_lshlrev_b32 v185, 16, v101
  v_and_b32 v101, 0xffff0000, v101
  v_add_f32 v178, v178, v185
  v_add_f32 v179, v179, v101
  v_lshlrev_b32 v184, 16, v102
  v_and_b32 v102, 0xffff0000, v102
  v_add_f32 v180, v180, v184
  v_add_f32 v181, v181, v102
  v_lshlrev_b32 v185, 16, v103
  v_and_b32 v103, 0xffff0000, v103
  v_add_f32 v182, v182, v185
  v_add_f32 v183, v183, v103
  s_waitcnt vmcnt(8)
  v_lshlrev_b32 v184, 16, v104
  v_and_b32 v104, 0xffff0000, v104
  v_add_f32 v152, v152, v184
  v_add_f32 v153, v153, v104
  v_lshlrev_b32 v185, 16, v105
  v_and_b32 v105, 0xffff0000, v105
  v_add_f32 v154, v154, v185
  v_add_f32 v155, v155, v105
  v_lshlrev_b32 v184, 16, v106
  v_and_b32 v106, 0xffff0000, v106
  v_add_f32 v156, v156, v184
  v_add_f32 v157, v157, v106
  v_lshlrev_b32 v185, 16, v107
  v_and_b32 v107, 0xffff0000, v107
  v_add_f32 v158, v158, v185
  v_add_f32 v159, v159, v107
  v_lshlrev_b32 v184, 16, v108
  v_and_b32 v108, 0xffff0000, v108
  v_add_f32 v160, v160, v184
  v_add_f32 v161, v161, v108
  v_lshlrev_b32 v185, 16, v109
  v_and_b32 v109, 0xffff0000, v109
  v_add_f32 v162, v162, v185
  v_add_f32 v163, v163, v109
  v_lshlrev_b32 v184, 16, v110
  v_and_b32 v110, 0xffff0000, v110
  v_add_f32 v164, v164, v184
  v_add_f32 v165, v165, v110
  v_lshlrev_b32 v185, 16, v111
  v_and_b32 v111, 0xffff0000, v111
  v_add_f32 v166, v166, v185
  v_add_f32 v167, v167, v111
  v_lshlrev_b32 v184, 16, v112
  v_and_b32 v112, 0xffff0000, v112
  v_add_f32 v168, v168, v184
  v_add_f32 v169, v169, v112
  v_lshlrev_b32 v185, 16, v113
  v_and_b32 v113, 0xffff0000, v113
  v_add_f32 v170, v170, v185
  v_add_f32 v171, v171, v113
  v_lshlrev_b32 v184, 16, v114
  v_and_b32 v114, 0xffff0000, v114
  v_add_f32 v172, v172, v184
  v_add_f32 v173, v173, v114
  v_lshlrev_b32 v185, 16, v115
  v_and_b32 v115, 0xffff0000, v115
  v_add_f32 v174, v174, v185
  v_add_f32 v175, v175, v115
  v_lshlrev_b32 v184, 16, v116
  v_and_b32 v116, 0xffff0000, v116
  v_add_f32 v176, v176, v184
  v_add_f32 v177, v177, v116
  v_lshlrev_b32 v185, 16, v117
  v_and_b32 v117, 0xffff0000, v117
  v_add_f32 v178, v178, v185
  v_add_f32 v179, v179, v117
  v_lshlrev_b32 v184, 16, v118
  v_and_b32 v118, 0xffff0000, v118
  v_add_f32 v180, v180, v184
  v_add_f32 v181, v181, v118
  v_lshlrev_b32 v185, 16, v119
  v_and_b32 v119, 0xffff0000, v119
  v_add_f32 v182, v182, v185
  v_add_f32 v183, v183, v119
  s_waitcnt vmcnt(4)
  v_lshlrev_b32 v184, 16, v120
  v_and_b32 v120, 0xffff0000, v120
  v_add_f32 v152, v152, v184
  v_add_f32 v153, v153, v120
  v_lshlrev_b32 v185, 16, v121
  v_and_b32 v121, 0xffff0000, v121
  v_add_f32 v154, v154, v185
  v_add_f32 v155, v155, v121
  v_lshlrev_b32 v184, 16, v122
  v_and_b32 v122, 0xffff0000, v122
  v_add_f32 v156, v156, v184
  v_add_f32 v157, v157, v122
  v_lshlrev_b32 v185, 16, v123
  v_and_b32 v123, 0xffff0000, v123
  v_add_f32 v158, v158, v185
  v_add_f32 v159, v159, v123
  v_lshlrev_b32 v184, 16, v124
  v_and_b32 v124, 0xffff0000, v124
  v_add_f32 v160, v160, v184
  v_add_f32 v161, v161, v124
  v_lshlrev_b32 v185, 16, v125
  v_and_b32 v125, 0xffff0000, v125
  v_add_f32 v162, v162, v185
  v_add_f32 v163, v163, v125
  v_lshlrev_b32 v184, 16, v126
  v_and_b32 v126, 0xffff0000, v126
  v_add_f32 v164, v164, v184
  v_add_f32 v165, v165, v126
  v_lshlrev_b32 v185, 16, v127
  v_and_b32 v127, 0xffff0000, v127
  v_add_f32 v166, v166, v185
  v_add_f32 v167, v167, v127
  v_lshlrev_b32 v184, 16, v128
  v_and_b32 v128, 0xffff0000, v128
  v_add_f32 v168, v168, v184
  v_add_f32 v169, v169, v128
  v_lshlrev_b32 v185, 16, v129
  v_and_b32 v129, 0xffff0000, v129
  v_add_f32 v170, v170, v185
  v_add_f32 v171, v171, v129
  v_lshlrev_b32 v184, 16, v130
  v_and_b32 v130, 0xffff0000, v130
  v_add_f32 v172, v172, v184
  v_add_f32 v173, v173, v130
  v_lshlrev_b32 v185, 16, v131
  v_and_b32 v131, 0xffff0000, v131
  v_add_f32 v174, v174, v185
  v_add_f32 v175, v175, v131
  v_lshlrev_b32 v184, 16, v132
  v_and_b32 v132, 0xffff0000, v132
  v_add_f32 v176, v176, v184
  v_add_f32 v177, v177, v132
  v_lshlrev_b32 v185, 16, v133
  v_and_b32 v133, 0xffff0000, v133
  v_add_f32 v178, v178, v185
  v_add_f32 v179, v179, v133
  v_lshlrev_b32 v184, 16, v134
  v_and_b32 v134, 0xffff0000, v134
  v_add_f32 v180, v180, v184
  v_add_f32 v181, v181, v134
  v_lshlrev_b32 v185, 16, v135
  v_and_b32 v135, 0xffff0000, v135
  v_add_f32 v182, v182, v185
  v_add_f32 v183, v183, v135
  s_waitcnt vmcnt(0)
  v_lshlrev_b32 v184, 16, v136
  v_and_b32 v136, 0xffff0000, v136
  v_add_f32 v152, v152, v184
  v_add_f32 v153, v153, v136
  v_lshlrev_b32 v185, 16, v137
  v_and_b32 v137, 0xffff0000, v137
  v_add_f32 v154, v154, v185
  v_add_f32 v155, v155, v137
  v_lshlrev_b32 v184, 16, v138
  v_and_b32 v138, 0xffff0000, v138
  v_add_f32 v156, v156, v184
  v_add_f32 v157, v157, v138
  v_lshlrev_b32 v185, 16, v139
  v_and_b32 v139, 0xffff0000, v139
  v_add_f32 v158, v158, v185
  v_add_f32 v159, v159, v139
  v_lshlrev_b32 v184, 16, v140
  v_and_b32 v140, 0xffff0000, v140
  v_add_f32 v160, v160, v184
  v_add_f32 v161, v161, v140
  v_lshlrev_b32 v185, 16, v141
  v_and_b32 v141, 0xffff0000, v141
  v_add_f32 v162, v162, v185
  v_add_f32 v163, v163, v141
  v_lshlrev_b32 v184, 16, v142
  v_and_b32 v142, 0xffff0000, v142
  v_add_f32 v164, v164, v184
  v_add_f32 v165, v165, v142
  v_lshlrev_b32 v185, 16, v143
  v_and_b32 v143, 0xffff0000, v143
  v_add_f32 v166, v166, v185
  v_add_f32 v167, v167, v143
  v_lshlrev_b32 v184, 16, v144
  v_and_b32 v144, 0xffff0000, v144
  v_add_f32 v168, v168, v184
  v_add_f32 v169, v169, v144
  v_lshlrev_b32 v185, 16, v145
  v_and_b32 v145, 0xffff0000, v145
  v_add_f32 v170, v170, v185
  v_add_f32 v171, v171, v145
  v_lshlrev_b32 v184, 16, v146
  v_and_b32 v146, 0xffff0000, v146
  v_add_f32 v172, v172, v184
  v_add_f32 v173, v173, v146
  v_lshlrev_b32 v185, 16, v147
  v_and_b32 v147, 0xffff0000, v147
  v_add_f32 v174, v174, v185
  v_add_f32 v175, v175, v147
  v_lshlrev_b32 v184, 16, v148
  v_and_b32 v148, 0xffff0000, v148
  v_add_f32 v176, v176, v184
  v_add_f32 v177, v177, v148
  v_lshlrev_b32 v185, 16, v149
  v_and_b32 v149, 0xffff0000, v149
  v_add_f32 v178, v178, v185
  v_add_f32 v179, v179, v149
  v_lshlrev_b32 v184, 16, v150
  v_and_b32 v150, 0xffff0000, v150
  v_add_f32 v180, v180, v184
  v_add_f32 v181, v181, v150
  v_lshlrev_b32 v185, 16, v151
  v_and_b32 v151, 0xffff0000, v151
  v_add_f32 v182, v182, v185
  v_add_f32 v183, v183, v151
rd_p_172m:
  v_cmp_gt_u32 vcc, 8, v186
  s_cbranch_vccz rd_g_173m
  s_sleep 8
  buffer_load_dword v186, off, s[24:27], s32 sc1
  s_sub_u32 s31, s31, 1
  s_cbranch_scc1 fused_kernel_end
  s_waitcnt vmcnt(0)
  s_branch rd_p_172m
rd_g_173m:
  s_cmp_lg_u32 s20, 0
  s_cbranch_scc1 w_pop_174
  s_mov_b64 exec, 1
  v_mov_b32 v255, 1
  buffer_atomic_add v255, off, s[8:11], s28 sc0 sc1
  s_mov_b64 exec, -1
w_pop_174:
  s_lshl_b32 s63, s62, 7
  s_add_u32 s63, s63, 54796288
  buffer_load_dword v6, v5, s[24:27], s63 offen offset:0
  buffer_load_dword v7, v5, s[24:27], s63 offen offset:64
  s_lshl_b32 s62, s62, 16
  s_and_b32 s63, s60, 15
  s_lshl_b32 s63, s63, 7
  s_add_u32 s62, s62, s63
  s_add_u32 s63, s62, 71303168
  s_add_u32 s64, s62, 71335936
  buffer_load_dwordx2 v[8:9], v3, s[24:27], s63 offen offset:0
  buffer_load_dwordx2 v[12:13], v3, s[24:27], s63 offen offset:32
  buffer_load_dwordx2 v[16:17], v3, s[24:27], s63 offen offset:64
  buffer_load_dwordx2 v[20:21], v3, s[24:27], s63 offen offset:96
  buffer_load_dwordx2 v[10:11], v3, s[24:27], s64 offen offset:0
  buffer_load_dwordx2 v[14:15], v3, s[24:27], s64 offen offset:32
  buffer_load_dwordx2 v[18:19], v3, s[24:27], s64 offen offset:64
  buffer_load_dwordx2 v[22:23], v3, s[24:27], s64 offen offset:96
  s_add_u32 s63, s62, 32768
  s_waitcnt vmcnt(0)
  v_lshlrev_b32 v184, 16, v8
  v_and_b32 v8, 0xffff0000, v8
  v_fma_f32 v152, v152, v6, v184
  v_fma_f32 v153, v153, v6, v8
  v_lshlrev_b32 v185, 16, v9
  v_and_b32 v9, 0xffff0000, v9
  v_fma_f32 v154, v154, v6, v185
  v_fma_f32 v155, v155, v6, v9
  v_lshlrev_b32 v184, 16, v10
  v_and_b32 v10, 0xffff0000, v10
  v_fma_f32 v156, v156, v7, v184
  v_fma_f32 v157, v157, v7, v10
  v_lshlrev_b32 v185, 16, v11
  v_and_b32 v11, 0xffff0000, v11
  v_fma_f32 v158, v158, v7, v185
  v_fma_f32 v159, v159, v7, v11
  v_lshlrev_b32 v184, 16, v12
  v_and_b32 v12, 0xffff0000, v12
  v_fma_f32 v160, v160, v6, v184
  v_fma_f32 v161, v161, v6, v12
  v_lshlrev_b32 v185, 16, v13
  v_and_b32 v13, 0xffff0000, v13
  v_fma_f32 v162, v162, v6, v185
  v_fma_f32 v163, v163, v6, v13
  v_lshlrev_b32 v184, 16, v14
  v_and_b32 v14, 0xffff0000, v14
  v_fma_f32 v164, v164, v7, v184
  v_fma_f32 v165, v165, v7, v14
  v_lshlrev_b32 v185, 16, v15
  v_and_b32 v15, 0xffff0000, v15
  v_fma_f32 v166, v166, v7, v185
  v_fma_f32 v167, v167, v7, v15
  v_lshlrev_b32 v184, 16, v16
  v_and_b32 v16, 0xffff0000, v16
  v_fma_f32 v168, v168, v6, v184
  v_fma_f32 v169, v169, v6, v16
  v_lshlrev_b32 v185, 16, v17
  v_and_b32 v17, 0xffff0000, v17
  v_fma_f32 v170, v170, v6, v185
  v_fma_f32 v171, v171, v6, v17
  v_lshlrev_b32 v184, 16, v18
  v_and_b32 v18, 0xffff0000, v18
  v_fma_f32 v172, v172, v7, v184
  v_fma_f32 v173, v173, v7, v18
  v_lshlrev_b32 v185, 16, v19
  v_and_b32 v19, 0xffff0000, v19
  v_fma_f32 v174, v174, v7, v185
  v_fma_f32 v175, v175, v7, v19
  v_lshlrev_b32 v184, 16, v20
  v_and_b32 v20, 0xffff0000, v20
  v_fma_f32 v176, v176, v6, v184
  v_fma_f32 v177, v177, v6, v20
  v_lshlrev_b32 v185, 16, v21
  v_and_b32 v21, 0xffff0000, v21
  v_fma_f32 v178, v178, v6, v185
  v_fma_f32 v179, v179, v6, v21
  v_lshlrev_b32 v184, 16, v22
  v_and_b32 v22, 0xffff0000, v22
  v_fma_f32 v180, v180, v7, v184
  v_fma_f32 v181, v181, v7, v22
  v_lshlrev_b32 v185, 16, v23
  v_and_b32 v23, 0xffff0000, v23
  v_fma_f32 v182, v182, v7, v185
  v_fma_f32 v183, v183, v7, v23
  v_cvt_pk_bf16_f32 v24, v152, v153
  v_cvt_pk_bf16_f32 v25, v154, v155
  v_cvt_pk_bf16_f32 v32, v156, v157
  v_cvt_pk_bf16_f32 v33, v158, v159
  v_cvt_pk_bf16_f32 v26, v160, v161
  v_cvt_pk_bf16_f32 v27, v162, v163
  v_cvt_pk_bf16_f32 v34, v164, v165
  v_cvt_pk_bf16_f32 v35, v166, v167
  v_cvt_pk_bf16_f32 v28, v168, v169
  v_cvt_pk_bf16_f32 v29, v170, v171
  v_cvt_pk_bf16_f32 v36, v172, v173
  v_cvt_pk_bf16_f32 v37, v174, v175
  v_cvt_pk_bf16_f32 v30, v176, v177
  v_cvt_pk_bf16_f32 v31, v178, v179
  v_cvt_pk_bf16_f32 v38, v180, v181
  v_cvt_pk_bf16_f32 v39, v182, v183
  v_permlane16_swap_b32 v24, v26
  v_permlane16_swap_b32 v25, v27
  v_permlane16_swap_b32 v28, v30
  v_permlane16_swap_b32 v29, v31
  v_permlane16_swap_b32 v32, v34
  v_permlane16_swap_b32 v33, v35
  v_permlane16_swap_b32 v36, v38
  v_permlane16_swap_b32 v37, v39
  buffer_store_dwordx4 v[24:27], v4, s[44:47], s62 offen offset:0 sc1
  buffer_store_dwordx4 v[28:31], v4, s[44:47], s62 offen offset:64 sc1
  buffer_store_dwordx4 v[32:35], v4, s[44:47], s63 offen offset:0 sc1
  buffer_store_dwordx4 v[36:39], v4, s[44:47], s63 offen offset:64 sc1
  s_branch w_next_87
fused_kernel_eof:
.section .rodata,"a"
.p2align 6
.amdhsa_kernel fused_kernel
  .amdhsa_next_free_vgpr 256
  .amdhsa_next_free_sgpr 102
  .amdhsa_accum_offset 256
  .amdhsa_group_segment_fixed_size 0
  .amdhsa_kernarg_size 128
  .amdhsa_user_sgpr_count 2
  .amdhsa_user_sgpr_kernarg_segment_ptr 1
  .amdhsa_system_sgpr_workgroup_id_x 1
  .amdhsa_float_denorm_mode_32 3
  .amdhsa_float_denorm_mode_16_64 3
.end_amdhsa_kernel
.text
```
